```python
import torch

def _softmax(x, axis=-1):
    return torch.softmax(x, dim=axis)
def _gelu(x):
    return torch.nn.functional.gelu(x, approximate="tanh")
def _silu(x):
    return torch.nn.functional.silu(x)
def _sigmoid(x):
    return torch.sigmoid(x)
def _layernorm(x, axis=-1, eps=1e-5):
    m = x.mean(dim=axis, keepdim=True)
    v = x.var(dim=axis, keepdim=True, unbiased=False)
    return (x - m) / torch.sqrt(v + eps)
def _scatter_add(tgt, idx, src, axis=0):
    return tgt.clone().index_add_(axis, idx, src)
def _segment_sum(src, seg, n):
    out = torch.zeros((n,) + src.shape[1:], dtype=src.dtype)
    return out.index_add_(0, seg, src)
def _pad(x, pw):
    flat = tuple(v for pair in reversed(pw) for v in pair)
    return torch.nn.functional.pad(x, flat)

kernel_name = 'concat_heads__gqa_block_cached__gqa_block_cached__near_ridge'

def setup_inputs():

    _w = (lambda a: (lambda t: t.to(torch.bfloat16) if t.is_floating_point() else t)(torch.as_tensor(a)))
    def _A_setup():
        B, Sq, D = 32, 48, 512
        Hq, Hkv, Sk, Dh = 32, 8, 512, 128
        assert Hq % Hkv == 0, (Hq, Hkv)
        return {
            "x": _w((lambda *s: torch.randn(*s, dtype=torch.bfloat16) * 0.8)(B, Sq, D)),
            "k_cache": _w((lambda *s: torch.randn(*s, dtype=torch.bfloat16) * 0.8)(B, Hkv, Sk, Dh)),
            "v_cache": _w((lambda *s: torch.randn(*s, dtype=torch.bfloat16) * 0.05)(B, Hkv, Sk, Dh)),
            "wq": _w((lambda *s: torch.randn(*s, dtype=torch.bfloat16) * 0.8)(D, Hq * Dh) * (D ** -0.5)),
            "wo": _w((lambda *s: torch.randn(*s, dtype=torch.bfloat16) * 0.05)(Hq * Dh, D) * ((Hq * Dh) ** -0.5)),
        }
    _A_in = _A_setup()

    def _B_setup():
        B, Sq, D = 32, 48, 512
        Hq, Hkv, Sk, Dh = 32, 8, 512, 128
        assert Hq % Hkv == 0, (Hq, Hkv)
        return {
            "x": _w((lambda *s: torch.randn(*s, dtype=torch.bfloat16) * 0.8)(B, Sq, D)),
            "k_cache": _w((lambda *s: torch.randn(*s, dtype=torch.bfloat16) * 0.8)(B, Hkv, Sk, Dh)),
            "v_cache": _w((lambda *s: torch.randn(*s, dtype=torch.bfloat16) * 0.05)(B, Hkv, Sk, Dh)),
            "wq": _w((lambda *s: torch.randn(*s, dtype=torch.bfloat16) * 0.8)(D, Hq * Dh) * (D ** -0.5)),
            "wo": _w((lambda *s: torch.randn(*s, dtype=torch.bfloat16) * 0.05)(Hq * Dh, D) * ((Hq * Dh) ** -0.5)),
        }
    _B_in = _B_setup()

    return {
        "A_x": _A_in["x"],
        "A_k_cache": _A_in["k_cache"],
        "A_v_cache": _A_in["v_cache"],
        "A_wq": _A_in["wq"],
        "A_wo": _A_in["wo"],
        "B_x": _B_in["x"],
        "B_k_cache": _B_in["k_cache"],
        "B_v_cache": _B_in["v_cache"],
        "B_wq": _B_in["wq"],
        "B_wo": _B_in["wo"],
    }

def reference(A_x, A_k_cache, A_v_cache, A_wq, A_wo, B_x, B_k_cache, B_v_cache, B_wq, B_wo):
    def _A_ref(x, k_cache, v_cache, wq, wo):
        B, Sq, D = x.shape
        Hq, Dh = 32, 128
        Hkv = k_cache.shape[1]
        rep = Hq // Hkv
        q = (lambda x, *d: x.permute(*d))((x @ wq).reshape(B, Sq, Hq, Dh), 0, 2, 1, 3)
        k = (lambda x, n, axis: torch.repeat_interleave(x, n, dim=axis))(k_cache, rep, axis=1)
        v = (lambda x, n, axis: torch.repeat_interleave(x, n, dim=axis))(v_cache, rep, axis=1)
        scores = torch.einsum("bhqd,bhkd->bhqk", q, k) * (Dh ** -0.5)
        p = _softmax(scores, axis=-1)
        o = torch.einsum("bhqk,bhkd->bhqd", p, v)
        return (lambda x, *d: x.permute(*d))(o, 0, 2, 1, 3).reshape(B, Sq, Hq * Dh) @ wo

    def _B_ref(x, k_cache, v_cache, wq, wo):
        B, Sq, D = x.shape
        Hq, Dh = 32, 128
        Hkv = k_cache.shape[1]
        rep = Hq // Hkv
        q = (lambda x, *d: x.permute(*d))((x @ wq).reshape(B, Sq, Hq, Dh), 0, 2, 1, 3)
        k = (lambda x, n, axis: torch.repeat_interleave(x, n, dim=axis))(k_cache, rep, axis=1)
        v = (lambda x, n, axis: torch.repeat_interleave(x, n, dim=axis))(v_cache, rep, axis=1)
        scores = torch.einsum("bhqd,bhkd->bhqk", q, k) * (Dh ** -0.5)
        p = _softmax(scores, axis=-1)
        o = torch.einsum("bhqk,bhkd->bhqd", p, v)
        return (lambda x, *d: x.permute(*d))(o, 0, 2, 1, 3).reshape(B, Sq, Hq * Dh) @ wo

    a = _A_ref(A_x, A_k_cache, A_v_cache, A_wq, A_wo)
    b = _B_ref(B_x, B_k_cache, B_v_cache, B_wq, B_wo)
    return torch.concatenate([a, b], axis=-1)
```

```asm
; @launch grid=(256,1,1) block=(256,1,1) lds=163840
.amdgcn_target "amdgcn-amd-amdhsa--gfx950"
.text
.p2align 12
.globl concat_heads__gqa_block_cached__gqa_block_cached__near_ridge_kernel
.p2align 8
.type concat_heads__gqa_block_cached__gqa_block_cached__near_ridge_kernel,@function
concat_heads__gqa_block_cached__gqa_block_cached__near_ridge_kernel:
    s_cmp_ge_u32 s2, 256
    s_cbranch_scc1 L_exit
    s_load_dwordx16 s[36:51], s[0:1], 0
    s_load_dwordx8 s[52:59], s[0:1], 64
    s_load_dwordx2 s[60:61], s[0:1], 96
    v_lshrrev_b32 v1, 6, v0
    v_and_b32 v216, 63, v0
    v_readfirstlane_b32 s3, v1
    s_lshr_b32 s34, s2, 4
    s_and_b32 s34, s34, 3
    s_lshl2_add_u32 s34, s34, s3
    s_lshr_b32 s34, s2, 4
    s_and_b32 s34, s34, 3
    s_lshl2_add_u32 s34, s34, s3
    s_and_b32 s66, s2, 1
    s_bfe_u32 s64, s2, 0x20001
    s_bfe_u32 s82, s2, 0x10003
    s_lshl_b32 s64, s64, 1
    s_add_u32 s64, s64, s82
    s_lshr_b32 s65, s2, 4
    s_and_b32 s67, s65, 3
    s_and_b32 s62, s3, 1
    s_lshr_b32 s63, s3, 1
    s_and_b32 s82, s65, 14
    s_lshl_b32 s82, s82, 1
    s_lshr_b32 s82, 0x66442200, s82
    s_lshl_b32 s83, s64, 2
    s_lshr_b32 s83, 0x66442200, s83
    s_xor_b32 s82, s82, s83
    s_and_b32 s77, s82, 7
    s_lshl_b32 s82, s77, 12
    s_or_b32 s82, s82, s67
    s_lshl_b32 s71, s82, 7
    s_mul_i32 s82, s62, 40960
    s_lshl_b32 s68, s63, 12
    s_add_u32 s68, s68, s82
    s_mul_i32 s69, s63, 3072
    s_add_u32 s69, s69, s82
    v_lshrrev_b32 v217, 3, v216
    v_and_b32 v218, 7, v216
    v_lshrrev_b32 v219, 4, v216
    v_xor_b32 v219, v218, v219
    v_lshlrev_b32 v219, 4, v219
    v_lshl_or_b32 v219, v217, 10, v219
    s_lshl_b32 s82, s65, 2
    s_lshl_b32 s83, s62, 1
    s_add_u32 s82, s82, s83
    s_add_u32 s82, s82, s63
    s_mul_i32 s82, s82, 24576
    s_lshl_b32 s83, s63, 6
    v_xor_b32 v219, s83, v219
    v_add_u32 v208, s82, v219
    v_xor_b32 v209, 64, v208
    v_add_u32 v209, 7168, v209
    v_add_u32 v210, 14336, v208
    v_bfe_u32 v219, v216, 4, 1
    v_lshlrev_b32 v219, 1, v219
    v_xor_b32 v219, v218, v219
    v_lshlrev_b32 v219, 4, v219
    v_lshl_or_b32 v219, v217, 13, v219
    s_lshl_b32 s82, s63, 8
    s_add_u32 s82, s82, s64
    s_lshl_b32 s82, s82, 1
    s_add_u32 s82, s82, s62
    s_lshl_b32 s82, s82, 9
    v_add_u32 v204, s82, v219
    v_xor_b32 v205, 64, v204
    v_add_u32 v206, 129024, v204
    v_add_u32 v207, 193536, v205
    v_add_u32 v205, 64512, v205
    s_mov_b32 s75, 0x3e0293ee
    s_mov_b32 s78, 0
    s_mov_b32 s79, 0x4e800000
    s_mul_i32 s82, s63, 40960
    v_bfe_u32 v217, v216, 3, 2
    v_and_b32 v218, 3, v216
    v_lshl_or_b32 v217, v217, 2, v218
    v_lshlrev_b32 v217, 3, v217
    v_bfe_u32 v218, v216, 2, 2
    v_lshl_or_b32 v217, v218, 7, v217
    v_lshrrev_b32 v218, 4, v216
    v_lshl_or_b32 v219, v218, 10, v217
    v_add_u32 v192, s82, v219
    v_xor_b32 v193, 32, v192
    v_xor_b32 v194, 64, v192
    v_xor_b32 v195, 0x60, v192
    v_add_u32 v196, 81920, v192
    v_add_u32 v197, 81920, v193
    v_add_u32 v198, 81920, v194
    v_add_u32 v199, 81920, v195
    s_lshl_b32 s82, s82, 1
    v_lshl_or_b32 v219, v218, 9, v217
    v_add_u32 v219, s82, v219
    v_accvgpr_write_b32 a245, v219
    s_mul_i32 s82, s62, 40960
    v_bfe_u32 v217, v216, 1, 3
    v_xor_b32 v217, v217, v218
    v_lshlrev_b32 v217, 4, v217
    v_and_b32 v219, 15, v216
    v_lshl_or_b32 v217, v219, 7, v217
    v_add_u32 v200, s82, v217
    v_xor_b32 v201, 64, v200
    v_add_u32 v202, 81920, v200
    v_add_u32 v203, 81920, v201
    v_lshlrev_b32 v218, 1, v218
    v_and_b32 v217, 7, v216
    v_xor_b32 v217, v217, v218
    v_lshlrev_b32 v217, 4, v217
    v_lshrrev_b32 v218, 3, v216
    v_lshl_or_b32 v217, v218, 10, v217
    s_lshl_b32 s82, s64, 4
    s_add_u32 s82, s82, s63
    s_lshl_b32 s82, s82, 15
    v_add_u32 v217, s82, v217
    v_accvgpr_write_b32 a244, v217
    v_lshlrev_b32 v217, 4, v216
    v_accvgpr_write_b32 a246, v217
    v_mov_b32 v217, 0x3f803f80
    v_accvgpr_write_b32 a240, v217
    v_accvgpr_write_b32 a241, v217
    v_accvgpr_write_b32 a242, v217
    v_accvgpr_write_b32 a243, v217
    v_lshrrev_b32 v217, 4, v216
    v_and_b32 v218, 15, v216
    v_lshlrev_b32 v219, 1, v217
    v_xor_b32 v219, v218, v219
    v_lshlrev_b32 v219, 4, v219
    v_lshl_or_b32 v219, v217, 8, v219
    s_lshl_b32 s82, s65, 1
    s_add_u32 s82, s82, s62
    s_cmp_eq_u32 s66, 1
    s_waitcnt lgkmcnt(0)
    s_cselect_b32 s4, s46, s36
    s_cselect_b32 s5, s47, s37
    s_mov_b32 s6, 1572864
    s_mov_b32 s7, 0x20000
    s_cselect_b32 s16, s52, s42
    s_cselect_b32 s17, s53, s43
    s_mov_b32 s18, 4194304
    s_mov_b32 s19, 0x20000
    s_cselect_b32 s8, s48, s38
    s_cselect_b32 s9, s49, s39
    s_mov_b32 s10, 33554432
    s_mov_b32 s11, 0x20000
    s_cselect_b32 s12, s50, s40
    s_cselect_b32 s13, s51, s41
    s_mov_b32 s14, 33554432
    s_mov_b32 s15, 0x20000
    s_cselect_b32 s20, s54, s44
    s_cselect_b32 s21, s55, s45
    s_mov_b32 s22, 4194304
    s_mov_b32 s23, 0x20000
    s_lshl_b32 s36, s77, 7
    s_mov_b32 s38, 0
    s_add_u32 m0, s69, 8192
    s_xor_b32 s37, s36, 0
    buffer_load_dwordx4 v208, s[4:7], s37 offen offset:0 lds
    buffer_load_dwordx4 v209, s[4:7], s37 offen offset:1024 lds
    buffer_load_dwordx4 v210, s[4:7], s37 offen offset:2048 lds
    s_add_u32 m0, s68, 32768
    s_xor_b32 s73, s71, 0
    buffer_load_dwordx4 v204, s[16:19], s73 offen offset:0 lds
    buffer_load_dwordx4 v205, s[16:19], s73 offen offset:1024 lds
    buffer_load_dwordx4 v206, s[16:19], s73 offen offset:2048 lds
    buffer_load_dwordx4 v207, s[16:19], s73 offen offset:3072 lds
    s_lshl_b32 s82, s82, 3
    s_add_u32 s82, s82, s64
    s_lshl_b32 s82, s82, 5
    s_add_u32 s82, s82, s63
    s_lshl_b32 s82, s82, 12
    v_add_u32 v252, s82, v219
    s_add_u32 m0, s69, 90112
    s_xor_b32 s37, s36, 128
    buffer_load_dwordx4 v208, s[4:7], s37 offen offset:0 lds
    v_xor_b32 v253, 0x80, v252
    v_xor_b32 v254, 16, v252
    v_xor_b32 v255, 0x90, v252
    s_mul_i32 s82, s62, 40960
    s_and_b32 s83, s67, 1
    s_lshl_b32 s83, s83, 7
    s_add_u32 s83, s83, s82
    buffer_load_dwordx4 v209, s[4:7], s37 offen offset:1024 lds
    v_bfe_u32 v219, v216, 4, 1
    v_lshrrev_b32 v220, 5, v216
    v_lshl_or_b32 v217, v219, 1, v220
    v_and_b32 v219, 7, v216
    v_bfe_u32 v220, v216, 3, 1
    v_lshl_or_b32 v219, v219, 1, v220
    v_xor_b32 v219, v219, v217
    buffer_load_dwordx4 v210, s[4:7], s37 offen offset:2048 lds
    v_lshlrev_b32 v219, 4, v219
    v_lshl_or_b32 v219, v218, 8, v219
    v_xor_b32 v240, s83, v219
    v_xor_b32 v241, 64, v240
    v_xor_b32 v242, 0x80, v240
    v_xor_b32 v243, 0xc0, v240
    v_and_b32 v218, 3, v216
    s_add_u32 m0, s68, 114688
    s_xor_b32 s73, s71, 128
    buffer_load_dwordx4 v204, s[16:19], s73 offen offset:0 lds
    v_lshlrev_b32 v219, 1, v218
    v_xor_b32 v219, v219, v217
    v_lshlrev_b32 v219, 4, v219
    v_lshl_or_b32 v219, v218, 8, v219
    v_xor_b32 v212, s83, v219
    v_xor_b32 v213, 64, v212
    buffer_load_dwordx4 v205, s[16:19], s73 offen offset:1024 lds
    v_xor_b32 v214, 0x80, v212
    v_xor_b32 v215, 0xc0, v212
    s_add_u32 s82, s83, 81920
    v_bfe_u32 v217, v216, 2, 3
    v_lshrrev_b32 v218, 5, v216
    v_lshl_or_b32 v217, v217, 1, v218
    v_bfe_u32 v218, v216, 1, 1
    buffer_load_dwordx4 v206, s[16:19], s73 offen offset:2048 lds
    v_xor_b32 v217, v217, v218
    v_and_b32 v218, 1, v216
    v_lshl_or_b32 v217, v217, 1, v218
    v_lshlrev_b32 v217, 3, v217
    v_lshrrev_b32 v218, 2, v216
    v_lshl_or_b32 v217, v218, 8, v217
    v_xor_b32 v244, s82, v217
    buffer_load_dwordx4 v207, s[16:19], s73 offen offset:3072 lds
    v_xor_b32 v245, 0x20, v244
    v_xor_b32 v246, 0x40, v244
    v_xor_b32 v247, 0x60, v244
    v_xor_b32 v248, 0x80, v244
    v_xor_b32 v249, 0xa0, v244
    v_xor_b32 v250, 0xc0, v244
    v_xor_b32 v251, 0xe0, v244
    s_mov_b64 exec, 0
    s_cmp_ge_u32 s34, 7
    s_cbranch_scc1 L_ta_7
    s_cmp_ge_u32 s34, 3
    s_cbranch_scc1 L_ta_3
    s_cmp_eq_u32 s34, 0
    s_cbranch_scc1 L_hopa_0
    s_cmp_eq_u32 s34, 1
    s_cbranch_scc1 L_hopa_1
    s_cmp_eq_u32 s34, 2
    s_cbranch_scc1 L_hopa_2
L_ta_3:
    s_cmp_eq_u32 s34, 3
    s_cbranch_scc1 L_hopa_3
    s_cmp_eq_u32 s34, 4
    s_cbranch_scc1 L_hopa_4
    s_cmp_eq_u32 s34, 5
    s_cbranch_scc1 L_hopa_5
    s_cmp_eq_u32 s34, 6
    s_cbranch_scc1 L_hopa_6
L_ta_7:
    s_cmp_ge_u32 s34, 11
    s_cbranch_scc1 L_ta_11
    s_cmp_eq_u32 s34, 7
    s_cbranch_scc1 L_hopa_7
    s_cmp_eq_u32 s34, 8
    s_cbranch_scc1 L_hopa_8
    s_cmp_eq_u32 s34, 9
    s_cbranch_scc1 L_hopa_9
    s_cmp_eq_u32 s34, 10
    s_cbranch_scc1 L_hopa_10
L_ta_11:
    s_cmp_eq_u32 s34, 11
    s_cbranch_scc1 L_hopa_11
    s_cmp_eq_u32 s34, 12
    s_cbranch_scc1 L_hopa_12
    s_cmp_eq_u32 s34, 13
    s_cbranch_scc1 L_hopa_13
    s_cmp_eq_u32 s34, 14
    s_cbranch_scc1 L_hopa_14
L_backa:
    s_mov_b64 exec, -1
    s_add_u32 m0, s68, 98304
    s_xor_b32 s73, s71, 524288
    buffer_load_dwordx4 v204, s[16:19], s73 offen offset:0 lds
    buffer_load_dwordx4 v205, s[16:19], s73 offen offset:1024 lds
    buffer_load_dwordx4 v206, s[16:19], s73 offen offset:2048 lds
    buffer_load_dwordx4 v207, s[16:19], s73 offen offset:3072 lds
    s_add_u32 m0, s68, 24576
    s_xor_b32 s73, s71, 524416
    buffer_load_dwordx4 v204, s[16:19], s73 offen offset:0 lds
    buffer_load_dwordx4 v205, s[16:19], s73 offen offset:1024 lds
    buffer_load_dwordx4 v206, s[16:19], s73 offen offset:2048 lds
    buffer_load_dwordx4 v207, s[16:19], s73 offen offset:3072 lds
    s_waitcnt vmcnt(15)
    s_barrier
    ds_read_b128 a[0:3], v200 offset:8192
    ds_read_b128 a[12:15], v201 offset:8192
    ds_read_b64_tr_b16 a[192:193], v192 offset:32768
    ds_read_b64_tr_b16 a[194:195], v192 offset:33280
    ds_read_b64_tr_b16 a[196:197], v192 offset:36864
    ds_read_b64_tr_b16 a[198:199], v192 offset:37376
    ds_read_b128 a[4:7], v200 offset:10240
    ds_read_b128 a[16:19], v201 offset:10240
    ds_read_b128 a[8:11], v200 offset:12288
    ds_read_b128 a[20:23], v201 offset:12288
    ds_read_b64_tr_b16 a[200:201], v193 offset:32768
    ds_read_b64_tr_b16 a[202:203], v193 offset:33280
    ds_read_b64_tr_b16 a[204:205], v193 offset:36864
    ds_read_b64_tr_b16 a[206:207], v193 offset:37376
    s_waitcnt lgkmcnt(10)
    v_mfma_f32_16x16x32_bf16 v[0:3], a[192:195], a[0:3], 0
    s_waitcnt lgkmcnt(8)
    s_add_u32 m0, s69, 16384
    ds_read_b64_tr_b16 a[208:209], v194 offset:32768
    v_mfma_f32_16x16x32_bf16 v[0:3], a[196:199], a[12:15], v[0:3]
    s_waitcnt lgkmcnt(8)
    s_xor_b32 s37, s36, 256
    ds_read_b64_tr_b16 a[210:211], v194 offset:33280
    v_mfma_f32_16x16x32_bf16 v[4:7], a[192:195], a[4:7], 0
    s_waitcnt lgkmcnt(8)
    buffer_load_dwordx4 v208, s[4:7], s37 offen offset:0 lds
    v_mfma_f32_16x16x32_bf16 v[4:7], a[196:199], a[16:19], v[4:7]
    s_waitcnt lgkmcnt(7)
    ds_read_b64_tr_b16 a[212:213], v194 offset:36864
    v_mfma_f32_16x16x32_bf16 v[8:11], a[192:195], a[8:11], 0
    s_waitcnt lgkmcnt(7)
    ds_read_b64_tr_b16 a[214:215], v194 offset:37376
    v_mfma_f32_16x16x32_bf16 v[8:11], a[196:199], a[20:23], v[8:11]
    s_waitcnt lgkmcnt(4)
    v_mfma_f32_16x16x32_bf16 v[12:15], a[200:203], a[0:3], 0
    buffer_load_dwordx4 v209, s[4:7], s37 offen offset:1024 lds
    v_mfma_f32_16x16x32_bf16 v[12:15], a[204:207], a[12:15], v[12:15]
    ds_read_b64_tr_b16 a[192:193], v195 offset:32768
    ds_read_b64_tr_b16 a[194:195], v195 offset:33280
    v_mfma_f32_16x16x32_bf16 v[16:19], a[200:203], a[4:7], 0
    ds_read_b64_tr_b16 a[196:197], v195 offset:36864
    ds_read_b64_tr_b16 a[198:199], v195 offset:37376
    v_mfma_f32_16x16x32_bf16 v[16:19], a[204:207], a[16:19], v[16:19]
    buffer_load_dwordx4 v210, s[4:7], s37 offen offset:2048 lds
    v_mfma_f32_16x16x32_bf16 v[20:23], a[200:203], a[8:11], 0
    v_mfma_f32_16x16x32_bf16 v[20:23], a[204:207], a[20:23], v[20:23]
    s_waitcnt lgkmcnt(4)
    v_mfma_f32_16x16x32_bf16 v[24:27], a[208:211], a[0:3], 0
    s_add_u32 m0, s68, 106496
    v_mfma_f32_16x16x32_bf16 v[24:27], a[212:215], a[12:15], v[24:27]
    s_waitcnt vmcnt(11) lgkmcnt(0)
    v_mfma_f32_16x16x32_bf16 v[28:31], a[208:211], a[4:7], 0
    s_barrier
    ds_read_b64_tr_b16 a[200:201], v196 offset:32768
    ds_read_b64_tr_b16 a[202:203], v196 offset:33280
    v_mfma_f32_16x16x32_bf16 v[28:31], a[212:215], a[16:19], v[28:31]
    s_xor_b32 s73, s71, 1048576
    ds_read_b64_tr_b16 a[204:205], v196 offset:36864
    v_mfma_f32_16x16x32_bf16 v[32:35], a[208:211], a[8:11], 0
    buffer_load_dwordx4 v204, s[16:19], s73 offen offset:0 lds
    v_mfma_f32_16x16x32_bf16 v[32:35], a[212:215], a[20:23], v[32:35]
    ds_read_b64_tr_b16 a[206:207], v196 offset:37376
    ds_read_b128 a[24:27], v202 offset:8192
    v_mfma_f32_16x16x32_bf16 v[36:39], a[192:195], a[0:3], 0
    ds_read_b64_tr_b16 a[208:209], v197 offset:32768
    ds_read_b64_tr_b16 a[210:211], v197 offset:33280
    v_mfma_f32_16x16x32_bf16 v[36:39], a[196:199], a[12:15], v[36:39]
    buffer_load_dwordx4 v205, s[16:19], s73 offen offset:1024 lds
    v_mfma_f32_16x16x32_bf16 v[40:43], a[192:195], a[4:7], 0
    ds_read_b64_tr_b16 a[212:213], v197 offset:36864
    ds_read_b128 a[36:39], v203 offset:8192
    v_mfma_f32_16x16x32_bf16 v[40:43], a[196:199], a[16:19], v[40:43]
    ds_read_b64_tr_b16 a[214:215], v197 offset:37376
    v_mfma_f32_16x16x32_bf16 v[44:47], a[192:195], a[8:11], 0
    buffer_load_dwordx4 v206, s[16:19], s73 offen offset:2048 lds
    v_mfma_f32_16x16x32_bf16 v[44:47], a[196:199], a[20:23], v[44:47]
    s_waitcnt lgkmcnt(6)
    ds_read_b128 a[28:31], v202 offset:10240
    v_mfma_f32_16x16x32_bf16 v[48:51], a[200:203], a[0:3], 0
    ds_read_b64_tr_b16 a[192:193], v198 offset:32768
    ds_read_b64_tr_b16 a[194:195], v198 offset:33280
    v_mfma_f32_16x16x32_bf16 v[48:51], a[204:207], a[12:15], v[48:51]
    buffer_load_dwordx4 v207, s[16:19], s73 offen offset:3072 lds
    v_mfma_f32_16x16x32_bf16 v[52:55], a[200:203], a[4:7], 0
    s_add_u32 m0, s69, 8192
    ds_read_b64_tr_b16 a[196:197], v198 offset:36864
    ds_read_b128 a[40:43], v203 offset:10240
    v_mfma_f32_16x16x32_bf16 v[52:55], a[204:207], a[16:19], v[52:55]
    s_xor_b32 s37, s36, 384
    ds_read_b64_tr_b16 a[198:199], v198 offset:37376
    v_mfma_f32_16x16x32_bf16 v[56:59], a[200:203], a[8:11], 0
    buffer_load_dwordx4 v208, s[4:7], s37 offen offset:0 lds
    v_mfma_f32_16x16x32_bf16 v[56:59], a[204:207], a[20:23], v[56:59]
    s_waitcnt lgkmcnt(6)
    ds_read_b128 a[32:35], v202 offset:12288
    v_mfma_f32_16x16x32_bf16 v[60:63], a[208:211], a[0:3], 0
    ds_read_b64_tr_b16 a[200:201], v199 offset:32768
    ds_read_b64_tr_b16 a[202:203], v199 offset:33280
    v_mfma_f32_16x16x32_bf16 v[60:63], a[212:215], a[12:15], v[60:63]
    buffer_load_dwordx4 v209, s[4:7], s37 offen offset:1024 lds
    v_mfma_f32_16x16x32_bf16 v[64:67], a[208:211], a[4:7], 0
    ds_read_b64_tr_b16 a[204:205], v199 offset:36864
    ds_read_b128 a[44:47], v203 offset:12288
    v_mfma_f32_16x16x32_bf16 v[64:67], a[212:215], a[16:19], v[64:67]
    ds_read_b64_tr_b16 a[206:207], v199 offset:37376
    v_mfma_f32_16x16x32_bf16 v[68:71], a[208:211], a[8:11], 0
    buffer_load_dwordx4 v210, s[4:7], s37 offen offset:2048 lds
    v_mfma_f32_16x16x32_bf16 v[68:71], a[212:215], a[20:23], v[68:71]
    s_waitcnt lgkmcnt(6)
    v_mfma_f32_16x16x32_bf16 v[72:75], a[192:195], a[0:3], 0
    s_add_u32 m0, s68, 32768
    v_mfma_f32_16x16x32_bf16 v[72:75], a[196:199], a[12:15], v[72:75]
    s_waitcnt vmcnt(14) lgkmcnt(0)
    v_mfma_f32_16x16x32_bf16 v[76:79], a[192:195], a[4:7], 0
    s_barrier
    ds_read_b64_tr_b16 a[208:209], v196 offset:16384
    ds_read_b64_tr_b16 a[210:211], v196 offset:16896
    v_mfma_f32_16x16x32_bf16 v[76:79], a[196:199], a[16:19], v[76:79]
    s_xor_b32 s73, s71, 1048704
    ds_read_b64_tr_b16 a[212:213], v196 offset:20480
    v_mfma_f32_16x16x32_bf16 v[80:83], a[192:195], a[8:11], 0
    buffer_load_dwordx4 v204, s[16:19], s73 offen offset:0 lds
    v_mfma_f32_16x16x32_bf16 v[80:83], a[196:199], a[20:23], v[80:83]
    ds_read_b64_tr_b16 a[214:215], v196 offset:20992
    v_mfma_f32_16x16x32_bf16 v[84:87], a[200:203], a[0:3], 0
    buffer_load_dwordx4 v205, s[16:19], s73 offen offset:1024 lds
    v_mfma_f32_16x16x32_bf16 v[84:87], a[204:207], a[12:15], v[84:87]
    ds_read_b64_tr_b16 a[192:193], v197 offset:16384
    ds_read_b64_tr_b16 a[194:195], v197 offset:16896
    v_mfma_f32_16x16x32_bf16 v[88:91], a[200:203], a[4:7], 0
    buffer_load_dwordx4 v206, s[16:19], s73 offen offset:2048 lds
    v_mfma_f32_16x16x32_bf16 v[88:91], a[204:207], a[16:19], v[88:91]
    ds_read_b64_tr_b16 a[196:197], v197 offset:20480
    ds_read_b64_tr_b16 a[198:199], v197 offset:20992
    v_mfma_f32_16x16x32_bf16 v[92:95], a[200:203], a[8:11], 0
    buffer_load_dwordx4 v207, s[16:19], s73 offen offset:3072 lds
    v_mfma_f32_16x16x32_bf16 v[92:95], a[204:207], a[20:23], v[92:95]
    s_waitcnt lgkmcnt(4)
    s_add_u32 m0, s68, 114688
    v_mfma_f32_16x16x32_bf16 v[0:3], a[208:211], a[24:27], v[0:3]
    s_xor_b32 s73, s71, 1572864
    buffer_load_dwordx4 v204, s[16:19], s73 offen offset:0 lds
    v_mfma_f32_16x16x32_bf16 v[0:3], a[212:215], a[36:39], v[0:3]
    ds_read_b64_tr_b16 a[200:201], v198 offset:16384
    ds_read_b64_tr_b16 a[202:203], v198 offset:16896
    v_mfma_f32_16x16x32_bf16 v[4:7], a[208:211], a[28:31], v[4:7]
    ds_read_b64_tr_b16 a[204:205], v198 offset:20480
    v_mfma_f32_16x16x32_bf16 v[4:7], a[212:215], a[40:43], v[4:7]
    buffer_load_dwordx4 v205, s[16:19], s73 offen offset:1024 lds
    v_mfma_f32_16x16x32_bf16 v[8:11], a[208:211], a[32:35], v[8:11]
    s_add_u32 m0, s68, 0
    ds_read_b64_tr_b16 a[206:207], v198 offset:20992
    v_mfma_f32_16x16x32_bf16 v[8:11], a[212:215], a[44:47], v[8:11]
    s_waitcnt lgkmcnt(4)
    s_xor_b32 s74, s38, 0
    buffer_load_dwordx4 v252, s[8:11], s74 offen offset:0 nt lds
    v_mfma_f32_16x16x32_bf16 v[12:15], a[192:195], a[24:27], v[12:15]
    ds_read_b64_tr_b16 a[208:209], v199 offset:16384
    ds_read_b64_tr_b16 a[210:211], v199 offset:16896
    v_mfma_f32_16x16x32_bf16 v[12:15], a[196:199], a[36:39], v[12:15]
    buffer_load_dwordx4 v253, s[8:11], s74 offen offset:1024 nt lds
    v_mfma_f32_16x16x32_bf16 v[16:19], a[192:195], a[28:31], v[16:19]
    ds_read_b64_tr_b16 a[212:213], v199 offset:20480
    ds_read_b64_tr_b16 a[214:215], v199 offset:20992
    v_mfma_f32_16x16x32_bf16 v[16:19], a[196:199], a[40:43], v[16:19]
    buffer_load_dwordx4 v254, s[8:11], s74 offen offset:2048 nt lds
    v_mfma_f32_16x16x32_bf16 v[20:23], a[192:195], a[32:35], v[20:23]
    v_mfma_f32_16x16x32_bf16 v[20:23], a[196:199], a[44:47], v[20:23]
    s_waitcnt lgkmcnt(4)
    buffer_load_dwordx4 v255, s[8:11], s74 offen offset:3072 nt lds
    v_mfma_f32_16x16x32_bf16 v[24:27], a[200:203], a[24:27], v[24:27]
    s_add_u32 m0, s68, 114688
    v_mfma_f32_16x16x32_bf16 v[24:27], a[204:207], a[36:39], v[24:27]
    s_waitcnt vmcnt(17) lgkmcnt(0)
    v_mfma_f32_16x16x32_bf16 v[28:31], a[200:203], a[28:31], v[28:31]
    s_barrier
    ds_read_b64_tr_b16 a[192:193], v192 offset:24576
    ds_read_b64_tr_b16 a[194:195], v192 offset:25088
    v_mfma_f32_16x16x32_bf16 v[28:31], a[204:207], a[40:43], v[28:31]
    s_xor_b32 s73, s71, 1572864
    ds_read_b64_tr_b16 a[196:197], v192 offset:28672
    v_mfma_f32_16x16x32_bf16 v[32:35], a[200:203], a[32:35], v[32:35]
    buffer_load_dwordx4 v206, s[16:19], s73 offen offset:2048 lds
    v_mfma_f32_16x16x32_bf16 v[32:35], a[204:207], a[44:47], v[32:35]
    ds_read_b64_tr_b16 a[198:199], v192 offset:29184
    ds_read_b128 a[48:51], v200 offset:16384
    v_mfma_f32_16x16x32_bf16 v[36:39], a[208:211], a[24:27], v[36:39]
    ds_read_b64_tr_b16 a[200:201], v193 offset:24576
    v_mfma_f32_16x16x32_bf16 v[36:39], a[212:215], a[36:39], v[36:39]
    ds_read_b64_tr_b16 a[202:203], v193 offset:25088
    ds_read_b128 a[60:63], v201 offset:16384
    v_mfma_f32_16x16x32_bf16 v[40:43], a[208:211], a[28:31], v[40:43]
    buffer_load_dwordx4 v207, s[16:19], s73 offen offset:3072 lds
    v_mfma_f32_16x16x32_bf16 v[40:43], a[212:215], a[40:43], v[40:43]
    s_add_u32 m0, s68, 98304
    ds_read_b64_tr_b16 a[204:205], v193 offset:28672
    v_mfma_f32_16x16x32_bf16 v[44:47], a[208:211], a[32:35], v[44:47]
    s_xor_b32 s73, s71, 1572992
    ds_read_b64_tr_b16 a[206:207], v193 offset:29184
    ds_read_b128 a[52:55], v200 offset:18432
    v_mfma_f32_16x16x32_bf16 v[44:47], a[212:215], a[44:47], v[44:47]
    s_waitcnt lgkmcnt(7)
    buffer_load_dwordx4 v204, s[16:19], s73 offen offset:0 lds
    v_mfma_f32_16x16x32_bf16 v[48:51], a[192:195], a[24:27], v[48:51]
    ds_read_b64_tr_b16 a[208:209], v194 offset:24576
    v_mfma_f32_16x16x32_bf16 v[48:51], a[196:199], a[36:39], v[48:51]
    ds_read_b64_tr_b16 a[210:211], v194 offset:25088
    ds_read_b128 a[64:67], v201 offset:18432
    v_mfma_f32_16x16x32_bf16 v[52:55], a[192:195], a[28:31], v[52:55]
    ds_read_b64_tr_b16 a[212:213], v194 offset:28672
    v_mfma_f32_16x16x32_bf16 v[52:55], a[196:199], a[40:43], v[52:55]
    buffer_load_dwordx4 v205, s[16:19], s73 offen offset:1024 lds
    v_mfma_f32_16x16x32_bf16 v[56:59], a[192:195], a[32:35], v[56:59]
    ds_read_b64_tr_b16 a[214:215], v194 offset:29184
    ds_read_b128 a[56:59], v200 offset:20480
    v_mfma_f32_16x16x32_bf16 v[56:59], a[196:199], a[44:47], v[56:59]
    s_waitcnt lgkmcnt(7)
    v_mfma_f32_16x16x32_bf16 v[60:63], a[200:203], a[24:27], v[60:63]
    buffer_load_dwordx4 v206, s[16:19], s73 offen offset:2048 lds
    v_mfma_f32_16x16x32_bf16 v[60:63], a[204:207], a[36:39], v[60:63]
    s_add_u32 m0, s69, 90112
    ds_read_b64_tr_b16 a[192:193], v195 offset:24576
    ds_read_b64_tr_b16 a[194:195], v195 offset:25088
    v_mfma_f32_16x16x32_bf16 v[64:67], a[200:203], a[28:31], v[64:67]
    s_xor_b32 s37, s36, 512
    ds_read_b64_tr_b16 a[196:197], v195 offset:28672
    ds_read_b128 a[68:71], v201 offset:20480
    v_mfma_f32_16x16x32_bf16 v[64:67], a[204:207], a[40:43], v[64:67]
    ds_read_b64_tr_b16 a[198:199], v195 offset:29184
    v_mfma_f32_16x16x32_bf16 v[68:71], a[200:203], a[32:35], v[68:71]
L_hopa_0:
    s_cbranch_execz L_backa
    buffer_load_dwordx4 v208, s[4:7], s37 offen offset:0 lds
    v_mfma_f32_16x16x32_bf16 v[68:71], a[204:207], a[44:47], v[68:71]
    s_waitcnt lgkmcnt(6)
    v_mfma_f32_16x16x32_bf16 v[72:75], a[208:211], a[24:27], v[72:75]
    s_add_u32 m0, s68, 98304
    v_mfma_f32_16x16x32_bf16 v[72:75], a[212:215], a[36:39], v[72:75]
    s_waitcnt vmcnt(19) lgkmcnt(0)
    v_mfma_f32_16x16x32_bf16 v[76:79], a[208:211], a[28:31], v[76:79]
    s_barrier
    ds_read_b64_tr_b16 a[200:201], v196 offset:24576
    ds_read_b64_tr_b16 a[202:203], v196 offset:25088
    v_mfma_f32_16x16x32_bf16 v[76:79], a[212:215], a[40:43], v[76:79]
    s_xor_b32 s73, s71, 1572992
    ds_read_b64_tr_b16 a[204:205], v196 offset:28672
    v_mfma_f32_16x16x32_bf16 v[80:83], a[208:211], a[32:35], v[80:83]
    buffer_load_dwordx4 v207, s[16:19], s73 offen offset:3072 lds
    v_mfma_f32_16x16x32_bf16 v[80:83], a[212:215], a[44:47], v[80:83]
    s_add_u32 m0, s68, 24576
    ds_read_b64_tr_b16 a[206:207], v196 offset:29184
    v_mfma_f32_16x16x32_bf16 v[84:87], a[192:195], a[24:27], v[84:87]
    s_xor_b32 s73, s71, 2097152
    ds_read_b64_tr_b16 a[208:209], v197 offset:24576
    ds_read_b64_tr_b16 a[210:211], v197 offset:25088
    v_mfma_f32_16x16x32_bf16 v[84:87], a[196:199], a[36:39], v[84:87]
    buffer_load_dwordx4 v204, s[16:19], s73 offen offset:0 lds
    v_mfma_f32_16x16x32_bf16 v[88:91], a[192:195], a[28:31], v[88:91]
    ds_read_b64_tr_b16 a[212:213], v197 offset:28672
    v_mfma_f32_16x16x32_bf16 v[88:91], a[196:199], a[40:43], v[88:91]
    ds_read_b64_tr_b16 a[214:215], v197 offset:29184
    v_mfma_f32_16x16x32_bf16 v[92:95], a[192:195], a[32:35], v[92:95]
    buffer_load_dwordx4 v205, s[16:19], s73 offen offset:1024 lds
    v_mfma_f32_16x16x32_bf16 v[92:95], a[196:199], a[44:47], v[92:95]
    s_waitcnt lgkmcnt(4)
    v_mfma_f32_16x16x32_bf16 v[0:3], a[200:203], a[48:51], v[0:3]
    ds_read_b64_tr_b16 a[192:193], v198 offset:24576
    ds_read_b64_tr_b16 a[194:195], v198 offset:25088
    v_mfma_f32_16x16x32_bf16 v[0:3], a[204:207], a[60:63], v[0:3]
    buffer_load_dwordx4 v206, s[16:19], s73 offen offset:2048 lds
    v_mfma_f32_16x16x32_bf16 v[4:7], a[200:203], a[52:55], v[4:7]
    ds_read_b64_tr_b16 a[196:197], v198 offset:28672
    v_mfma_f32_16x16x32_bf16 v[4:7], a[204:207], a[64:67], v[4:7]
    ds_read_b64_tr_b16 a[198:199], v198 offset:29184
    v_mfma_f32_16x16x32_bf16 v[8:11], a[200:203], a[56:59], v[8:11]
    buffer_load_dwordx4 v207, s[16:19], s73 offen offset:3072 lds
    v_mfma_f32_16x16x32_bf16 v[8:11], a[204:207], a[68:71], v[8:11]
    s_waitcnt lgkmcnt(4)
    v_mfma_f32_16x16x32_bf16 v[12:15], a[208:211], a[48:51], v[12:15]
    s_add_u32 m0, s69, 90112
    ds_read_b64_tr_b16 a[200:201], v199 offset:24576
    ds_read_b64_tr_b16 a[202:203], v199 offset:25088
    v_mfma_f32_16x16x32_bf16 v[12:15], a[212:215], a[60:63], v[12:15]
    s_xor_b32 s37, s36, 512
    buffer_load_dwordx4 v209, s[4:7], s37 offen offset:1024 lds
    v_mfma_f32_16x16x32_bf16 v[16:19], a[208:211], a[52:55], v[16:19]
    ds_read_b64_tr_b16 a[204:205], v199 offset:28672
    v_mfma_f32_16x16x32_bf16 v[16:19], a[212:215], a[64:67], v[16:19]
    ds_read_b64_tr_b16 a[206:207], v199 offset:29184
    v_mfma_f32_16x16x32_bf16 v[20:23], a[208:211], a[56:59], v[20:23]
    buffer_load_dwordx4 v210, s[4:7], s37 offen offset:2048 lds
    v_mfma_f32_16x16x32_bf16 v[20:23], a[212:215], a[68:71], v[20:23]
    s_waitcnt lgkmcnt(4)
    v_mfma_f32_16x16x32_bf16 v[24:27], a[192:195], a[48:51], v[24:27]
    s_add_u32 m0, s68, 106496
    v_mfma_f32_16x16x32_bf16 v[24:27], a[196:199], a[60:63], v[24:27]
    s_waitcnt vmcnt(19) lgkmcnt(0)
    v_mfma_f32_16x16x32_bf16 v[28:31], a[192:195], a[52:55], v[28:31]
    s_barrier
    ds_read_b64_tr_b16 a[208:209], v192 offset:32768
    ds_read_b64_tr_b16 a[210:211], v192 offset:33280
    v_mfma_f32_16x16x32_bf16 v[28:31], a[196:199], a[64:67], v[28:31]
    s_xor_b32 s73, s71, 2097280
    ds_read_b64_tr_b16 a[212:213], v192 offset:36864
    v_mfma_f32_16x16x32_bf16 v[32:35], a[192:195], a[56:59], v[32:35]
    buffer_load_dwordx4 v204, s[16:19], s73 offen offset:0 lds
    v_mfma_f32_16x16x32_bf16 v[32:35], a[196:199], a[68:71], v[32:35]
    ds_read_b64_tr_b16 a[214:215], v192 offset:37376
    ds_read_b128 a[72:75], v200 offset:8192
    v_mfma_f32_16x16x32_bf16 v[36:39], a[200:203], a[48:51], v[36:39]
    ds_read_b64_tr_b16 a[192:193], v193 offset:32768
    v_mfma_f32_16x16x32_bf16 v[36:39], a[204:207], a[60:63], v[36:39]
    ds_read_b64_tr_b16 a[194:195], v193 offset:33280
    ds_read_b128 a[84:87], v201 offset:8192
    v_mfma_f32_16x16x32_bf16 v[40:43], a[200:203], a[52:55], v[40:43]
    buffer_load_dwordx4 v205, s[16:19], s73 offen offset:1024 lds
    v_mfma_f32_16x16x32_bf16 v[40:43], a[204:207], a[64:67], v[40:43]
    ds_read_b64_tr_b16 a[196:197], v193 offset:36864
    v_mfma_f32_16x16x32_bf16 v[44:47], a[200:203], a[56:59], v[44:47]
    ds_read_b64_tr_b16 a[198:199], v193 offset:37376
    ds_read_b128 a[76:79], v200 offset:10240
    v_mfma_f32_16x16x32_bf16 v[44:47], a[204:207], a[68:71], v[44:47]
    s_waitcnt lgkmcnt(7)
    v_mfma_f32_16x16x32_bf16 v[48:51], a[208:211], a[48:51], v[48:51]
    buffer_load_dwordx4 v206, s[16:19], s73 offen offset:2048 lds
    v_mfma_f32_16x16x32_bf16 v[48:51], a[212:215], a[60:63], v[48:51]
    ds_read_b64_tr_b16 a[200:201], v194 offset:32768
    ds_read_b128 a[88:91], v201 offset:10240
    v_mfma_f32_16x16x32_bf16 v[52:55], a[208:211], a[52:55], v[52:55]
    ds_read_b64_tr_b16 a[202:203], v194 offset:33280
    v_mfma_f32_16x16x32_bf16 v[52:55], a[212:215], a[64:67], v[52:55]
    ds_read_b64_tr_b16 a[204:205], v194 offset:36864
    v_mfma_f32_16x16x32_bf16 v[56:59], a[208:211], a[56:59], v[56:59]
    ds_read_b64_tr_b16 a[206:207], v194 offset:37376
    ds_read_b128 a[80:83], v200 offset:12288
    v_mfma_f32_16x16x32_bf16 v[56:59], a[212:215], a[68:71], v[56:59]
    s_waitcnt lgkmcnt(7)
    buffer_load_dwordx4 v207, s[16:19], s73 offen offset:3072 lds
    v_mfma_f32_16x16x32_bf16 v[60:63], a[192:195], a[48:51], v[60:63]
    s_add_u32 m0, s69, 16384
    ds_read_b64_tr_b16 a[208:209], v195 offset:32768
    ds_read_b64_tr_b16 a[210:211], v195 offset:33280
    v_mfma_f32_16x16x32_bf16 v[60:63], a[196:199], a[60:63], v[60:63]
    s_xor_b32 s37, s36, 640
    ds_read_b64_tr_b16 a[212:213], v195 offset:36864
    ds_read_b128 a[92:95], v201 offset:12288
    v_mfma_f32_16x16x32_bf16 v[64:67], a[192:195], a[52:55], v[64:67]
    ds_read_b64_tr_b16 a[214:215], v195 offset:37376
    v_mfma_f32_16x16x32_bf16 v[64:67], a[196:199], a[64:67], v[64:67]
    buffer_load_dwordx4 v208, s[4:7], s37 offen offset:0 lds
    v_mfma_f32_16x16x32_bf16 v[68:71], a[192:195], a[56:59], v[68:71]
    v_mfma_f32_16x16x32_bf16 v[68:71], a[196:199], a[68:71], v[68:71]
    s_waitcnt lgkmcnt(6)
    v_mfma_f32_16x16x32_bf16 v[72:75], a[200:203], a[48:51], v[72:75]
    s_add_u32 m0, s68, 32768
    v_mfma_f32_16x16x32_bf16 v[72:75], a[204:207], a[60:63], v[72:75]
    s_waitcnt vmcnt(16) lgkmcnt(0)
    v_mfma_f32_16x16x32_bf16 v[76:79], a[200:203], a[52:55], v[76:79]
    s_barrier
    ds_read_b64_tr_b16 a[192:193], v196 offset:32768
    ds_read_b64_tr_b16 a[194:195], v196 offset:33280
    v_mfma_f32_16x16x32_bf16 v[76:79], a[204:207], a[64:67], v[76:79]
    s_xor_b32 s73, s71, 2621440
    ds_read_b64_tr_b16 a[196:197], v196 offset:36864
    v_mfma_f32_16x16x32_bf16 v[80:83], a[200:203], a[56:59], v[80:83]
    buffer_load_dwordx4 v204, s[16:19], s73 offen offset:0 lds
    v_mfma_f32_16x16x32_bf16 v[80:83], a[204:207], a[68:71], v[80:83]
    ds_read_b64_tr_b16 a[198:199], v196 offset:37376
    v_mfma_f32_16x16x32_bf16 v[84:87], a[208:211], a[48:51], v[84:87]
    buffer_load_dwordx4 v205, s[16:19], s73 offen offset:1024 lds
    v_mfma_f32_16x16x32_bf16 v[84:87], a[212:215], a[60:63], v[84:87]
    ds_read_b64_tr_b16 a[200:201], v197 offset:32768
    ds_read_b64_tr_b16 a[202:203], v197 offset:33280
    v_mfma_f32_16x16x32_bf16 v[88:91], a[208:211], a[52:55], v[88:91]
    buffer_load_dwordx4 v206, s[16:19], s73 offen offset:2048 lds
    v_mfma_f32_16x16x32_bf16 v[88:91], a[212:215], a[64:67], v[88:91]
    ds_read_b64_tr_b16 a[204:205], v197 offset:36864
    ds_read_b64_tr_b16 a[206:207], v197 offset:37376
    v_mfma_f32_16x16x32_bf16 v[92:95], a[208:211], a[56:59], v[92:95]
    buffer_load_dwordx4 v207, s[16:19], s73 offen offset:3072 lds
    v_mfma_f32_16x16x32_bf16 v[92:95], a[212:215], a[68:71], v[92:95]
    s_waitcnt lgkmcnt(4)
    s_add_u32 m0, s69, 16384
    v_mfma_f32_16x16x32_bf16 v[0:3], a[192:195], a[72:75], v[0:3]
    s_xor_b32 s37, s36, 640
    buffer_load_dwordx4 v209, s[4:7], s37 offen offset:1024 lds
    v_mfma_f32_16x16x32_bf16 v[0:3], a[196:199], a[84:87], v[0:3]
    ds_read_b64_tr_b16 a[208:209], v198 offset:32768
    ds_read_b64_tr_b16 a[210:211], v198 offset:33280
    v_mfma_f32_16x16x32_bf16 v[4:7], a[192:195], a[76:79], v[4:7]
    ds_read_b64_tr_b16 a[212:213], v198 offset:36864
    v_mfma_f32_16x16x32_bf16 v[4:7], a[196:199], a[88:91], v[4:7]
    buffer_load_dwordx4 v210, s[4:7], s37 offen offset:2048 lds
    v_mfma_f32_16x16x32_bf16 v[8:11], a[192:195], a[80:83], v[8:11]
    s_add_u32 m0, s68, 81920
    ds_read_b64_tr_b16 a[214:215], v198 offset:37376
    v_mfma_f32_16x16x32_bf16 v[8:11], a[196:199], a[92:95], v[8:11]
    s_waitcnt lgkmcnt(4)
    s_xor_b32 s74, s38, 0
    buffer_load_dwordx4 v252, s[12:15], s74 offen offset:0 nt lds
    v_mfma_f32_16x16x32_bf16 v[12:15], a[200:203], a[72:75], v[12:15]
    ds_read_b64_tr_b16 a[192:193], v199 offset:32768
    ds_read_b64_tr_b16 a[194:195], v199 offset:33280
    v_mfma_f32_16x16x32_bf16 v[12:15], a[204:207], a[84:87], v[12:15]
    buffer_load_dwordx4 v253, s[12:15], s74 offen offset:1024 nt lds
    v_mfma_f32_16x16x32_bf16 v[16:19], a[200:203], a[76:79], v[16:19]
    ds_read_b64_tr_b16 a[196:197], v199 offset:36864
    ds_read_b64_tr_b16 a[198:199], v199 offset:37376
    v_mfma_f32_16x16x32_bf16 v[16:19], a[204:207], a[88:91], v[16:19]
    buffer_load_dwordx4 v254, s[12:15], s74 offen offset:2048 nt lds
    v_mfma_f32_16x16x32_bf16 v[20:23], a[200:203], a[80:83], v[20:23]
    v_mfma_f32_16x16x32_bf16 v[20:23], a[204:207], a[92:95], v[20:23]
    s_waitcnt lgkmcnt(4)
    buffer_load_dwordx4 v255, s[12:15], s74 offen offset:3072 nt lds
    v_mfma_f32_16x16x32_bf16 v[24:27], a[208:211], a[72:75], v[24:27]
    s_add_u32 m0, s68, 114688
    v_mfma_f32_16x16x32_bf16 v[24:27], a[212:215], a[84:87], v[24:27]
    s_waitcnt vmcnt(15) lgkmcnt(0)
    v_mfma_f32_16x16x32_bf16 v[28:31], a[208:211], a[76:79], v[28:31]
    s_barrier
    ds_read_b64_tr_b16 a[200:201], v196 offset:16384
    ds_read_b64_tr_b16 a[202:203], v196 offset:16896
    v_mfma_f32_16x16x32_bf16 v[28:31], a[212:215], a[88:91], v[28:31]
    s_xor_b32 s73, s71, 2621568
    ds_read_b64_tr_b16 a[204:205], v196 offset:20480
    v_mfma_f32_16x16x32_bf16 v[32:35], a[208:211], a[80:83], v[32:35]
    buffer_load_dwordx4 v204, s[16:19], s73 offen offset:0 lds
    v_mfma_f32_16x16x32_bf16 v[32:35], a[212:215], a[92:95], v[32:35]
    ds_read_b64_tr_b16 a[206:207], v196 offset:20992
    ds_read_b128 a[96:99], v202 offset:8192
    v_mfma_f32_16x16x32_bf16 v[36:39], a[192:195], a[72:75], v[36:39]
    ds_read_b64_tr_b16 a[208:209], v197 offset:16384
    v_mfma_f32_16x16x32_bf16 v[36:39], a[196:199], a[84:87], v[36:39]
    ds_read_b64_tr_b16 a[210:211], v197 offset:16896
    ds_read_b128 a[108:111], v203 offset:8192
    v_mfma_f32_16x16x32_bf16 v[40:43], a[192:195], a[76:79], v[40:43]
    buffer_load_dwordx4 v205, s[16:19], s73 offen offset:1024 lds
    v_mfma_f32_16x16x32_bf16 v[40:43], a[196:199], a[88:91], v[40:43]
    ds_read_b64_tr_b16 a[212:213], v197 offset:20480
    v_mfma_f32_16x16x32_bf16 v[44:47], a[192:195], a[80:83], v[44:47]
    ds_read_b64_tr_b16 a[214:215], v197 offset:20992
    ds_read_b128 a[100:103], v202 offset:10240
    v_mfma_f32_16x16x32_bf16 v[44:47], a[196:199], a[92:95], v[44:47]
    s_waitcnt lgkmcnt(7)
    v_mfma_f32_16x16x32_bf16 v[48:51], a[200:203], a[72:75], v[48:51]
    buffer_load_dwordx4 v206, s[16:19], s73 offen offset:2048 lds
    v_mfma_f32_16x16x32_bf16 v[48:51], a[204:207], a[84:87], v[48:51]
    ds_read_b64_tr_b16 a[192:193], v198 offset:16384
    ds_read_b128 a[112:115], v203 offset:10240
    v_mfma_f32_16x16x32_bf16 v[52:55], a[200:203], a[76:79], v[52:55]
    ds_read_b64_tr_b16 a[194:195], v198 offset:16896
    v_mfma_f32_16x16x32_bf16 v[52:55], a[204:207], a[88:91], v[52:55]
    ds_read_b64_tr_b16 a[196:197], v198 offset:20480
    v_mfma_f32_16x16x32_bf16 v[56:59], a[200:203], a[80:83], v[56:59]
    ds_read_b64_tr_b16 a[198:199], v198 offset:20992
    ds_read_b128 a[104:107], v202 offset:12288
    v_mfma_f32_16x16x32_bf16 v[56:59], a[204:207], a[92:95], v[56:59]
    s_waitcnt lgkmcnt(7)
    buffer_load_dwordx4 v207, s[16:19], s73 offen offset:3072 lds
    v_mfma_f32_16x16x32_bf16 v[60:63], a[208:211], a[72:75], v[60:63]
    s_add_u32 m0, s69, 8192
    ds_read_b64_tr_b16 a[200:201], v199 offset:16384
    ds_read_b64_tr_b16 a[202:203], v199 offset:16896
    v_mfma_f32_16x16x32_bf16 v[60:63], a[212:215], a[84:87], v[60:63]
    s_xor_b32 s37, s36, 768
    ds_read_b64_tr_b16 a[204:205], v199 offset:20480
    ds_read_b128 a[116:119], v203 offset:12288
    v_mfma_f32_16x16x32_bf16 v[64:67], a[208:211], a[76:79], v[64:67]
    ds_read_b64_tr_b16 a[206:207], v199 offset:20992
    v_mfma_f32_16x16x32_bf16 v[64:67], a[212:215], a[88:91], v[64:67]
    buffer_load_dwordx4 v208, s[4:7], s37 offen offset:0 lds
    v_mfma_f32_16x16x32_bf16 v[68:71], a[208:211], a[80:83], v[68:71]
    v_mfma_f32_16x16x32_bf16 v[68:71], a[212:215], a[92:95], v[68:71]
    s_waitcnt lgkmcnt(6)
    v_mfma_f32_16x16x32_bf16 v[72:75], a[192:195], a[72:75], v[72:75]
    s_add_u32 m0, s68, 98304
    v_mfma_f32_16x16x32_bf16 v[72:75], a[196:199], a[84:87], v[72:75]
    s_waitcnt lgkmcnt(0)
    v_mfma_f32_16x16x32_bf16 v[76:79], a[192:195], a[76:79], v[76:79]
    s_barrier
    ds_read_b64_tr_b16 a[208:209], v192 offset:24576
    ds_read_b64_tr_b16 a[210:211], v192 offset:25088
    v_mfma_f32_16x16x32_bf16 v[76:79], a[196:199], a[88:91], v[76:79]
    s_xor_b32 s73, s71, 3145728
    ds_read_b64_tr_b16 a[212:213], v192 offset:28672
    v_mfma_f32_16x16x32_bf16 v[80:83], a[192:195], a[80:83], v[80:83]
    buffer_load_dwordx4 v204, s[16:19], s73 offen offset:0 lds
    v_mfma_f32_16x16x32_bf16 v[80:83], a[196:199], a[92:95], v[80:83]
    ds_read_b64_tr_b16 a[214:215], v192 offset:29184
    v_mfma_f32_16x16x32_bf16 v[84:87], a[200:203], a[72:75], v[84:87]
    ds_read_b64_tr_b16 a[192:193], v193 offset:24576
    v_mfma_f32_16x16x32_bf16 v[84:87], a[204:207], a[84:87], v[84:87]
    ds_read_b64_tr_b16 a[194:195], v193 offset:25088
    v_mfma_f32_16x16x32_bf16 v[88:91], a[200:203], a[76:79], v[88:91]
    buffer_load_dwordx4 v205, s[16:19], s73 offen offset:1024 lds
    v_mfma_f32_16x16x32_bf16 v[88:91], a[204:207], a[88:91], v[88:91]
    ds_read_b64_tr_b16 a[196:197], v193 offset:28672
    v_mfma_f32_16x16x32_bf16 v[92:95], a[200:203], a[80:83], v[92:95]
    ds_read_b64_tr_b16 a[198:199], v193 offset:29184
    v_mfma_f32_16x16x32_bf16 v[92:95], a[204:207], a[92:95], v[92:95]
    s_waitcnt lgkmcnt(4)
    buffer_load_dwordx4 v206, s[16:19], s73 offen offset:2048 lds
    v_mfma_f32_16x16x32_bf16 v[0:3], a[208:211], a[96:99], v[0:3]
    ds_read_b64_tr_b16 a[200:201], v194 offset:24576
    v_mfma_f32_16x16x32_bf16 v[0:3], a[212:215], a[108:111], v[0:3]
    ds_read_b64_tr_b16 a[202:203], v194 offset:25088
    v_mfma_f32_16x16x32_bf16 v[4:7], a[208:211], a[100:103], v[4:7]
    ds_read_b64_tr_b16 a[204:205], v194 offset:28672
    v_mfma_f32_16x16x32_bf16 v[4:7], a[212:215], a[112:115], v[4:7]
    buffer_load_dwordx4 v207, s[16:19], s73 offen offset:3072 lds
    v_mfma_f32_16x16x32_bf16 v[8:11], a[208:211], a[104:107], v[8:11]
    s_add_u32 m0, s69, 8192
    ds_read_b64_tr_b16 a[206:207], v194 offset:29184
    v_mfma_f32_16x16x32_bf16 v[8:11], a[212:215], a[116:119], v[8:11]
    s_waitcnt lgkmcnt(4)
    v_mfma_f32_16x16x32_bf16 v[12:15], a[192:195], a[96:99], v[12:15]
    s_xor_b32 s37, s36, 768
    buffer_load_dwordx4 v209, s[4:7], s37 offen offset:1024 lds
    v_mfma_f32_16x16x32_bf16 v[12:15], a[196:199], a[108:111], v[12:15]
    ds_read_b64_tr_b16 a[208:209], v195 offset:24576
    ds_read_b64_tr_b16 a[210:211], v195 offset:25088
    v_mfma_f32_16x16x32_bf16 v[16:19], a[192:195], a[100:103], v[16:19]
    ds_read_b64_tr_b16 a[212:213], v195 offset:28672
    v_mfma_f32_16x16x32_bf16 v[16:19], a[196:199], a[112:115], v[16:19]
    ds_read_b64_tr_b16 a[214:215], v195 offset:29184
    v_mfma_f32_16x16x32_bf16 v[20:23], a[192:195], a[104:107], v[20:23]
    buffer_load_dwordx4 v210, s[4:7], s37 offen offset:2048 lds
    v_mfma_f32_16x16x32_bf16 v[20:23], a[196:199], a[116:119], v[20:23]
    s_waitcnt lgkmcnt(4)
    v_mfma_f32_16x16x32_bf16 v[24:27], a[200:203], a[96:99], v[24:27]
    s_add_u32 m0, s68, 24576
    v_mfma_f32_16x16x32_bf16 v[24:27], a[204:207], a[108:111], v[24:27]
    s_waitcnt vmcnt(15) lgkmcnt(0)
    v_mfma_f32_16x16x32_bf16 v[28:31], a[200:203], a[100:103], v[28:31]
    s_barrier
    ds_read_b64_tr_b16 a[192:193], v196 offset:24576
    ds_read_b64_tr_b16 a[194:195], v196 offset:25088
    v_mfma_f32_16x16x32_bf16 v[28:31], a[204:207], a[112:115], v[28:31]
    s_xor_b32 s73, s71, 3145856
    ds_read_b64_tr_b16 a[196:197], v196 offset:28672
    v_mfma_f32_16x16x32_bf16 v[32:35], a[200:203], a[104:107], v[32:35]
    buffer_load_dwordx4 v204, s[16:19], s73 offen offset:0 lds
    v_mfma_f32_16x16x32_bf16 v[32:35], a[204:207], a[116:119], v[32:35]
    ds_read_b64_tr_b16 a[198:199], v196 offset:29184
    ds_read_b128 a[120:123], v200 offset:16384
    v_mfma_f32_16x16x32_bf16 v[36:39], a[208:211], a[96:99], v[36:39]
    ds_read_b64_tr_b16 a[200:201], v197 offset:24576
    v_mfma_f32_16x16x32_bf16 v[36:39], a[212:215], a[108:111], v[36:39]
    ds_read_b64_tr_b16 a[202:203], v197 offset:25088
    ds_read_b128 a[132:135], v201 offset:16384
    v_mfma_f32_16x16x32_bf16 v[40:43], a[208:211], a[100:103], v[40:43]
    buffer_load_dwordx4 v205, s[16:19], s73 offen offset:1024 lds
    v_mfma_f32_16x16x32_bf16 v[40:43], a[212:215], a[112:115], v[40:43]
    ds_read_b64_tr_b16 a[204:205], v197 offset:28672
    v_mfma_f32_16x16x32_bf16 v[44:47], a[208:211], a[104:107], v[44:47]
    ds_read_b64_tr_b16 a[206:207], v197 offset:29184
    ds_read_b128 a[124:127], v200 offset:18432
    v_mfma_f32_16x16x32_bf16 v[44:47], a[212:215], a[116:119], v[44:47]
    s_waitcnt lgkmcnt(7)
    v_mfma_f32_16x16x32_bf16 v[48:51], a[192:195], a[96:99], v[48:51]
    buffer_load_dwordx4 v206, s[16:19], s73 offen offset:2048 lds
    v_mfma_f32_16x16x32_bf16 v[48:51], a[196:199], a[108:111], v[48:51]
    ds_read_b64_tr_b16 a[208:209], v198 offset:24576
    ds_read_b128 a[136:139], v201 offset:18432
    v_mfma_f32_16x16x32_bf16 v[52:55], a[192:195], a[100:103], v[52:55]
    ds_read_b64_tr_b16 a[210:211], v198 offset:25088
    v_mfma_f32_16x16x32_bf16 v[52:55], a[196:199], a[112:115], v[52:55]
    ds_read_b64_tr_b16 a[212:213], v198 offset:28672
    v_mfma_f32_16x16x32_bf16 v[56:59], a[192:195], a[104:107], v[56:59]
    ds_read_b64_tr_b16 a[214:215], v198 offset:29184
    ds_read_b128 a[128:131], v200 offset:20480
    v_mfma_f32_16x16x32_bf16 v[56:59], a[196:199], a[116:119], v[56:59]
    s_waitcnt lgkmcnt(7)
    buffer_load_dwordx4 v207, s[16:19], s73 offen offset:3072 lds
    v_mfma_f32_16x16x32_bf16 v[60:63], a[200:203], a[96:99], v[60:63]
    s_add_u32 m0, s69, 90112
    ds_read_b64_tr_b16 a[192:193], v199 offset:24576
    ds_read_b64_tr_b16 a[194:195], v199 offset:25088
    v_mfma_f32_16x16x32_bf16 v[60:63], a[204:207], a[108:111], v[60:63]
    s_xor_b32 s37, s36, 896
    ds_read_b64_tr_b16 a[196:197], v199 offset:28672
    ds_read_b128 a[140:143], v201 offset:20480
    v_mfma_f32_16x16x32_bf16 v[64:67], a[200:203], a[100:103], v[64:67]
    ds_read_b64_tr_b16 a[198:199], v199 offset:29184
    v_mfma_f32_16x16x32_bf16 v[64:67], a[204:207], a[112:115], v[64:67]
    buffer_load_dwordx4 v208, s[4:7], s37 offen offset:0 lds
    v_mfma_f32_16x16x32_bf16 v[68:71], a[200:203], a[104:107], v[68:71]
    v_mfma_f32_16x16x32_bf16 v[68:71], a[204:207], a[116:119], v[68:71]
    s_waitcnt lgkmcnt(6)
    v_mfma_f32_16x16x32_bf16 v[72:75], a[208:211], a[96:99], v[72:75]
    s_add_u32 m0, s68, 106496
    v_mfma_f32_16x16x32_bf16 v[72:75], a[212:215], a[108:111], v[72:75]
    s_waitcnt lgkmcnt(0)
    v_mfma_f32_16x16x32_bf16 v[76:79], a[208:211], a[100:103], v[76:79]
    s_barrier
    ds_read_b64_tr_b16 a[200:201], v192 offset:32768
    ds_read_b64_tr_b16 a[202:203], v192 offset:33280
    v_mfma_f32_16x16x32_bf16 v[76:79], a[212:215], a[112:115], v[76:79]
    s_xor_b32 s73, s71, 3670016
    ds_read_b64_tr_b16 a[204:205], v192 offset:36864
    v_mfma_f32_16x16x32_bf16 v[80:83], a[208:211], a[104:107], v[80:83]
    buffer_load_dwordx4 v204, s[16:19], s73 offen offset:0 lds
    v_mfma_f32_16x16x32_bf16 v[80:83], a[212:215], a[116:119], v[80:83]
    ds_read_b64_tr_b16 a[206:207], v192 offset:37376
    v_mfma_f32_16x16x32_bf16 v[84:87], a[192:195], a[96:99], v[84:87]
    buffer_load_dwordx4 v205, s[16:19], s73 offen offset:1024 lds
    v_mfma_f32_16x16x32_bf16 v[84:87], a[196:199], a[108:111], v[84:87]
    ds_read_b64_tr_b16 a[208:209], v193 offset:32768
    ds_read_b64_tr_b16 a[210:211], v193 offset:33280
    v_mfma_f32_16x16x32_bf16 v[88:91], a[192:195], a[100:103], v[88:91]
    buffer_load_dwordx4 v206, s[16:19], s73 offen offset:2048 lds
    v_mfma_f32_16x16x32_bf16 v[88:91], a[196:199], a[112:115], v[88:91]
    ds_read_b64_tr_b16 a[212:213], v193 offset:36864
    ds_read_b64_tr_b16 a[214:215], v193 offset:37376
    v_mfma_f32_16x16x32_bf16 v[92:95], a[192:195], a[104:107], v[92:95]
    buffer_load_dwordx4 v207, s[16:19], s73 offen offset:3072 lds
    v_mfma_f32_16x16x32_bf16 v[92:95], a[196:199], a[116:119], v[92:95]
    s_waitcnt lgkmcnt(4)
    s_add_u32 m0, s69, 90112
    v_mfma_f32_16x16x32_bf16 v[0:3], a[200:203], a[120:123], v[0:3]
    s_xor_b32 s37, s36, 896
    buffer_load_dwordx4 v209, s[4:7], s37 offen offset:1024 lds
    v_mfma_f32_16x16x32_bf16 v[0:3], a[204:207], a[132:135], v[0:3]
    ds_read_b64_tr_b16 a[192:193], v194 offset:32768
    ds_read_b64_tr_b16 a[194:195], v194 offset:33280
    v_mfma_f32_16x16x32_bf16 v[4:7], a[200:203], a[124:127], v[4:7]
    ds_read_b64_tr_b16 a[196:197], v194 offset:36864
    v_accvgpr_write_b32 a248, -1
    v_mfma_f32_16x16x32_bf16 v[4:7], a[204:207], a[136:139], v[4:7]
    buffer_load_dwordx4 v210, s[4:7], s37 offen offset:2048 lds
    v_mfma_f32_16x16x32_bf16 v[8:11], a[200:203], a[128:131], v[8:11]
    s_xor_b32 s74, s38, 40960
    ds_read_b64_tr_b16 a[198:199], v194 offset:37376
    v_accvgpr_write_b32 a249, -1
    v_mfma_f32_16x16x32_bf16 v[8:11], a[204:207], a[140:143], v[8:11]
    s_waitcnt lgkmcnt(4)
    buffer_load_dwordx4 a[216:219], v252, s[8:11], s74 offen offset:0 nt
    v_mfma_f32_16x16x32_bf16 v[12:15], a[208:211], a[120:123], v[12:15]
    ds_read_b64_tr_b16 a[200:201], v195 offset:32768
    ds_read_b64_tr_b16 a[202:203], v195 offset:33280
    v_mfma_f32_16x16x32_bf16 v[12:15], a[212:215], a[132:135], v[12:15]
    buffer_load_dwordx4 a[220:223], v253, s[8:11], s74 offen offset:1024 nt
    v_mfma_f32_16x16x32_bf16 v[16:19], a[208:211], a[124:127], v[16:19]
    ds_read_b64_tr_b16 a[204:205], v195 offset:36864
    ds_read_b64_tr_b16 a[206:207], v195 offset:37376
    v_mfma_f32_16x16x32_bf16 v[16:19], a[212:215], a[136:139], v[16:19]
    buffer_load_dwordx4 a[224:227], v254, s[8:11], s74 offen offset:2048 nt
    v_mfma_f32_16x16x32_bf16 v[20:23], a[208:211], a[128:131], v[20:23]
    v_accvgpr_write_b32 a250, -1
    v_accvgpr_write_b32 a251, -1
    v_mfma_f32_16x16x32_bf16 v[20:23], a[212:215], a[140:143], v[20:23]
    s_waitcnt lgkmcnt(4)
    buffer_load_dwordx4 a[228:231], v255, s[8:11], s74 offen offset:3072 nt
    v_mfma_f32_16x16x32_bf16 v[24:27], a[192:195], a[120:123], v[24:27]
    v_mfma_f32_16x16x32_bf16 v[24:27], a[196:199], a[132:135], v[24:27]
    s_waitcnt vmcnt(15) lgkmcnt(0)
    v_mfma_f32_16x16x32_bf16 v[28:31], a[192:195], a[124:127], v[28:31]
    s_barrier
    ds_read_b64_tr_b16 a[208:209], v196 offset:32768
    ds_read_b64_tr_b16 a[210:211], v196 offset:33280
    v_mfma_f32_16x16x32_bf16 v[28:31], a[196:199], a[136:139], v[28:31]
    s_add_u32 m0, s68, 32768
    ds_read_b64_tr_b16 a[212:213], v196 offset:36864
    v_mfma_f32_16x16x32_bf16 v[32:35], a[192:195], a[128:131], v[32:35]
    s_xor_b32 s73, s71, 3670144
    ds_read_b64_tr_b16 a[214:215], v196 offset:37376
    ds_read_b128 a[144:147], v200 offset:8192
    v_mfma_f32_16x16x32_bf16 v[32:35], a[196:199], a[140:143], v[32:35]
    buffer_load_dwordx4 v204, s[16:19], s73 offen offset:0 lds
    v_mfma_f32_16x16x32_bf16 v[36:39], a[200:203], a[120:123], v[36:39]
    ds_read_b64_tr_b16 a[192:193], v197 offset:32768
    v_mfma_f32_16x16x32_bf16 v[36:39], a[204:207], a[132:135], v[36:39]
    ds_read_b64_tr_b16 a[194:195], v197 offset:33280
    ds_read_b128 a[156:159], v201 offset:8192
    v_mfma_f32_16x16x32_bf16 v[40:43], a[200:203], a[124:127], v[40:43]
    ds_read_b64_tr_b16 a[196:197], v197 offset:36864
    v_mfma_f32_16x16x32_bf16 v[40:43], a[204:207], a[136:139], v[40:43]
    ds_read_b64_tr_b16 a[198:199], v197 offset:37376
    v_mfma_f32_16x16x32_bf16 v[44:47], a[200:203], a[128:131], v[44:47]
    ds_read_b128 a[148:151], v200 offset:10240
    v_mfma_f32_16x16x32_bf16 v[44:47], a[204:207], a[140:143], v[44:47]
    s_waitcnt lgkmcnt(7)
    buffer_load_dwordx4 v205, s[16:19], s73 offen offset:1024 lds
    v_mfma_f32_16x16x32_bf16 v[48:51], a[208:211], a[120:123], v[48:51]
    s_mul_i32 s70, s62, 81920
    ds_read_b64_tr_b16 a[200:201], v198 offset:32768
    v_mfma_f32_16x16x32_bf16 v[48:51], a[212:215], a[132:135], v[48:51]
    s_lshl_b32 s82, s63, 12
    ds_read_b64_tr_b16 a[202:203], v198 offset:33280
    ds_read_b128 a[160:163], v201 offset:10240
    v_mfma_f32_16x16x32_bf16 v[52:55], a[208:211], a[124:127], v[52:55]
    s_add_u32 s70, s70, s82
    ds_read_b64_tr_b16 a[204:205], v198 offset:36864
    v_mfma_f32_16x16x32_bf16 v[52:55], a[212:215], a[136:139], v[52:55]
    s_lshr_b32 s48, s64, 1
    ds_read_b64_tr_b16 a[206:207], v198 offset:37376
    v_mfma_f32_16x16x32_bf16 v[56:59], a[208:211], a[128:131], v[56:59]
    s_lshr_b32 s82, s65, 2
    ds_read_b128 a[152:155], v200 offset:12288
    v_mfma_f32_16x16x32_bf16 v[56:59], a[212:215], a[140:143], v[56:59]
    s_waitcnt lgkmcnt(7)
    buffer_load_dwordx4 v206, s[16:19], s73 offen offset:2048 lds
    v_mfma_f32_16x16x32_bf16 v[60:63], a[192:195], a[120:123], v[60:63]
    s_xor_b32 s48, s48, s82
    ds_read_b64_tr_b16 a[208:209], v199 offset:32768
    v_mfma_f32_16x16x32_bf16 v[60:63], a[196:199], a[132:135], v[60:63]
    s_lshl2_add_u32 s82, s62, s67
    ds_read_b64_tr_b16 a[210:211], v199 offset:33280
    ds_read_b128 a[164:167], v201 offset:12288
    v_mfma_f32_16x16x32_bf16 v[64:67], a[192:195], a[124:127], v[64:67]
    s_lshl_b32 s82, s82, 16
    ds_read_b64_tr_b16 a[212:213], v199 offset:36864
    v_mfma_f32_16x16x32_bf16 v[64:67], a[196:199], a[136:139], v[64:67]
    s_lshl2_add_u32 s72, s62, s48
    ds_read_b64_tr_b16 a[214:215], v199 offset:37376
    v_mfma_f32_16x16x32_bf16 v[68:71], a[192:195], a[128:131], v[68:71]
    s_lshl_b32 s72, s72, 7
    v_mfma_f32_16x16x32_bf16 v[68:71], a[196:199], a[140:143], v[68:71]
    s_waitcnt lgkmcnt(6)
    buffer_load_dwordx4 v207, s[16:19], s73 offen offset:3072 lds
    v_mfma_f32_16x16x32_bf16 v[72:75], a[200:203], a[120:123], v[72:75]
    s_or_b32 s72, s72, s82
    v_mfma_f32_16x16x32_bf16 v[72:75], a[204:207], a[132:135], v[72:75]
    s_waitcnt lgkmcnt(0)
    v_mfma_f32_16x16x32_bf16 v[76:79], a[200:203], a[124:127], v[76:79]
    s_barrier
    ds_read_b64_tr_b16 a[192:193], v196 offset:16384
    ds_read_b64_tr_b16 a[194:195], v196 offset:16896
    v_mfma_f32_16x16x32_bf16 v[76:79], a[204:207], a[136:139], v[76:79]
    s_add_u32 m0, s68, 114688
    ds_read_b64_tr_b16 a[196:197], v196 offset:20480
    v_mfma_f32_16x16x32_bf16 v[80:83], a[200:203], a[128:131], v[80:83]
    s_xor_b32 s73, s71, 256
    ds_read_b64_tr_b16 a[198:199], v196 offset:20992
    v_mfma_f32_16x16x32_bf16 v[80:83], a[204:207], a[140:143], v[80:83]
    s_and_b32 s83, s64, 1
    buffer_load_dwordx4 v204, s[16:19], s73 offen offset:0 lds
    v_mfma_f32_16x16x32_bf16 v[84:87], a[208:211], a[120:123], v[84:87]
    s_lshl2_add_u32 s48, s83, s48
    ds_read_b64_tr_b16 a[200:201], v197 offset:16384
    v_mfma_f32_16x16x32_bf16 v[84:87], a[212:215], a[132:135], v[84:87]
    s_xor_b32 s52, s48, 3
    ds_read_b64_tr_b16 a[202:203], v197 offset:16896
    v_mfma_f32_16x16x32_bf16 v[88:91], a[208:211], a[124:127], v[88:91]
    s_lshl_b32 s52, s52, 7
    ds_read_b64_tr_b16 a[204:205], v197 offset:20480
    v_mfma_f32_16x16x32_bf16 v[88:91], a[212:215], a[136:139], v[88:91]
    s_or_b32 s49, s52, s82
    ds_read_b64_tr_b16 a[206:207], v197 offset:20992
    v_mfma_f32_16x16x32_bf16 v[92:95], a[208:211], a[128:131], v[92:95]
    s_lshl4_add_u32 s53, s66, s65
    v_mfma_f32_16x16x32_bf16 v[92:95], a[212:215], a[140:143], v[92:95]
    s_waitcnt lgkmcnt(4)
    buffer_load_dwordx4 v205, s[16:19], s73 offen offset:1024 lds
    v_mfma_f32_16x16x32_bf16 v[0:3], a[192:195], a[144:147], v[0:3]
    s_lshl_b32 s53, s53, 3
    ds_read_b64_tr_b16 a[208:209], v198 offset:16384
    v_mfma_f32_16x16x32_bf16 v[0:3], a[196:199], a[156:159], v[0:3]
    s_mul_i32 s82, s53, 1
    ds_read_b64_tr_b16 a[210:211], v198 offset:16896
    v_mfma_f32_16x16x32_bf16 v[4:7], a[192:195], a[148:151], v[4:7]
    s_add_u32 s82, s82, s48
    ds_read_b64_tr_b16 a[212:213], v198 offset:20480
    v_mfma_f32_16x16x32_bf16 v[4:7], a[196:199], a[160:163], v[4:7]
    s_lshl2_add_u32 s76, s82, s3
    ds_read_b64_tr_b16 a[214:215], v198 offset:20992
    v_mfma_f32_16x16x32_bf16 v[8:11], a[192:195], a[152:155], v[8:11]
    s_lshl_b32 s76, s76, 10
    v_mfma_f32_16x16x32_bf16 v[8:11], a[196:199], a[164:167], v[8:11]
    s_waitcnt lgkmcnt(4)
    buffer_load_dwordx4 v206, s[16:19], s73 offen offset:2048 lds
    v_mfma_f32_16x16x32_bf16 v[12:15], a[200:203], a[144:147], v[12:15]
    s_xor_b32 s51, s76, 0x4000
    ds_read_b64_tr_b16 a[192:193], v199 offset:16384
    v_mfma_f32_16x16x32_bf16 v[12:15], a[204:207], a[156:159], v[12:15]
    s_lshl1_add_u32 s83, s83, s62
    ds_read_b64_tr_b16 a[194:195], v199 offset:16896
    v_mfma_f32_16x16x32_bf16 v[16:19], a[200:203], a[148:151], v[16:19]
L_hopa_1:
    s_cbranch_execz L_backa
    s_lshl2_add_u32 s50, s82, s83
    ds_read_b64_tr_b16 a[196:197], v199 offset:20480
    v_mfma_f32_16x16x32_bf16 v[16:19], a[204:207], a[160:163], v[16:19]
    s_lshl_b32 s50, s50, 10
    ds_read_b64_tr_b16 a[198:199], v199 offset:20992
    v_mfma_f32_16x16x32_bf16 v[20:23], a[200:203], a[152:155], v[20:23]
    s_xor_b32 s35, s76, 28311552
    v_mfma_f32_16x16x32_bf16 v[20:23], a[204:207], a[164:167], v[20:23]
    s_waitcnt lgkmcnt(4)
    buffer_load_dwordx4 v207, s[16:19], s73 offen offset:3072 lds
    v_mfma_f32_16x16x32_bf16 v[24:27], a[208:211], a[144:147], v[24:27]
    s_lshl_b32 s82, s63, 22
    v_mfma_f32_16x16x32_bf16 v[24:27], a[212:215], a[156:159], v[24:27]
    s_waitcnt vmcnt(12) lgkmcnt(0)
    v_mfma_f32_16x16x32_bf16 v[28:31], a[208:211], a[148:151], v[28:31]
    s_barrier
    ds_read_b64_tr_b16 a[200:201], v192 offset:24576
    ds_read_b64_tr_b16 a[202:203], v192 offset:25088
    v_mfma_f32_16x16x32_bf16 v[28:31], a[212:215], a[160:163], v[28:31]
    s_add_u32 m0, s68, 98304
    ds_read_b64_tr_b16 a[204:205], v192 offset:28672
    v_mfma_f32_16x16x32_bf16 v[32:35], a[208:211], a[152:155], v[32:35]
    s_xor_b32 s73, s71, 524544
    ds_read_b64_tr_b16 a[206:207], v192 offset:29184
    ds_read_b128 a[168:171], v202 offset:8192
    v_mfma_f32_16x16x32_bf16 v[32:35], a[212:215], a[164:167], v[32:35]
    s_xor_b32 s50, s50, s82
    buffer_load_dwordx4 v204, s[16:19], s73 offen offset:0 lds
    v_mfma_f32_16x16x32_bf16 v[36:39], a[192:195], a[144:147], v[36:39]
    s_lshl1_add_u32 s82, s65, s62
    ds_read_b64_tr_b16 a[208:209], v193 offset:24576
    v_mfma_f32_16x16x32_bf16 v[36:39], a[196:199], a[156:159], v[36:39]
    s_mul_i32 s82, s82, 98304
    ds_read_b64_tr_b16 a[210:211], v193 offset:25088
    ds_read_b128 a[180:183], v203 offset:8192
    v_mfma_f32_16x16x32_bf16 v[40:43], a[192:195], a[148:151], v[40:43]
    s_add_u32 s52, s52, s82
    ds_read_b64_tr_b16 a[212:213], v193 offset:28672
    v_mfma_f32_16x16x32_bf16 v[40:43], a[196:199], a[160:163], v[40:43]
    s_lshl4_add_u32 s82, s66, s63
    ds_read_b64_tr_b16 a[214:215], v193 offset:29184
    v_mfma_f32_16x16x32_bf16 v[44:47], a[192:195], a[152:155], v[44:47]
    s_lshl_b32 s82, s82, 6
    ds_read_b128 a[172:175], v202 offset:10240
    v_mfma_f32_16x16x32_bf16 v[44:47], a[196:199], a[164:167], v[44:47]
    s_waitcnt lgkmcnt(7)
    buffer_load_dwordx4 v205, s[16:19], s73 offen offset:1024 lds
    v_mfma_f32_16x16x32_bf16 v[48:51], a[200:203], a[144:147], v[48:51]
    s_add_u32 s52, s52, s82
    ds_read_b64_tr_b16 a[192:193], v194 offset:24576
    v_mfma_f32_16x16x32_bf16 v[48:51], a[204:207], a[156:159], v[48:51]
    s_mov_b32 s24, s60
    ds_read_b64_tr_b16 a[194:195], v194 offset:25088
    ds_read_b128 a[184:187], v203 offset:10240
    v_mfma_f32_16x16x32_bf16 v[52:55], a[200:203], a[148:151], v[52:55]
    s_mov_b32 s25, s61
    ds_read_b64_tr_b16 a[196:197], v194 offset:28672
    v_mfma_f32_16x16x32_bf16 v[52:55], a[204:207], a[160:163], v[52:55]
    s_mov_b32 s26, 33554432
    ds_read_b64_tr_b16 a[198:199], v194 offset:29184
    v_mfma_f32_16x16x32_bf16 v[56:59], a[200:203], a[152:155], v[56:59]
    s_mov_b32 s27, 0x20000
    ds_read_b128 a[176:179], v202 offset:12288
    v_mfma_f32_16x16x32_bf16 v[56:59], a[204:207], a[164:167], v[56:59]
    s_waitcnt lgkmcnt(7)
    buffer_load_dwordx4 v206, s[16:19], s73 offen offset:2048 lds
    v_mfma_f32_16x16x32_bf16 v[60:63], a[208:211], a[144:147], v[60:63]
    s_mov_b32 s28, s56
    ds_read_b64_tr_b16 a[200:201], v195 offset:24576
    v_mfma_f32_16x16x32_bf16 v[60:63], a[212:215], a[156:159], v[60:63]
    s_mov_b32 s29, s57
    ds_read_b64_tr_b16 a[202:203], v195 offset:25088
    ds_read_b128 a[188:191], v203 offset:12288
    v_mfma_f32_16x16x32_bf16 v[64:67], a[208:211], a[148:151], v[64:67]
    s_mov_b32 s30, 3145728
    ds_read_b64_tr_b16 a[204:205], v195 offset:28672
    v_mfma_f32_16x16x32_bf16 v[64:67], a[212:215], a[160:163], v[64:67]
    s_mov_b32 s31, 0x20000
    ds_read_b64_tr_b16 a[206:207], v195 offset:29184
    v_mfma_f32_16x16x32_bf16 v[68:71], a[208:211], a[152:155], v[68:71]
    v_mfma_f32_16x16x32_bf16 v[68:71], a[212:215], a[164:167], v[68:71]
    s_waitcnt lgkmcnt(6)
    buffer_load_dwordx4 v207, s[16:19], s73 offen offset:3072 lds
    v_mfma_f32_16x16x32_bf16 v[72:75], a[192:195], a[144:147], v[72:75]
    s_add_u32 m0, s68, 24576
    v_mfma_f32_16x16x32_bf16 v[72:75], a[196:199], a[156:159], v[72:75]
    s_waitcnt lgkmcnt(0)
    v_mfma_f32_16x16x32_bf16 v[76:79], a[192:195], a[148:151], v[76:79]
    s_barrier
    ds_read_b64_tr_b16 a[208:209], v196 offset:24576
    ds_read_b64_tr_b16 a[210:211], v196 offset:25088
    v_mfma_f32_16x16x32_bf16 v[76:79], a[196:199], a[160:163], v[76:79]
    s_xor_b32 s73, s71, 1048832
    ds_read_b64_tr_b16 a[212:213], v196 offset:28672
    v_mfma_f32_16x16x32_bf16 v[80:83], a[192:195], a[152:155], v[80:83]
    buffer_load_dwordx4 v204, s[16:19], s73 offen offset:0 lds
    v_mfma_f32_16x16x32_bf16 v[80:83], a[196:199], a[164:167], v[80:83]
    ds_read_b64_tr_b16 a[214:215], v196 offset:29184
    v_mfma_f32_16x16x32_bf16 v[84:87], a[200:203], a[144:147], v[84:87]
    ds_read_b64_tr_b16 a[192:193], v197 offset:24576
    ds_read_b64_tr_b16 a[194:195], v197 offset:25088
    v_mfma_f32_16x16x32_bf16 v[84:87], a[204:207], a[156:159], v[84:87]
    buffer_load_dwordx4 v205, s[16:19], s73 offen offset:1024 lds
    v_mfma_f32_16x16x32_bf16 v[88:91], a[200:203], a[148:151], v[88:91]
    ds_read_b64_tr_b16 a[196:197], v197 offset:28672
    v_mfma_f32_16x16x32_bf16 v[88:91], a[204:207], a[160:163], v[88:91]
    buffer_load_dwordx4 v206, s[16:19], s73 offen offset:2048 lds
    v_mfma_f32_16x16x32_bf16 v[92:95], a[200:203], a[152:155], v[92:95]
    ds_read_b64_tr_b16 a[198:199], v197 offset:29184
    v_mfma_f32_16x16x32_bf16 v[92:95], a[204:207], a[164:167], v[92:95]
    s_waitcnt lgkmcnt(4)
    v_mfma_f32_16x16x32_bf16 v[0:3], a[208:211], a[168:171], v[0:3]
    buffer_load_dwordx4 v207, s[16:19], s73 offen offset:3072 lds
    v_mfma_f32_16x16x32_bf16 v[0:3], a[212:215], a[180:183], v[0:3]
    s_xor_b32 s74, s38, 40960
    ds_read_b64_tr_b16 a[200:201], v198 offset:24576
    ds_read_b64_tr_b16 a[202:203], v198 offset:25088
    v_mfma_f32_16x16x32_bf16 v[4:7], a[208:211], a[172:175], v[4:7]
    ds_read_b64_tr_b16 a[204:205], v198 offset:28672
    v_mfma_f32_16x16x32_bf16 v[4:7], a[212:215], a[184:187], v[4:7]
    buffer_load_dwordx4 a[232:235], v252, s[12:15], s74 offen offset:0 nt
    v_mfma_f32_16x16x32_bf16 v[8:11], a[208:211], a[176:179], v[8:11]
    ds_read_b64_tr_b16 a[206:207], v198 offset:29184
    v_mfma_f32_16x16x32_bf16 v[8:11], a[212:215], a[188:191], v[8:11]
    s_waitcnt lgkmcnt(4)
    buffer_load_dwordx4 a[236:239], v253, s[12:15], s74 offen offset:1024 nt
    v_mfma_f32_16x16x32_bf16 v[12:15], a[192:195], a[168:171], v[12:15]
    ds_read_b64_tr_b16 a[208:209], v199 offset:24576
    ds_read_b64_tr_b16 a[210:211], v199 offset:25088
    v_mfma_f32_16x16x32_bf16 v[12:15], a[196:199], a[180:183], v[12:15]
    ds_read_b64_tr_b16 a[212:213], v199 offset:28672
    v_mul_f32 v0, s75, v0
    v_mfma_f32_16x16x32_bf16 v[16:19], a[192:195], a[172:175], v[16:19]
    buffer_load_dwordx4 a[252:255], v254, s[12:15], s74 offen offset:2048 nt
    v_mfma_f32_16x16x32_bf16 v[16:19], a[196:199], a[184:187], v[16:19]
    s_add_u32 m0, s68, 16384
    ds_read_b64_tr_b16 a[214:215], v199 offset:29184
    v_mul_f32 v1, s75, v1
    v_mfma_f32_16x16x32_bf16 v[20:23], a[192:195], a[176:179], v[20:23]
    s_xor_b32 s74, s38, 16384
    buffer_load_dwordx4 v252, s[8:11], s74 offen offset:0 nt lds
    v_mfma_f32_16x16x32_bf16 v[20:23], a[196:199], a[188:191], v[20:23]
    s_waitcnt lgkmcnt(4)
    v_mul_f32 v2, s75, v2
    v_mul_f32 v3, s75, v3
    v_mfma_f32_16x16x32_bf16 v[24:27], a[200:203], a[168:171], v[24:27]
    v_cvt_pk_bf16_f32 v0, v0, v1
    v_cvt_pk_bf16_f32 v1, v2, v3
    v_mfma_f32_16x16x32_bf16 v[24:27], a[204:207], a[180:183], v[24:27]
    s_waitcnt vmcnt(16) lgkmcnt(0)
    v_mul_f32 v12, s75, v12
    v_mul_f32 v13, s75, v13
    v_mfma_f32_16x16x32_bf16 v[28:31], a[200:203], a[172:175], v[28:31]
    s_barrier
    ds_read_b64_tr_b16 a[192:193], v192 offset:32768
    ds_read_b64_tr_b16 a[194:195], v192 offset:33280
    v_mfma_f32_16x16x32_bf16 v[28:31], a[204:207], a[184:187], v[28:31]
    s_add_u32 m0, s68, 106496
    ds_read_b64_tr_b16 a[196:197], v192 offset:36864
    v_mul_f32 v14, s75, v14
    v_mfma_f32_16x16x32_bf16 v[32:35], a[200:203], a[176:179], v[32:35]
    s_xor_b32 s73, s71, 1573120
    ds_read_b64_tr_b16 a[198:199], v192 offset:37376
    v_mul_f32 v15, s75, v15
    v_mfma_f32_16x16x32_bf16 v[32:35], a[204:207], a[188:191], v[32:35]
    buffer_load_dwordx4 v204, s[16:19], s73 offen offset:0 lds
    v_mfma_f32_16x16x32_bf16 v[36:39], a[208:211], a[168:171], v[36:39]
    ds_read_b64_tr_b16 a[200:201], v193 offset:32768
    v_cvt_pk_bf16_f32 v12, v12, v13
    v_mfma_f32_16x16x32_bf16 v[36:39], a[212:215], a[180:183], v[36:39]
    ds_read_b64_tr_b16 a[202:203], v193 offset:33280
    v_cvt_pk_bf16_f32 v13, v14, v15
    v_mfma_f32_16x16x32_bf16 v[40:43], a[208:211], a[172:175], v[40:43]
    ds_read_b64_tr_b16 a[204:205], v193 offset:36864
    v_mfma_f32_16x16x32_bf16 v[40:43], a[212:215], a[184:187], v[40:43]
    ds_read_b64_tr_b16 a[206:207], v193 offset:37376
    v_mfma_f32_16x16x32_bf16 v[44:47], a[208:211], a[176:179], v[44:47]
    v_permlane16_swap_b32 v0, v12
    v_mfma_f32_16x16x32_bf16 v[44:47], a[212:215], a[188:191], v[44:47]
    s_waitcnt lgkmcnt(4)
    buffer_load_dwordx4 v205, s[16:19], s73 offen offset:1024 lds
    v_mfma_f32_16x16x32_bf16 v[48:51], a[192:195], a[168:171], v[48:51]
    ds_read_b64_tr_b16 a[208:209], v194 offset:32768
    v_mfma_f32_16x16x32_bf16 v[48:51], a[196:199], a[180:183], v[48:51]
    ds_read_b64_tr_b16 a[210:211], v194 offset:33280
    v_mfma_f32_16x16x32_bf16 v[52:55], a[192:195], a[172:175], v[52:55]
    ds_read_b64_tr_b16 a[212:213], v194 offset:36864
    v_mfma_f32_16x16x32_bf16 v[52:55], a[196:199], a[184:187], v[52:55]
    ds_read_b64_tr_b16 a[214:215], v194 offset:37376
    v_mfma_f32_16x16x32_bf16 v[56:59], a[192:195], a[176:179], v[56:59]
    v_permlane16_swap_b32 v1, v13
    v_mfma_f32_16x16x32_bf16 v[56:59], a[196:199], a[188:191], v[56:59]
    s_waitcnt lgkmcnt(4)
    buffer_load_dwordx4 v206, s[16:19], s73 offen offset:2048 lds
    v_mfma_f32_16x16x32_bf16 v[60:63], a[200:203], a[168:171], v[60:63]
    ds_read_b64_tr_b16 a[192:193], v195 offset:32768
    v_mul_f32 v4, s75, v4
    v_mfma_f32_16x16x32_bf16 v[60:63], a[204:207], a[180:183], v[60:63]
    ds_read_b64_tr_b16 a[194:195], v195 offset:33280
    v_mul_f32 v5, s75, v5
    v_mfma_f32_16x16x32_bf16 v[64:67], a[200:203], a[172:175], v[64:67]
    ds_read_b64_tr_b16 a[196:197], v195 offset:36864
    v_mul_f32 v6, s75, v6
    v_mfma_f32_16x16x32_bf16 v[64:67], a[204:207], a[184:187], v[64:67]
    ds_read_b64_tr_b16 a[198:199], v195 offset:37376
    v_mul_f32 v7, s75, v7
    v_mfma_f32_16x16x32_bf16 v[68:71], a[200:203], a[176:179], v[68:71]
    v_cvt_pk_bf16_f32 v4, v4, v5
    v_cvt_pk_bf16_f32 v5, v6, v7
    v_mfma_f32_16x16x32_bf16 v[68:71], a[204:207], a[188:191], v[68:71]
    s_waitcnt lgkmcnt(4)
    buffer_load_dwordx4 v207, s[16:19], s73 offen offset:3072 lds
    v_mfma_f32_16x16x32_bf16 v[72:75], a[208:211], a[168:171], v[72:75]
    v_mul_f32 v16, s75, v16
    v_mul_f32 v17, s75, v17
    v_mfma_f32_16x16x32_bf16 v[72:75], a[212:215], a[180:183], v[72:75]
    s_waitcnt vmcnt(16) lgkmcnt(0)
    v_mul_f32 v18, s75, v18
    v_mul_f32 v19, s75, v19
    v_mfma_f32_16x16x32_bf16 v[76:79], a[208:211], a[172:175], v[76:79]
    s_barrier
    ds_read_b64_tr_b16 a[200:201], v196 offset:32768
    ds_read_b64_tr_b16 a[202:203], v196 offset:33280
    v_mfma_f32_16x16x32_bf16 v[76:79], a[212:215], a[184:187], v[76:79]
    s_add_u32 m0, s68, 32768
    ds_read_b64_tr_b16 a[204:205], v196 offset:36864
    v_cvt_pk_bf16_f32 v16, v16, v17
    v_mfma_f32_16x16x32_bf16 v[80:83], a[208:211], a[176:179], v[80:83]
    s_xor_b32 s73, s71, 2097408
    ds_read_b64_tr_b16 a[206:207], v196 offset:37376
    v_cvt_pk_bf16_f32 v17, v18, v19
    v_mfma_f32_16x16x32_bf16 v[80:83], a[212:215], a[188:191], v[80:83]
    buffer_load_dwordx4 v204, s[16:19], s73 offen offset:0 lds
    v_mfma_f32_16x16x32_bf16 v[84:87], a[192:195], a[168:171], v[84:87]
    ds_read_b64_tr_b16 a[208:209], v197 offset:32768
    v_mul_f32 v48, s75, v48
    v_mfma_f32_16x16x32_bf16 v[84:87], a[196:199], a[180:183], v[84:87]
    ds_read_b64_tr_b16 a[210:211], v197 offset:33280
    v_mul_f32 v49, s75, v49
    v_mfma_f32_16x16x32_bf16 v[88:91], a[192:195], a[172:175], v[88:91]
    ds_read_b64_tr_b16 a[212:213], v197 offset:36864
    v_mul_f32 v50, s75, v50
    v_mfma_f32_16x16x32_bf16 v[88:91], a[196:199], a[184:187], v[88:91]
    ds_read_b64_tr_b16 a[214:215], v197 offset:37376
    v_mul_f32 v51, s75, v51
    v_mfma_f32_16x16x32_bf16 v[92:95], a[192:195], a[176:179], v[92:95]
    v_permlane16_swap_b32 v4, v16
    v_mfma_f32_16x16x32_bf16 v[92:95], a[196:199], a[188:191], v[92:95]
    s_waitcnt lgkmcnt(4)
    buffer_load_dwordx4 v205, s[16:19], s73 offen offset:1024 lds
    v_mfma_f32_16x16x32_bf16 v[96:99], a[200:203], a[0:3], 0
    ds_read_b64_tr_b16 a[192:193], v198 offset:32768
    v_cvt_pk_bf16_f32 v48, v48, v49
    v_mfma_f32_16x16x32_bf16 v[96:99], a[204:207], a[12:15], v[96:99]
    ds_read_b64_tr_b16 a[194:195], v198 offset:33280
    v_cvt_pk_bf16_f32 v49, v50, v51
    v_mfma_f32_16x16x32_bf16 v[100:103], a[200:203], a[4:7], 0
    ds_read_b64_tr_b16 a[196:197], v198 offset:36864
    v_mul_f32 v60, s75, v60
    v_mfma_f32_16x16x32_bf16 v[100:103], a[204:207], a[16:19], v[100:103]
    ds_read_b64_tr_b16 a[198:199], v198 offset:37376
    v_mul_f32 v61, s75, v61
    v_mfma_f32_16x16x32_bf16 v[104:107], a[200:203], a[8:11], 0
    v_permlane16_swap_b32 v5, v17
    v_mfma_f32_16x16x32_bf16 v[104:107], a[204:207], a[20:23], v[104:107]
    s_waitcnt lgkmcnt(4)
    buffer_load_dwordx4 v206, s[16:19], s73 offen offset:2048 lds
    v_mfma_f32_16x16x32_bf16 v[108:111], a[208:211], a[0:3], 0
    ds_read_b64_tr_b16 a[200:201], v199 offset:32768
    v_mul_f32 v8, s75, v8
    v_mfma_f32_16x16x32_bf16 v[108:111], a[212:215], a[12:15], v[108:111]
    ds_read_b64_tr_b16 a[202:203], v199 offset:33280
    v_mul_f32 v9, s75, v9
    v_mfma_f32_16x16x32_bf16 v[112:115], a[208:211], a[4:7], 0
    ds_read_b64_tr_b16 a[204:205], v199 offset:36864
    v_mul_f32 v10, s75, v10
    v_mfma_f32_16x16x32_bf16 v[112:115], a[212:215], a[16:19], v[112:115]
    ds_read_b64_tr_b16 a[206:207], v199 offset:37376
    v_mul_f32 v11, s75, v11
    v_mfma_f32_16x16x32_bf16 v[116:119], a[208:211], a[8:11], 0
    v_cvt_pk_bf16_f32 v8, v8, v9
    v_cvt_pk_bf16_f32 v9, v10, v11
    v_mfma_f32_16x16x32_bf16 v[116:119], a[212:215], a[20:23], v[116:119]
    s_waitcnt lgkmcnt(4)
    buffer_load_dwordx4 v207, s[16:19], s73 offen offset:3072 lds
    v_mfma_f32_16x16x32_bf16 v[120:123], a[192:195], a[0:3], 0
    v_mul_f32 v20, s75, v20
    v_mul_f32 v21, s75, v21
    v_mfma_f32_16x16x32_bf16 v[120:123], a[196:199], a[12:15], v[120:123]
    s_waitcnt vmcnt(16) lgkmcnt(0)
    v_mul_f32 v22, s75, v22
    v_mul_f32 v23, s75, v23
    v_mfma_f32_16x16x32_bf16 v[124:127], a[192:195], a[4:7], 0
    s_barrier
    ds_read_b64_tr_b16 a[208:209], v196 offset:16384
    ds_read_b64_tr_b16 a[210:211], v196 offset:16896
    v_mfma_f32_16x16x32_bf16 v[124:127], a[196:199], a[16:19], v[124:127]
    s_add_u32 m0, s68, 114688
    ds_read_b64_tr_b16 a[212:213], v196 offset:20480
    v_cvt_pk_bf16_f32 v20, v20, v21
    v_mfma_f32_16x16x32_bf16 v[128:131], a[192:195], a[8:11], 0
    s_xor_b32 s73, s71, 2621696
    ds_read_b64_tr_b16 a[214:215], v196 offset:20992
    v_cvt_pk_bf16_f32 v21, v22, v23
    v_mfma_f32_16x16x32_bf16 v[128:131], a[196:199], a[20:23], v[128:131]
    buffer_load_dwordx4 v204, s[16:19], s73 offen offset:0 lds
    v_mfma_f32_16x16x32_bf16 v[132:135], a[200:203], a[0:3], 0
    ds_read_b64_tr_b16 a[192:193], v197 offset:16384
    v_mul_f32 v62, s75, v62
    v_mfma_f32_16x16x32_bf16 v[132:135], a[204:207], a[12:15], v[132:135]
    ds_read_b64_tr_b16 a[194:195], v197 offset:16896
    v_mul_f32 v63, s75, v63
    v_mfma_f32_16x16x32_bf16 v[136:139], a[200:203], a[4:7], 0
    ds_read_b64_tr_b16 a[196:197], v197 offset:20480
    v_cvt_pk_bf16_f32 v60, v60, v61
    v_mfma_f32_16x16x32_bf16 v[136:139], a[204:207], a[16:19], v[136:139]
    ds_read_b64_tr_b16 a[198:199], v197 offset:20992
    v_cvt_pk_bf16_f32 v61, v62, v63
    v_mfma_f32_16x16x32_bf16 v[140:143], a[200:203], a[8:11], 0
    v_permlane16_swap_b32 v8, v20
    v_mfma_f32_16x16x32_bf16 v[140:143], a[204:207], a[20:23], v[140:143]
    s_waitcnt lgkmcnt(4)
    buffer_load_dwordx4 v205, s[16:19], s73 offen offset:1024 lds
    v_mfma_f32_16x16x32_bf16 v[96:99], a[208:211], a[24:27], v[96:99]
    ds_read_b64_tr_b16 a[200:201], v198 offset:16384
    v_mfma_f32_16x16x32_bf16 v[96:99], a[212:215], a[36:39], v[96:99]
    ds_read_b64_tr_b16 a[202:203], v198 offset:16896
    v_mfma_f32_16x16x32_bf16 v[100:103], a[208:211], a[28:31], v[100:103]
    ds_read_b64_tr_b16 a[204:205], v198 offset:20480
    v_mfma_f32_16x16x32_bf16 v[100:103], a[212:215], a[40:43], v[100:103]
    ds_read_b64_tr_b16 a[206:207], v198 offset:20992
    v_mfma_f32_16x16x32_bf16 v[104:107], a[208:211], a[32:35], v[104:107]
    v_permlane16_swap_b32 v9, v21
    v_mfma_f32_16x16x32_bf16 v[104:107], a[212:215], a[44:47], v[104:107]
    s_waitcnt lgkmcnt(4)
    buffer_load_dwordx4 v206, s[16:19], s73 offen offset:2048 lds
    v_mfma_f32_16x16x32_bf16 v[108:111], a[192:195], a[24:27], v[108:111]
    ds_read_b64_tr_b16 a[208:209], v199 offset:16384
    v_mul_f32 v24, s75, v24
    v_mfma_f32_16x16x32_bf16 v[108:111], a[196:199], a[36:39], v[108:111]
    ds_read_b64_tr_b16 a[210:211], v199 offset:16896
    v_mul_f32 v25, s75, v25
    v_mfma_f32_16x16x32_bf16 v[112:115], a[192:195], a[28:31], v[112:115]
    ds_read_b64_tr_b16 a[212:213], v199 offset:20480
    v_mul_f32 v26, s75, v26
    v_mfma_f32_16x16x32_bf16 v[112:115], a[196:199], a[40:43], v[112:115]
    ds_read_b64_tr_b16 a[214:215], v199 offset:20992
    v_mul_f32 v27, s75, v27
    v_mfma_f32_16x16x32_bf16 v[116:119], a[192:195], a[32:35], v[116:119]
    v_cvt_pk_bf16_f32 v24, v24, v25
    v_cvt_pk_bf16_f32 v25, v26, v27
    v_mfma_f32_16x16x32_bf16 v[116:119], a[196:199], a[44:47], v[116:119]
    s_waitcnt lgkmcnt(4)
    buffer_load_dwordx4 v207, s[16:19], s73 offen offset:3072 lds
    v_mfma_f32_16x16x32_bf16 v[120:123], a[200:203], a[24:27], v[120:123]
    s_add_u32 m0, s68, 98304
    v_mul_f32 v36, s75, v36
    v_mul_f32 v37, s75, v37
    v_mfma_f32_16x16x32_bf16 v[120:123], a[204:207], a[36:39], v[120:123]
    s_waitcnt vmcnt(16) lgkmcnt(0)
    v_mul_f32 v38, s75, v38
    v_mul_f32 v39, s75, v39
    v_mfma_f32_16x16x32_bf16 v[124:127], a[200:203], a[28:31], v[124:127]
    s_barrier
    ds_read_b64_tr_b16 a[192:193], v192 offset:24576
    ds_read_b64_tr_b16 a[194:195], v192 offset:25088
    v_mfma_f32_16x16x32_bf16 v[124:127], a[204:207], a[40:43], v[124:127]
    s_xor_b32 s73, s71, 3145984
    ds_read_b64_tr_b16 a[196:197], v192 offset:28672
    v_cvt_pk_bf16_f32 v36, v36, v37
    v_mfma_f32_16x16x32_bf16 v[128:131], a[200:203], a[32:35], v[128:131]
    buffer_load_dwordx4 v204, s[16:19], s73 offen offset:0 lds
    v_mfma_f32_16x16x32_bf16 v[128:131], a[204:207], a[44:47], v[128:131]
    ds_read_b64_tr_b16 a[198:199], v192 offset:29184
    v_cvt_pk_bf16_f32 v37, v38, v39
    v_mfma_f32_16x16x32_bf16 v[132:135], a[208:211], a[24:27], v[132:135]
    ds_read_b64_tr_b16 a[200:201], v193 offset:24576
    ds_read_b64_tr_b16 a[202:203], v193 offset:25088
    v_mfma_f32_16x16x32_bf16 v[132:135], a[212:215], a[36:39], v[132:135]
    buffer_load_dwordx4 v205, s[16:19], s73 offen offset:1024 lds
    v_mfma_f32_16x16x32_bf16 v[136:139], a[208:211], a[28:31], v[136:139]
    ds_read_b64_tr_b16 a[204:205], v193 offset:28672
    v_mfma_f32_16x16x32_bf16 v[136:139], a[212:215], a[40:43], v[136:139]
    buffer_load_dwordx4 v206, s[16:19], s73 offen offset:2048 lds
    v_mfma_f32_16x16x32_bf16 v[140:143], a[208:211], a[32:35], v[140:143]
    ds_read_b64_tr_b16 a[206:207], v193 offset:29184
    v_mfma_f32_16x16x32_bf16 v[140:143], a[212:215], a[44:47], v[140:143]
    s_waitcnt lgkmcnt(4)
    v_permlane16_swap_b32 v24, v36
    v_mfma_f32_16x16x32_bf16 v[96:99], a[192:195], a[48:51], v[96:99]
    buffer_load_dwordx4 v207, s[16:19], s73 offen offset:3072 lds
    v_mfma_f32_16x16x32_bf16 v[96:99], a[196:199], a[60:63], v[96:99]
    s_add_u32 m0, s68, 16384
    ds_read_b64_tr_b16 a[208:209], v194 offset:24576
    ds_read_b64_tr_b16 a[210:211], v194 offset:25088
    v_mfma_f32_16x16x32_bf16 v[100:103], a[192:195], a[52:55], v[100:103]
    s_xor_b32 s74, s38, 16384
    ds_read_b64_tr_b16 a[212:213], v194 offset:28672
    v_mfma_f32_16x16x32_bf16 v[100:103], a[196:199], a[64:67], v[100:103]
    buffer_load_dwordx4 v253, s[8:11], s74 offen offset:1024 nt lds
    v_mfma_f32_16x16x32_bf16 v[104:107], a[192:195], a[56:59], v[104:107]
    ds_read_b64_tr_b16 a[214:215], v194 offset:29184
    v_mfma_f32_16x16x32_bf16 v[104:107], a[196:199], a[68:71], v[104:107]
    s_waitcnt lgkmcnt(4)
    buffer_load_dwordx4 v254, s[8:11], s74 offen offset:2048 nt lds
    v_mfma_f32_16x16x32_bf16 v[108:111], a[200:203], a[48:51], v[108:111]
    ds_read_b64_tr_b16 a[192:193], v195 offset:24576
    ds_read_b64_tr_b16 a[194:195], v195 offset:25088
    v_mfma_f32_16x16x32_bf16 v[108:111], a[204:207], a[60:63], v[108:111]
    ds_read_b64_tr_b16 a[196:197], v195 offset:28672
    v_mfma_f32_16x16x32_bf16 v[112:115], a[200:203], a[52:55], v[112:115]
    buffer_load_dwordx4 v255, s[8:11], s74 offen offset:3072 nt lds
    v_mfma_f32_16x16x32_bf16 v[112:115], a[204:207], a[64:67], v[112:115]
    s_add_u32 m0, s68, 8192
    ds_read_b64_tr_b16 a[198:199], v195 offset:29184
    v_mfma_f32_16x16x32_bf16 v[116:119], a[200:203], a[56:59], v[116:119]
    s_xor_b32 s74, s38, 8192
    buffer_load_dwordx4 v252, s[8:11], s74 offen offset:0 nt lds
    v_mfma_f32_16x16x32_bf16 v[116:119], a[204:207], a[68:71], v[116:119]
    s_waitcnt lgkmcnt(4)
    v_permlane16_swap_b32 v25, v37
    v_mfma_f32_16x16x32_bf16 v[120:123], a[208:211], a[48:51], v[120:123]
    v_mul_f32 v28, s75, v28
    v_mul_f32 v29, s75, v29
    v_mfma_f32_16x16x32_bf16 v[120:123], a[212:215], a[60:63], v[120:123]
    s_waitcnt vmcnt(16) lgkmcnt(0)
    v_mul_f32 v30, s75, v30
    v_mul_f32 v31, s75, v31
    v_mfma_f32_16x16x32_bf16 v[124:127], a[208:211], a[52:55], v[124:127]
    s_barrier
    ds_read_b64_tr_b16 a[200:201], v196 offset:24576
    ds_read_b64_tr_b16 a[202:203], v196 offset:25088
    v_mfma_f32_16x16x32_bf16 v[124:127], a[212:215], a[64:67], v[124:127]
    s_add_u32 m0, s68, 24576
    ds_read_b64_tr_b16 a[204:205], v196 offset:28672
    v_cvt_pk_bf16_f32 v28, v28, v29
    v_mfma_f32_16x16x32_bf16 v[128:131], a[208:211], a[56:59], v[128:131]
    s_xor_b32 s73, s71, 3670272
    ds_read_b64_tr_b16 a[206:207], v196 offset:29184
    v_cvt_pk_bf16_f32 v29, v30, v31
    v_mfma_f32_16x16x32_bf16 v[128:131], a[212:215], a[68:71], v[128:131]
    buffer_load_dwordx4 v204, s[16:19], s73 offen offset:0 lds
    v_mfma_f32_16x16x32_bf16 v[132:135], a[192:195], a[48:51], v[132:135]
    ds_read_b64_tr_b16 a[208:209], v197 offset:24576
    v_mul_f32 v40, s75, v40
    v_mfma_f32_16x16x32_bf16 v[132:135], a[196:199], a[60:63], v[132:135]
    ds_read_b64_tr_b16 a[210:211], v197 offset:25088
    v_mul_f32 v41, s75, v41
    v_mfma_f32_16x16x32_bf16 v[136:139], a[192:195], a[52:55], v[136:139]
    ds_read_b64_tr_b16 a[212:213], v197 offset:28672
    v_mul_f32 v42, s75, v42
    v_mfma_f32_16x16x32_bf16 v[136:139], a[196:199], a[64:67], v[136:139]
    ds_read_b64_tr_b16 a[214:215], v197 offset:29184
    v_mul_f32 v43, s75, v43
    v_mfma_f32_16x16x32_bf16 v[140:143], a[192:195], a[56:59], v[140:143]
    v_cvt_pk_bf16_f32 v40, v40, v41
    v_cvt_pk_bf16_f32 v41, v42, v43
    v_mfma_f32_16x16x32_bf16 v[140:143], a[196:199], a[68:71], v[140:143]
    s_waitcnt lgkmcnt(4)
    buffer_load_dwordx4 v205, s[16:19], s73 offen offset:1024 lds
    v_mfma_f32_16x16x32_bf16 v[96:99], a[200:203], a[72:75], v[96:99]
    ds_read_b64_tr_b16 a[192:193], v198 offset:24576
    v_mfma_f32_16x16x32_bf16 v[96:99], a[204:207], a[84:87], v[96:99]
    ds_read_b64_tr_b16 a[194:195], v198 offset:25088
    v_mfma_f32_16x16x32_bf16 v[100:103], a[200:203], a[76:79], v[100:103]
    ds_read_b64_tr_b16 a[196:197], v198 offset:28672
    v_mfma_f32_16x16x32_bf16 v[100:103], a[204:207], a[88:91], v[100:103]
    ds_read_b64_tr_b16 a[198:199], v198 offset:29184
    v_mfma_f32_16x16x32_bf16 v[104:107], a[200:203], a[80:83], v[104:107]
    v_permlane16_swap_b32 v28, v40
    v_mfma_f32_16x16x32_bf16 v[104:107], a[204:207], a[92:95], v[104:107]
    s_waitcnt lgkmcnt(4)
    buffer_load_dwordx4 v206, s[16:19], s73 offen offset:2048 lds
    v_mfma_f32_16x16x32_bf16 v[108:111], a[208:211], a[72:75], v[108:111]
    ds_read_b64_tr_b16 a[200:201], v199 offset:24576
    v_mfma_f32_16x16x32_bf16 v[108:111], a[212:215], a[84:87], v[108:111]
    ds_read_b64_tr_b16 a[202:203], v199 offset:25088
    v_mfma_f32_16x16x32_bf16 v[112:115], a[208:211], a[76:79], v[112:115]
    ds_read_b64_tr_b16 a[204:205], v199 offset:28672
    v_mfma_f32_16x16x32_bf16 v[112:115], a[212:215], a[88:91], v[112:115]
    ds_read_b64_tr_b16 a[206:207], v199 offset:29184
    v_mfma_f32_16x16x32_bf16 v[116:119], a[208:211], a[80:83], v[116:119]
    v_permlane16_swap_b32 v29, v41
    v_mfma_f32_16x16x32_bf16 v[116:119], a[212:215], a[92:95], v[116:119]
    s_waitcnt lgkmcnt(4)
    buffer_load_dwordx4 v207, s[16:19], s73 offen offset:3072 lds
    v_mfma_f32_16x16x32_bf16 v[120:123], a[192:195], a[72:75], v[120:123]
    v_mul_f32 v32, s75, v32
    v_mul_f32 v33, s75, v33
    v_mfma_f32_16x16x32_bf16 v[120:123], a[196:199], a[84:87], v[120:123]
    s_waitcnt vmcnt(16) lgkmcnt(0)
    v_mul_f32 v34, s75, v34
    v_mul_f32 v35, s75, v35
    v_mfma_f32_16x16x32_bf16 v[124:127], a[192:195], a[76:79], v[124:127]
    s_barrier
    ds_read_b64_tr_b16 a[208:209], v192 offset:32768
    ds_read_b64_tr_b16 a[210:211], v192 offset:33280
    v_mfma_f32_16x16x32_bf16 v[124:127], a[196:199], a[88:91], v[124:127]
    s_add_u32 m0, s68, 106496
    ds_read_b64_tr_b16 a[212:213], v192 offset:36864
    v_cvt_pk_bf16_f32 v32, v32, v33
    v_mfma_f32_16x16x32_bf16 v[128:131], a[192:195], a[80:83], v[128:131]
    s_xor_b32 s73, s71, 384
    ds_read_b64_tr_b16 a[214:215], v192 offset:37376
    v_cvt_pk_bf16_f32 v33, v34, v35
    v_mfma_f32_16x16x32_bf16 v[128:131], a[196:199], a[92:95], v[128:131]
    buffer_load_dwordx4 v204, s[16:19], s73 offen offset:0 lds
    v_mfma_f32_16x16x32_bf16 v[132:135], a[200:203], a[72:75], v[132:135]
    ds_read_b64_tr_b16 a[192:193], v193 offset:32768
    v_mul_f32 v44, s75, v44
    v_mfma_f32_16x16x32_bf16 v[132:135], a[204:207], a[84:87], v[132:135]
    ds_read_b64_tr_b16 a[194:195], v193 offset:33280
    v_mul_f32 v45, s75, v45
    v_mfma_f32_16x16x32_bf16 v[136:139], a[200:203], a[76:79], v[136:139]
    ds_read_b64_tr_b16 a[196:197], v193 offset:36864
    v_mul_f32 v46, s75, v46
    v_mfma_f32_16x16x32_bf16 v[136:139], a[204:207], a[88:91], v[136:139]
    ds_read_b64_tr_b16 a[198:199], v193 offset:37376
    v_mul_f32 v47, s75, v47
    v_mfma_f32_16x16x32_bf16 v[140:143], a[200:203], a[80:83], v[140:143]
    v_cvt_pk_bf16_f32 v44, v44, v45
    v_cvt_pk_bf16_f32 v45, v46, v47
    v_mfma_f32_16x16x32_bf16 v[140:143], a[204:207], a[92:95], v[140:143]
    s_waitcnt lgkmcnt(4)
    buffer_load_dwordx4 v205, s[16:19], s73 offen offset:1024 lds
    v_mfma_f32_16x16x32_bf16 v[96:99], a[208:211], a[96:99], v[96:99]
    ds_read_b64_tr_b16 a[200:201], v194 offset:32768
    v_mfma_f32_16x16x32_bf16 v[96:99], a[212:215], a[108:111], v[96:99]
    ds_read_b64_tr_b16 a[202:203], v194 offset:33280
    v_mfma_f32_16x16x32_bf16 v[100:103], a[208:211], a[100:103], v[100:103]
    ds_read_b64_tr_b16 a[204:205], v194 offset:36864
    v_mfma_f32_16x16x32_bf16 v[100:103], a[212:215], a[112:115], v[100:103]
    ds_read_b64_tr_b16 a[206:207], v194 offset:37376
    v_mfma_f32_16x16x32_bf16 v[104:107], a[208:211], a[104:107], v[104:107]
    v_permlane16_swap_b32 v32, v44
    v_mfma_f32_16x16x32_bf16 v[104:107], a[212:215], a[116:119], v[104:107]
    s_waitcnt lgkmcnt(4)
    buffer_load_dwordx4 v206, s[16:19], s73 offen offset:2048 lds
    v_mfma_f32_16x16x32_bf16 v[108:111], a[192:195], a[96:99], v[108:111]
    ds_read_b64_tr_b16 a[208:209], v195 offset:32768
    v_mfma_f32_16x16x32_bf16 v[108:111], a[196:199], a[108:111], v[108:111]
    ds_read_b64_tr_b16 a[210:211], v195 offset:33280
    v_mfma_f32_16x16x32_bf16 v[112:115], a[192:195], a[100:103], v[112:115]
    ds_read_b64_tr_b16 a[212:213], v195 offset:36864
    v_mfma_f32_16x16x32_bf16 v[112:115], a[196:199], a[112:115], v[112:115]
    ds_read_b64_tr_b16 a[214:215], v195 offset:37376
    v_mfma_f32_16x16x32_bf16 v[116:119], a[192:195], a[104:107], v[116:119]
    v_permlane16_swap_b32 v33, v45
    v_mfma_f32_16x16x32_bf16 v[116:119], a[196:199], a[116:119], v[116:119]
    s_waitcnt lgkmcnt(4)
    buffer_load_dwordx4 v207, s[16:19], s73 offen offset:3072 lds
    v_mfma_f32_16x16x32_bf16 v[120:123], a[200:203], a[96:99], v[120:123]
    v_permlane16_swap_b32 v48, v60
    v_mfma_f32_16x16x32_bf16 v[120:123], a[204:207], a[108:111], v[120:123]
    s_waitcnt vmcnt(16) lgkmcnt(0)
    v_permlane16_swap_b32 v49, v61
    v_mfma_f32_16x16x32_bf16 v[124:127], a[200:203], a[100:103], v[124:127]
    s_barrier
    ds_read_b64_tr_b16 a[192:193], v196 offset:32768
    ds_read_b64_tr_b16 a[194:195], v196 offset:33280
    v_mfma_f32_16x16x32_bf16 v[124:127], a[204:207], a[112:115], v[124:127]
    s_add_u32 m0, s68, 32768
    ds_read_b64_tr_b16 a[196:197], v196 offset:36864
    v_mul_f32 v52, s75, v52
    v_mfma_f32_16x16x32_bf16 v[128:131], a[200:203], a[104:107], v[128:131]
    s_xor_b32 s73, s71, 524672
    ds_read_b64_tr_b16 a[198:199], v196 offset:37376
    v_mul_f32 v53, s75, v53
    v_mfma_f32_16x16x32_bf16 v[128:131], a[204:207], a[116:119], v[128:131]
    buffer_load_dwordx4 v204, s[16:19], s73 offen offset:0 lds
    v_mfma_f32_16x16x32_bf16 v[132:135], a[208:211], a[96:99], v[132:135]
    ds_read_b64_tr_b16 a[200:201], v197 offset:32768
    v_mul_f32 v54, s75, v54
    v_mfma_f32_16x16x32_bf16 v[132:135], a[212:215], a[108:111], v[132:135]
    ds_read_b64_tr_b16 a[202:203], v197 offset:33280
    v_mul_f32 v55, s75, v55
    v_mfma_f32_16x16x32_bf16 v[136:139], a[208:211], a[100:103], v[136:139]
L_hopa_2:
    s_cbranch_execz L_backa
    ds_read_b64_tr_b16 a[204:205], v197 offset:36864
    v_cvt_pk_bf16_f32 v52, v52, v53
    v_mfma_f32_16x16x32_bf16 v[136:139], a[212:215], a[112:115], v[136:139]
    ds_read_b64_tr_b16 a[206:207], v197 offset:37376
    v_cvt_pk_bf16_f32 v53, v54, v55
    v_mfma_f32_16x16x32_bf16 v[140:143], a[208:211], a[104:107], v[140:143]
    v_mul_f32 v64, s75, v64
    v_mul_f32 v65, s75, v65
    v_mfma_f32_16x16x32_bf16 v[140:143], a[212:215], a[116:119], v[140:143]
    s_waitcnt lgkmcnt(4)
    buffer_load_dwordx4 v205, s[16:19], s73 offen offset:1024 lds
    v_mfma_f32_16x16x32_bf16 v[96:99], a[192:195], a[120:123], v[96:99]
    ds_read_b64_tr_b16 a[208:209], v198 offset:32768
    v_mul_f32 v66, s75, v66
    v_mfma_f32_16x16x32_bf16 v[96:99], a[196:199], a[132:135], v[96:99]
    ds_read_b64_tr_b16 a[210:211], v198 offset:33280
    v_mul_f32 v67, s75, v67
    v_mfma_f32_16x16x32_bf16 v[100:103], a[192:195], a[124:127], v[100:103]
    ds_read_b64_tr_b16 a[212:213], v198 offset:36864
    v_cvt_pk_bf16_f32 v64, v64, v65
    v_mfma_f32_16x16x32_bf16 v[100:103], a[196:199], a[136:139], v[100:103]
    ds_read_b64_tr_b16 a[214:215], v198 offset:37376
    v_cvt_pk_bf16_f32 v65, v66, v67
    v_mfma_f32_16x16x32_bf16 v[104:107], a[192:195], a[128:131], v[104:107]
    v_permlane16_swap_b32 v52, v64
    v_mfma_f32_16x16x32_bf16 v[104:107], a[196:199], a[140:143], v[104:107]
    s_waitcnt lgkmcnt(4)
    buffer_load_dwordx4 v206, s[16:19], s73 offen offset:2048 lds
    v_mfma_f32_16x16x32_bf16 v[108:111], a[200:203], a[120:123], v[108:111]
    ds_read_b64_tr_b16 a[192:193], v199 offset:32768
    v_mfma_f32_16x16x32_bf16 v[108:111], a[204:207], a[132:135], v[108:111]
    ds_read_b64_tr_b16 a[194:195], v199 offset:33280
    v_mfma_f32_16x16x32_bf16 v[112:115], a[200:203], a[124:127], v[112:115]
    ds_read_b64_tr_b16 a[196:197], v199 offset:36864
    v_mfma_f32_16x16x32_bf16 v[112:115], a[204:207], a[136:139], v[112:115]
    ds_read_b64_tr_b16 a[198:199], v199 offset:37376
    v_mfma_f32_16x16x32_bf16 v[116:119], a[200:203], a[128:131], v[116:119]
    v_permlane16_swap_b32 v53, v65
    v_mfma_f32_16x16x32_bf16 v[116:119], a[204:207], a[140:143], v[116:119]
    s_waitcnt lgkmcnt(4)
    buffer_load_dwordx4 v207, s[16:19], s73 offen offset:3072 lds
    v_mfma_f32_16x16x32_bf16 v[120:123], a[208:211], a[120:123], v[120:123]
    s_add_u32 m0, s68, 114688
    v_mul_f32 v56, s75, v56
    v_mul_f32 v57, s75, v57
    v_mfma_f32_16x16x32_bf16 v[120:123], a[212:215], a[132:135], v[120:123]
    s_waitcnt vmcnt(16) lgkmcnt(0)
    v_mul_f32 v58, s75, v58
    v_mul_f32 v59, s75, v59
    v_mfma_f32_16x16x32_bf16 v[124:127], a[208:211], a[124:127], v[124:127]
    s_barrier
    ds_read_b64_tr_b16 a[200:201], v196 offset:16384
    ds_read_b64_tr_b16 a[202:203], v196 offset:16896
    v_mfma_f32_16x16x32_bf16 v[124:127], a[212:215], a[136:139], v[124:127]
    s_xor_b32 s73, s71, 1048960
    ds_read_b64_tr_b16 a[204:205], v196 offset:20480
    v_cvt_pk_bf16_f32 v56, v56, v57
    v_mfma_f32_16x16x32_bf16 v[128:131], a[208:211], a[128:131], v[128:131]
    buffer_load_dwordx4 v204, s[16:19], s73 offen offset:0 lds
    v_mfma_f32_16x16x32_bf16 v[128:131], a[212:215], a[140:143], v[128:131]
    ds_read_b64_tr_b16 a[206:207], v196 offset:20992
    v_cvt_pk_bf16_f32 v57, v58, v59
    v_mfma_f32_16x16x32_bf16 v[132:135], a[192:195], a[120:123], v[132:135]
    ds_read_b64_tr_b16 a[208:209], v197 offset:16384
    ds_read_b64_tr_b16 a[210:211], v197 offset:16896
    v_mfma_f32_16x16x32_bf16 v[132:135], a[196:199], a[132:135], v[132:135]
    buffer_load_dwordx4 v205, s[16:19], s73 offen offset:1024 lds
    v_mfma_f32_16x16x32_bf16 v[136:139], a[192:195], a[124:127], v[136:139]
    ds_read_b64_tr_b16 a[212:213], v197 offset:20480
    v_mul_f32 v68, s75, v68
    v_mfma_f32_16x16x32_bf16 v[136:139], a[196:199], a[136:139], v[136:139]
    buffer_load_dwordx4 v206, s[16:19], s73 offen offset:2048 lds
    v_mfma_f32_16x16x32_bf16 v[140:143], a[192:195], a[128:131], v[140:143]
    ds_read_b64_tr_b16 a[214:215], v197 offset:20992
    v_mul_f32 v69, s75, v69
    v_mfma_f32_16x16x32_bf16 v[140:143], a[196:199], a[140:143], v[140:143]
    s_waitcnt lgkmcnt(4)
    v_mul_f32 v70, s75, v70
    v_mul_f32 v71, s75, v71
    v_mfma_f32_16x16x32_bf16 v[96:99], a[200:203], a[144:147], v[96:99]
    buffer_load_dwordx4 v207, s[16:19], s73 offen offset:3072 lds
    v_mfma_f32_16x16x32_bf16 v[96:99], a[204:207], a[156:159], v[96:99]
    s_add_u32 m0, s68, 8192
    ds_read_b64_tr_b16 a[192:193], v198 offset:16384
    ds_read_b64_tr_b16 a[194:195], v198 offset:16896
    v_mfma_f32_16x16x32_bf16 v[100:103], a[200:203], a[148:151], v[100:103]
    s_xor_b32 s74, s38, 8192
    ds_read_b64_tr_b16 a[196:197], v198 offset:20480
    v_cvt_pk_bf16_f32 v68, v68, v69
    v_mfma_f32_16x16x32_bf16 v[100:103], a[204:207], a[160:163], v[100:103]
    buffer_load_dwordx4 v253, s[8:11], s74 offen offset:1024 nt lds
    v_mfma_f32_16x16x32_bf16 v[104:107], a[200:203], a[152:155], v[104:107]
    ds_read_b64_tr_b16 a[198:199], v198 offset:20992
    v_cvt_pk_bf16_f32 v69, v70, v71
    v_mfma_f32_16x16x32_bf16 v[104:107], a[204:207], a[164:167], v[104:107]
    s_waitcnt lgkmcnt(4)
    buffer_load_dwordx4 v254, s[8:11], s74 offen offset:2048 nt lds
    v_mfma_f32_16x16x32_bf16 v[108:111], a[208:211], a[144:147], v[108:111]
    ds_read_b64_tr_b16 a[200:201], v199 offset:16384
    ds_read_b64_tr_b16 a[202:203], v199 offset:16896
    v_mfma_f32_16x16x32_bf16 v[108:111], a[212:215], a[156:159], v[108:111]
    ds_read_b64_tr_b16 a[204:205], v199 offset:20480
    v_mfma_f32_16x16x32_bf16 v[112:115], a[208:211], a[148:151], v[112:115]
    buffer_load_dwordx4 v255, s[8:11], s74 offen offset:3072 nt lds
    v_mfma_f32_16x16x32_bf16 v[112:115], a[212:215], a[160:163], v[112:115]
    s_add_u32 m0, s68, 90112
    ds_read_b64_tr_b16 a[206:207], v199 offset:20992
    v_mfma_f32_16x16x32_bf16 v[116:119], a[208:211], a[152:155], v[116:119]
    s_xor_b32 s74, s38, 8192
    buffer_load_dwordx4 v252, s[12:15], s74 offen offset:0 nt lds
    v_mfma_f32_16x16x32_bf16 v[116:119], a[212:215], a[164:167], v[116:119]
    s_waitcnt lgkmcnt(4)
    v_permlane16_swap_b32 v56, v68
    v_mfma_f32_16x16x32_bf16 v[120:123], a[192:195], a[144:147], v[120:123]
    v_permlane16_swap_b32 v57, v69
    v_mfma_f32_16x16x32_bf16 v[120:123], a[196:199], a[156:159], v[120:123]
    s_waitcnt vmcnt(16) lgkmcnt(0)
    v_mul_f32 v72, s75, v72
    v_mul_f32 v73, s75, v73
    v_mfma_f32_16x16x32_bf16 v[124:127], a[192:195], a[148:151], v[124:127]
    s_barrier
    ds_read_b64_tr_b16 a[208:209], v192 offset:24576
    ds_read_b64_tr_b16 a[210:211], v192 offset:25088
    v_mfma_f32_16x16x32_bf16 v[124:127], a[196:199], a[160:163], v[124:127]
    s_add_u32 m0, s68, 98304
    ds_read_b64_tr_b16 a[212:213], v192 offset:28672
    v_mul_f32 v74, s75, v74
    v_mfma_f32_16x16x32_bf16 v[128:131], a[192:195], a[152:155], v[128:131]
    s_xor_b32 s73, s71, 1573248
    ds_read_b64_tr_b16 a[214:215], v192 offset:29184
    v_mul_f32 v75, s75, v75
    v_mfma_f32_16x16x32_bf16 v[128:131], a[196:199], a[164:167], v[128:131]
    buffer_load_dwordx4 v204, s[16:19], s73 offen offset:0 lds
    v_mfma_f32_16x16x32_bf16 v[132:135], a[200:203], a[144:147], v[132:135]
    ds_read_b64_tr_b16 a[192:193], v193 offset:24576
    v_cvt_pk_bf16_f32 v72, v72, v73
    v_mfma_f32_16x16x32_bf16 v[132:135], a[204:207], a[156:159], v[132:135]
    ds_read_b64_tr_b16 a[194:195], v193 offset:25088
    v_cvt_pk_bf16_f32 v73, v74, v75
    v_mfma_f32_16x16x32_bf16 v[136:139], a[200:203], a[148:151], v[136:139]
    ds_read_b64_tr_b16 a[196:197], v193 offset:28672
    v_mul_f32 v84, s75, v84
    v_mfma_f32_16x16x32_bf16 v[136:139], a[204:207], a[160:163], v[136:139]
    ds_read_b64_tr_b16 a[198:199], v193 offset:29184
    v_mul_f32 v85, s75, v85
    v_mfma_f32_16x16x32_bf16 v[140:143], a[200:203], a[152:155], v[140:143]
    v_mul_f32 v86, s75, v86
    v_mul_f32 v87, s75, v87
    v_mfma_f32_16x16x32_bf16 v[140:143], a[204:207], a[164:167], v[140:143]
    s_waitcnt lgkmcnt(4)
    buffer_load_dwordx4 v205, s[16:19], s73 offen offset:1024 lds
    v_mfma_f32_16x16x32_bf16 v[96:99], a[208:211], a[168:171], v[96:99]
    ds_read_b64_tr_b16 a[200:201], v194 offset:24576
    v_cvt_pk_bf16_f32 v84, v84, v85
    v_mfma_f32_16x16x32_bf16 v[96:99], a[212:215], a[180:183], v[96:99]
    ds_read_b64_tr_b16 a[202:203], v194 offset:25088
    v_cvt_pk_bf16_f32 v85, v86, v87
    v_mfma_f32_16x16x32_bf16 v[100:103], a[208:211], a[172:175], v[100:103]
    ds_read_b64_tr_b16 a[204:205], v194 offset:28672
    v_mfma_f32_16x16x32_bf16 v[100:103], a[212:215], a[184:187], v[100:103]
    ds_read_b64_tr_b16 a[206:207], v194 offset:29184
    v_mfma_f32_16x16x32_bf16 v[104:107], a[208:211], a[176:179], v[104:107]
    v_permlane16_swap_b32 v72, v84
    v_mfma_f32_16x16x32_bf16 v[104:107], a[212:215], a[188:191], v[104:107]
    s_waitcnt lgkmcnt(4)
    buffer_load_dwordx4 v206, s[16:19], s73 offen offset:2048 lds
    v_mfma_f32_16x16x32_bf16 v[108:111], a[192:195], a[168:171], v[108:111]
    ds_read_b64_tr_b16 a[208:209], v195 offset:24576
    v_mul_f32 v96, s75, v96
    v_mfma_f32_16x16x32_bf16 v[108:111], a[196:199], a[180:183], v[108:111]
    ds_read_b64_tr_b16 a[210:211], v195 offset:25088
    v_mul_f32 v97, s75, v97
    v_mfma_f32_16x16x32_bf16 v[112:115], a[192:195], a[172:175], v[112:115]
    ds_read_b64_tr_b16 a[212:213], v195 offset:28672
    v_mul_f32 v98, s75, v98
    v_mfma_f32_16x16x32_bf16 v[112:115], a[196:199], a[184:187], v[112:115]
    ds_read_b64_tr_b16 a[214:215], v195 offset:29184
    v_mul_f32 v99, s75, v99
    v_mfma_f32_16x16x32_bf16 v[116:119], a[192:195], a[176:179], v[116:119]
    v_permlane16_swap_b32 v73, v85
    v_mfma_f32_16x16x32_bf16 v[116:119], a[196:199], a[188:191], v[116:119]
    s_waitcnt lgkmcnt(4)
    buffer_load_dwordx4 v207, s[16:19], s73 offen offset:3072 lds
    v_mfma_f32_16x16x32_bf16 v[120:123], a[200:203], a[168:171], v[120:123]
    v_mul_f32 v76, s75, v76
    v_mul_f32 v77, s75, v77
    v_mfma_f32_16x16x32_bf16 v[120:123], a[204:207], a[180:183], v[120:123]
    s_waitcnt vmcnt(16) lgkmcnt(0)
    v_mul_f32 v78, s75, v78
    v_mul_f32 v79, s75, v79
    v_mfma_f32_16x16x32_bf16 v[124:127], a[200:203], a[172:175], v[124:127]
    s_barrier
    ds_read_b64_tr_b16 a[192:193], v196 offset:24576
    ds_read_b64_tr_b16 a[194:195], v196 offset:25088
    v_mfma_f32_16x16x32_bf16 v[124:127], a[204:207], a[184:187], v[124:127]
    s_add_u32 m0, s68, 24576
    ds_read_b64_tr_b16 a[196:197], v196 offset:28672
    v_cvt_pk_bf16_f32 v76, v76, v77
    v_mfma_f32_16x16x32_bf16 v[128:131], a[200:203], a[176:179], v[128:131]
    s_xor_b32 s73, s71, 2097536
    ds_read_b64_tr_b16 a[198:199], v196 offset:29184
    v_cvt_pk_bf16_f32 v77, v78, v79
    v_mfma_f32_16x16x32_bf16 v[128:131], a[204:207], a[188:191], v[128:131]
    buffer_load_dwordx4 v204, s[16:19], s73 offen offset:0 lds
    v_mfma_f32_16x16x32_bf16 v[132:135], a[208:211], a[168:171], v[132:135]
    ds_read_b64_tr_b16 a[200:201], v197 offset:24576
    v_mul_f32 v88, s75, v88
    v_mfma_f32_16x16x32_bf16 v[132:135], a[212:215], a[180:183], v[132:135]
    ds_read_b64_tr_b16 a[202:203], v197 offset:25088
    v_mul_f32 v89, s75, v89
    v_mfma_f32_16x16x32_bf16 v[136:139], a[208:211], a[172:175], v[136:139]
    ds_read_b64_tr_b16 a[204:205], v197 offset:28672
    v_mul_f32 v90, s75, v90
    v_mfma_f32_16x16x32_bf16 v[136:139], a[212:215], a[184:187], v[136:139]
    ds_read_b64_tr_b16 a[206:207], v197 offset:29184
    v_mul_f32 v91, s75, v91
    v_mfma_f32_16x16x32_bf16 v[140:143], a[208:211], a[176:179], v[140:143]
    v_cvt_pk_bf16_f32 v88, v88, v89
    v_cvt_pk_bf16_f32 v89, v90, v91
    v_mfma_f32_16x16x32_bf16 v[140:143], a[212:215], a[188:191], v[140:143]
    s_waitcnt lgkmcnt(4)
    buffer_load_dwordx4 v205, s[16:19], s73 offen offset:1024 lds
    v_mfma_f32_16x16x32_bf16 v[144:147], a[192:195], a[0:3], 0
    ds_read_b64_tr_b16 a[208:209], v198 offset:24576
    v_cvt_pk_bf16_f32 v96, v96, v97
    v_mfma_f32_16x16x32_bf16 v[144:147], a[196:199], a[12:15], v[144:147]
    ds_read_b64_tr_b16 a[210:211], v198 offset:25088
    v_cvt_pk_bf16_f32 v97, v98, v99
    v_mfma_f32_16x16x32_bf16 v[148:151], a[192:195], a[4:7], 0
    ds_read_b64_tr_b16 a[212:213], v198 offset:28672
    v_mul_f32 v108, s75, v108
    v_mfma_f32_16x16x32_bf16 v[148:151], a[196:199], a[16:19], v[148:151]
    ds_read_b64_tr_b16 a[214:215], v198 offset:29184
    v_mul_f32 v109, s75, v109
    v_mfma_f32_16x16x32_bf16 v[152:155], a[192:195], a[8:11], 0
    v_permlane16_swap_b32 v76, v88
    v_mfma_f32_16x16x32_bf16 v[152:155], a[196:199], a[20:23], v[152:155]
    s_waitcnt lgkmcnt(4)
    buffer_load_dwordx4 v206, s[16:19], s73 offen offset:2048 lds
    v_mfma_f32_16x16x32_bf16 v[156:159], a[200:203], a[0:3], 0
    ds_read_b64_tr_b16 a[192:193], v199 offset:24576
    v_mul_f32 v110, s75, v110
    v_mfma_f32_16x16x32_bf16 v[156:159], a[204:207], a[12:15], v[156:159]
    ds_read_b64_tr_b16 a[194:195], v199 offset:25088
    v_mul_f32 v111, s75, v111
    v_mfma_f32_16x16x32_bf16 v[160:163], a[200:203], a[4:7], 0
    ds_read_b64_tr_b16 a[196:197], v199 offset:28672
    v_cvt_pk_bf16_f32 v108, v108, v109
    v_mfma_f32_16x16x32_bf16 v[160:163], a[204:207], a[16:19], v[160:163]
    ds_read_b64_tr_b16 a[198:199], v199 offset:29184
    v_cvt_pk_bf16_f32 v109, v110, v111
    v_mfma_f32_16x16x32_bf16 v[164:167], a[200:203], a[8:11], 0
    v_permlane16_swap_b32 v77, v89
    v_mfma_f32_16x16x32_bf16 v[164:167], a[204:207], a[20:23], v[164:167]
    s_waitcnt lgkmcnt(4)
    buffer_load_dwordx4 v207, s[16:19], s73 offen offset:3072 lds
    v_mfma_f32_16x16x32_bf16 v[168:171], a[208:211], a[0:3], 0
    v_mul_f32 v80, s75, v80
    v_mul_f32 v81, s75, v81
    v_mfma_f32_16x16x32_bf16 v[168:171], a[212:215], a[12:15], v[168:171]
    s_waitcnt vmcnt(16) lgkmcnt(0)
    v_mul_f32 v82, s75, v82
    v_mul_f32 v83, s75, v83
    v_mfma_f32_16x16x32_bf16 v[172:175], a[208:211], a[4:7], 0
    s_barrier
    ds_read_b64_tr_b16 a[200:201], v192 offset:32768
    ds_read_b64_tr_b16 a[202:203], v192 offset:33280
    v_mfma_f32_16x16x32_bf16 v[172:175], a[212:215], a[16:19], v[172:175]
    s_add_u32 m0, s68, 106496
    ds_read_b64_tr_b16 a[204:205], v192 offset:36864
    v_cvt_pk_bf16_f32 v80, v80, v81
    v_mfma_f32_16x16x32_bf16 v[176:179], a[208:211], a[8:11], 0
    s_xor_b32 s73, s71, 2621824
    ds_read_b64_tr_b16 a[206:207], v192 offset:37376
    v_cvt_pk_bf16_f32 v81, v82, v83
    v_mfma_f32_16x16x32_bf16 v[176:179], a[212:215], a[20:23], v[176:179]
    buffer_load_dwordx4 v204, s[16:19], s73 offen offset:0 lds
    v_mfma_f32_16x16x32_bf16 v[180:183], a[192:195], a[0:3], 0
    ds_read_b64_tr_b16 a[208:209], v193 offset:32768
    v_mul_f32 v92, s75, v92
    v_mfma_f32_16x16x32_bf16 v[180:183], a[196:199], a[12:15], v[180:183]
    ds_read_b64_tr_b16 a[210:211], v193 offset:33280
    v_mul_f32 v93, s75, v93
    v_mfma_f32_16x16x32_bf16 v[184:187], a[192:195], a[4:7], 0
    ds_read_b64_tr_b16 a[212:213], v193 offset:36864
    v_mul_f32 v94, s75, v94
    v_mfma_f32_16x16x32_bf16 v[184:187], a[196:199], a[16:19], v[184:187]
    ds_read_b64_tr_b16 a[214:215], v193 offset:37376
    v_mul_f32 v95, s75, v95
    v_mfma_f32_16x16x32_bf16 v[188:191], a[192:195], a[8:11], 0
    v_cvt_pk_bf16_f32 v82, v92, v93
    v_cvt_pk_bf16_f32 v83, v94, v95
    v_mfma_f32_16x16x32_bf16 v[188:191], a[196:199], a[20:23], v[188:191]
    s_waitcnt lgkmcnt(4)
    buffer_load_dwordx4 v205, s[16:19], s73 offen offset:1024 lds
    v_mfma_f32_16x16x32_bf16 v[144:147], a[200:203], a[24:27], v[144:147]
    ds_read_b64_tr_b16 a[192:193], v194 offset:32768
    v_accvgpr_write_b32 a0, v0
    v_mfma_f32_16x16x32_bf16 v[144:147], a[204:207], a[36:39], v[144:147]
    ds_read_b64_tr_b16 a[194:195], v194 offset:33280
    v_accvgpr_write_b32 a1, v1
    v_mfma_f32_16x16x32_bf16 v[148:151], a[200:203], a[28:31], v[148:151]
    ds_read_b64_tr_b16 a[196:197], v194 offset:36864
    v_accvgpr_write_b32 a2, v12
    v_mfma_f32_16x16x32_bf16 v[148:151], a[204:207], a[40:43], v[148:151]
    ds_read_b64_tr_b16 a[198:199], v194 offset:37376
    v_accvgpr_write_b32 a3, v13
    v_mfma_f32_16x16x32_bf16 v[152:155], a[200:203], a[32:35], v[152:155]
    v_permlane16_swap_b32 v80, v82
    v_mfma_f32_16x16x32_bf16 v[152:155], a[204:207], a[44:47], v[152:155]
    s_waitcnt lgkmcnt(4)
    buffer_load_dwordx4 v206, s[16:19], s73 offen offset:2048 lds
    v_mfma_f32_16x16x32_bf16 v[156:159], a[208:211], a[24:27], v[156:159]
    ds_read_b64_tr_b16 a[200:201], v195 offset:32768
    v_accvgpr_write_b32 a4, v4
    v_mfma_f32_16x16x32_bf16 v[156:159], a[212:215], a[36:39], v[156:159]
    ds_read_b64_tr_b16 a[202:203], v195 offset:33280
    v_accvgpr_write_b32 a5, v5
    v_mfma_f32_16x16x32_bf16 v[160:163], a[208:211], a[28:31], v[160:163]
    ds_read_b64_tr_b16 a[204:205], v195 offset:36864
    v_accvgpr_write_b32 a6, v16
    v_mfma_f32_16x16x32_bf16 v[160:163], a[212:215], a[40:43], v[160:163]
    ds_read_b64_tr_b16 a[206:207], v195 offset:37376
    v_accvgpr_write_b32 a7, v17
    v_mfma_f32_16x16x32_bf16 v[164:167], a[208:211], a[32:35], v[164:167]
    v_permlane16_swap_b32 v81, v83
    v_mfma_f32_16x16x32_bf16 v[164:167], a[212:215], a[44:47], v[164:167]
    s_waitcnt lgkmcnt(4)
    buffer_load_dwordx4 v207, s[16:19], s73 offen offset:3072 lds
    v_mfma_f32_16x16x32_bf16 v[168:171], a[192:195], a[24:27], v[168:171]
    s_add_u32 m0, s68, 32768
    v_accvgpr_write_b32 a8, v8
    v_accvgpr_write_b32 a9, v9
    v_mfma_f32_16x16x32_bf16 v[168:171], a[196:199], a[36:39], v[168:171]
    s_waitcnt vmcnt(16) lgkmcnt(0)
    v_accvgpr_write_b32 a10, v20
    v_accvgpr_write_b32 a11, v21
    v_mfma_f32_16x16x32_bf16 v[172:175], a[192:195], a[28:31], v[172:175]
    s_barrier
    ds_read_b64_tr_b16 a[208:209], v196 offset:32768
    ds_read_b64_tr_b16 a[210:211], v196 offset:33280
    v_mfma_f32_16x16x32_bf16 v[172:175], a[196:199], a[40:43], v[172:175]
    s_xor_b32 s73, s71, 3146112
    ds_read_b64_tr_b16 a[212:213], v196 offset:36864
    v_accvgpr_write_b32 a12, v24
    v_mfma_f32_16x16x32_bf16 v[176:179], a[192:195], a[32:35], v[176:179]
    buffer_load_dwordx4 v204, s[16:19], s73 offen offset:0 lds
    v_mfma_f32_16x16x32_bf16 v[176:179], a[196:199], a[44:47], v[176:179]
    ds_read_b64_tr_b16 a[214:215], v196 offset:37376
    v_accvgpr_write_b32 a13, v25
    v_mfma_f32_16x16x32_bf16 v[180:183], a[200:203], a[24:27], v[180:183]
    ds_read_b64_tr_b16 a[192:193], v197 offset:32768
    ds_read_b64_tr_b16 a[194:195], v197 offset:33280
    v_mfma_f32_16x16x32_bf16 v[180:183], a[204:207], a[36:39], v[180:183]
    buffer_load_dwordx4 v205, s[16:19], s73 offen offset:1024 lds
    v_mfma_f32_16x16x32_bf16 v[184:187], a[200:203], a[28:31], v[184:187]
    ds_read_b64_tr_b16 a[196:197], v197 offset:36864
    v_accvgpr_write_b32 a14, v36
    v_mfma_f32_16x16x32_bf16 v[184:187], a[204:207], a[40:43], v[184:187]
    buffer_load_dwordx4 v206, s[16:19], s73 offen offset:2048 lds
    v_mfma_f32_16x16x32_bf16 v[188:191], a[200:203], a[32:35], v[188:191]
    ds_read_b64_tr_b16 a[198:199], v197 offset:37376
    v_accvgpr_write_b32 a15, v37
    v_mfma_f32_16x16x32_bf16 v[188:191], a[204:207], a[44:47], v[188:191]
    s_waitcnt lgkmcnt(4)
    v_accvgpr_write_b32 a16, v28
    v_accvgpr_write_b32 a17, v29
    v_mfma_f32_16x16x32_bf16 v[144:147], a[208:211], a[48:51], v[144:147]
    buffer_load_dwordx4 v207, s[16:19], s73 offen offset:3072 lds
    v_mfma_f32_16x16x32_bf16 v[144:147], a[212:215], a[60:63], v[144:147]
    s_xor_b32 s74, s38, 40960
    ds_read_b64_tr_b16 a[200:201], v198 offset:32768
    ds_read_b64_tr_b16 a[202:203], v198 offset:33280
    v_mfma_f32_16x16x32_bf16 v[148:151], a[208:211], a[52:55], v[148:151]
    ds_read_b64_tr_b16 a[204:205], v198 offset:36864
    v_accvgpr_write_b32 a24, v48
    v_mfma_f32_16x16x32_bf16 v[148:151], a[212:215], a[64:67], v[148:151]
    buffer_load_dwordx4 v[92:95], v255, s[12:15], s74 offen offset:3072 nt
    v_mfma_f32_16x16x32_bf16 v[152:155], a[208:211], a[56:59], v[152:155]
    s_add_u32 m0, s68, 90112
    ds_read_b64_tr_b16 a[206:207], v198 offset:37376
    v_accvgpr_write_b32 a25, v49
    v_mfma_f32_16x16x32_bf16 v[152:155], a[212:215], a[68:71], v[152:155]
    s_waitcnt lgkmcnt(4)
    s_xor_b32 s74, s38, 8192
    buffer_load_dwordx4 v253, s[12:15], s74 offen offset:1024 nt lds
    v_mfma_f32_16x16x32_bf16 v[156:159], a[192:195], a[48:51], v[156:159]
    ds_read_b64_tr_b16 a[208:209], v199 offset:32768
    ds_read_b64_tr_b16 a[210:211], v199 offset:33280
    v_mfma_f32_16x16x32_bf16 v[156:159], a[196:199], a[60:63], v[156:159]
    ds_read_b64_tr_b16 a[212:213], v199 offset:36864
    v_accvgpr_write_b32 a26, v60
    v_mfma_f32_16x16x32_bf16 v[160:163], a[192:195], a[52:55], v[160:163]
    buffer_load_dwordx4 v254, s[12:15], s74 offen offset:2048 nt lds
    v_mfma_f32_16x16x32_bf16 v[160:163], a[196:199], a[64:67], v[160:163]
    ds_read_b64_tr_b16 a[214:215], v199 offset:37376
    v_accvgpr_write_b32 a27, v61
    v_mfma_f32_16x16x32_bf16 v[164:167], a[192:195], a[56:59], v[164:167]
    buffer_load_dwordx4 v255, s[12:15], s74 offen offset:3072 nt lds
    v_mfma_f32_16x16x32_bf16 v[164:167], a[196:199], a[68:71], v[164:167]
    s_waitcnt lgkmcnt(4)
    v_accvgpr_write_b32 a28, v52
    v_accvgpr_write_b32 a29, v53
    v_mfma_f32_16x16x32_bf16 v[168:171], a[200:203], a[48:51], v[168:171]
    v_accvgpr_write_b32 a30, v64
    v_accvgpr_write_b32 a31, v65
    v_mfma_f32_16x16x32_bf16 v[168:171], a[204:207], a[60:63], v[168:171]
    s_waitcnt vmcnt(16) lgkmcnt(0)
    v_accvgpr_write_b32 a32, v56
    v_accvgpr_write_b32 a33, v57
    v_mfma_f32_16x16x32_bf16 v[172:175], a[200:203], a[52:55], v[172:175]
    s_barrier
    ds_read_b64_tr_b16 a[192:193], v196 offset:16384
    ds_read_b64_tr_b16 a[194:195], v196 offset:16896
    v_mfma_f32_16x16x32_bf16 v[172:175], a[204:207], a[64:67], v[172:175]
    s_add_u32 m0, s68, 114688
    ds_read_b64_tr_b16 a[196:197], v196 offset:20480
    v_accvgpr_write_b32 a34, v68
    v_mfma_f32_16x16x32_bf16 v[176:179], a[200:203], a[56:59], v[176:179]
    s_xor_b32 s73, s71, 3670400
    ds_read_b64_tr_b16 a[198:199], v196 offset:20992
    v_accvgpr_write_b32 a35, v69
    v_mfma_f32_16x16x32_bf16 v[176:179], a[204:207], a[68:71], v[176:179]
    buffer_load_dwordx4 v204, s[16:19], s73 offen offset:0 lds
    v_mfma_f32_16x16x32_bf16 v[180:183], a[208:211], a[48:51], v[180:183]
    ds_read_b64_tr_b16 a[200:201], v197 offset:16384
    v_accvgpr_write_b32 a36, v72
    v_mfma_f32_16x16x32_bf16 v[180:183], a[212:215], a[60:63], v[180:183]
    ds_read_b64_tr_b16 a[202:203], v197 offset:16896
    v_accvgpr_write_b32 a37, v73
    v_mfma_f32_16x16x32_bf16 v[184:187], a[208:211], a[52:55], v[184:187]
    ds_read_b64_tr_b16 a[204:205], v197 offset:20480
    v_accvgpr_write_b32 a38, v84
    v_mfma_f32_16x16x32_bf16 v[184:187], a[212:215], a[64:67], v[184:187]
    ds_read_b64_tr_b16 a[206:207], v197 offset:20992
    v_accvgpr_write_b32 a39, v85
    v_mfma_f32_16x16x32_bf16 v[188:191], a[208:211], a[56:59], v[188:191]
    v_accvgpr_write_b32 a18, v40
    v_accvgpr_write_b32 a19, v41
    v_mfma_f32_16x16x32_bf16 v[188:191], a[212:215], a[68:71], v[188:191]
    s_waitcnt lgkmcnt(4)
    buffer_load_dwordx4 v205, s[16:19], s73 offen offset:1024 lds
    v_mfma_f32_16x16x32_bf16 v[144:147], a[192:195], a[72:75], v[144:147]
    ds_read_b64_tr_b16 a[208:209], v198 offset:16384
    v_accvgpr_read_b32 v210, a246
    v_mfma_f32_16x16x32_bf16 v[144:147], a[196:199], a[84:87], v[144:147]
    ds_read_b64_tr_b16 a[210:211], v198 offset:16896
    v_and_b32 v210, 0x70, v210
    v_mfma_f32_16x16x32_bf16 v[148:151], a[192:195], a[76:79], v[148:151]
    ds_read_b64_tr_b16 a[212:213], v198 offset:20480
    v_lshlrev_b32 v210, 8, v210
    v_mfma_f32_16x16x32_bf16 v[148:151], a[196:199], a[88:91], v[148:151]
    ds_read_b64_tr_b16 a[214:215], v198 offset:20992
    v_xor_b32 v210, s35, v210
    v_mfma_f32_16x16x32_bf16 v[152:155], a[192:195], a[80:83], v[152:155]
    v_accvgpr_write_b32 a40, v76
    v_accvgpr_write_b32 a41, v77
    v_mfma_f32_16x16x32_bf16 v[152:155], a[196:199], a[92:95], v[152:155]
    s_waitcnt lgkmcnt(4)
    buffer_load_dwordx4 v206, s[16:19], s73 offen offset:2048 lds
    v_mfma_f32_16x16x32_bf16 v[156:159], a[200:203], a[72:75], v[156:159]
    ds_read_b64_tr_b16 a[192:193], v199 offset:16384
    v_accvgpr_write_b32 a42, v88
    v_mfma_f32_16x16x32_bf16 v[156:159], a[204:207], a[84:87], v[156:159]
    ds_read_b64_tr_b16 a[194:195], v199 offset:16896
    v_accvgpr_write_b32 a43, v89
    v_mfma_f32_16x16x32_bf16 v[160:163], a[200:203], a[76:79], v[160:163]
    ds_read_b64_tr_b16 a[196:197], v199 offset:20480
    v_accvgpr_write_b32 a20, v32
    v_mfma_f32_16x16x32_bf16 v[160:163], a[204:207], a[88:91], v[160:163]
    ds_read_b64_tr_b16 a[198:199], v199 offset:20992
    v_accvgpr_write_b32 a21, v33
    v_mfma_f32_16x16x32_bf16 v[164:167], a[200:203], a[80:83], v[164:167]
    v_accvgpr_write_b32 a22, v44
    v_accvgpr_write_b32 a23, v45
    v_mfma_f32_16x16x32_bf16 v[164:167], a[204:207], a[92:95], v[164:167]
    s_waitcnt lgkmcnt(4)
    buffer_load_dwordx4 v207, s[16:19], s73 offen offset:3072 lds
    v_mfma_f32_16x16x32_bf16 v[168:171], a[208:211], a[72:75], v[168:171]
    v_accvgpr_write_b32 a44, v80
    v_accvgpr_write_b32 a45, v81
    v_mfma_f32_16x16x32_bf16 v[168:171], a[212:215], a[84:87], v[168:171]
    s_waitcnt vmcnt(16) lgkmcnt(0)
    v_accvgpr_write_b32 a46, v82
    v_accvgpr_write_b32 a47, v83
    v_mfma_f32_16x16x32_bf16 v[172:175], a[208:211], a[76:79], v[172:175]
    s_barrier
    ds_read_b64_tr_b16 a[200:201], v192 offset:24576
    ds_read_b64_tr_b16 a[202:203], v192 offset:25088
    v_mfma_f32_16x16x32_bf16 v[172:175], a[212:215], a[88:91], v[172:175]
    s_add_u32 m0, s68, 98304
    ds_read_b64_tr_b16 a[204:205], v192 offset:28672
    v_mfma_f32_16x16x32_bf16 v[176:179], a[208:211], a[80:83], v[176:179]
    s_xor_b32 s74, s38, 16384
    ds_read_b64_tr_b16 a[206:207], v192 offset:29184
    v_mfma_f32_16x16x32_bf16 v[176:179], a[212:215], a[92:95], v[176:179]
    buffer_load_dwordx4 v252, s[12:15], s74 offen offset:0 nt lds
    v_mfma_f32_16x16x32_bf16 v[180:183], a[192:195], a[72:75], v[180:183]
    ds_read_b64_tr_b16 a[208:209], v193 offset:24576
    v_mfma_f32_16x16x32_bf16 v[180:183], a[196:199], a[84:87], v[180:183]
    buffer_load_dword a247, v210, s[24:27], 0 offen sc1
    v_mfma_f32_16x16x32_bf16 v[184:187], a[192:195], a[76:79], v[184:187]
    ds_read_b64_tr_b16 a[210:211], v193 offset:25088
    v_mfma_f32_16x16x32_bf16 v[184:187], a[196:199], a[88:91], v[184:187]
    ds_read_b64_tr_b16 a[212:213], v193 offset:28672
    v_mfma_f32_16x16x32_bf16 v[188:191], a[192:195], a[80:83], v[188:191]
    ds_read_b64_tr_b16 a[214:215], v193 offset:29184
    v_mfma_f32_16x16x32_bf16 v[188:191], a[196:199], a[92:95], v[188:191]
    s_waitcnt lgkmcnt(4)
    buffer_load_dwordx4 v253, s[12:15], s74 offen offset:1024 nt lds
    v_mfma_f32_16x16x32_bf16 v[144:147], a[200:203], a[96:99], v[144:147]
    ds_read_b64_tr_b16 a[192:193], v194 offset:24576
    v_mfma_f32_16x16x32_bf16 v[144:147], a[204:207], a[108:111], v[144:147]
    ds_read_b64_tr_b16 a[194:195], v194 offset:25088
    v_mfma_f32_16x16x32_bf16 v[148:151], a[200:203], a[100:103], v[148:151]
    ds_read_b64_tr_b16 a[196:197], v194 offset:28672
    v_mfma_f32_16x16x32_bf16 v[148:151], a[204:207], a[112:115], v[148:151]
    ds_read_b64_tr_b16 a[198:199], v194 offset:29184
    v_mfma_f32_16x16x32_bf16 v[152:155], a[200:203], a[104:107], v[152:155]
    v_permlane16_swap_b32 v96, v108
    v_mfma_f32_16x16x32_bf16 v[152:155], a[204:207], a[116:119], v[152:155]
    s_waitcnt lgkmcnt(4)
    buffer_load_dwordx4 v254, s[12:15], s74 offen offset:2048 nt lds
    v_mfma_f32_16x16x32_bf16 v[156:159], a[208:211], a[96:99], v[156:159]
    ds_read_b64_tr_b16 a[200:201], v195 offset:24576
    v_mfma_f32_16x16x32_bf16 v[156:159], a[212:215], a[108:111], v[156:159]
    ds_read_b64_tr_b16 a[202:203], v195 offset:25088
    v_mfma_f32_16x16x32_bf16 v[160:163], a[208:211], a[100:103], v[160:163]
    ds_read_b64_tr_b16 a[204:205], v195 offset:28672
    v_mfma_f32_16x16x32_bf16 v[160:163], a[212:215], a[112:115], v[160:163]
    ds_read_b64_tr_b16 a[206:207], v195 offset:29184
    v_mfma_f32_16x16x32_bf16 v[164:167], a[208:211], a[104:107], v[164:167]
    v_permlane16_swap_b32 v97, v109
    v_mfma_f32_16x16x32_bf16 v[164:167], a[212:215], a[116:119], v[164:167]
    s_waitcnt lgkmcnt(4)
    buffer_load_dwordx4 v255, s[12:15], s74 offen offset:3072 nt lds
    v_mfma_f32_16x16x32_bf16 v[168:171], a[192:195], a[96:99], v[168:171]
    v_accvgpr_write_b32 a48, v96
    v_accvgpr_write_b32 a49, v97
    v_mfma_f32_16x16x32_bf16 v[168:171], a[196:199], a[108:111], v[168:171]
    s_waitcnt vmcnt(17) lgkmcnt(0)
    v_accvgpr_write_b32 a50, v108
    v_accvgpr_write_b32 a51, v109
    v_mfma_f32_16x16x32_bf16 v[172:175], a[192:195], a[100:103], v[172:175]
    s_barrier
    ds_read_b64_tr_b16 a[208:209], v196 offset:24576
    ds_read_b64_tr_b16 a[210:211], v196 offset:25088
    v_mfma_f32_16x16x32_bf16 v[172:175], a[196:199], a[112:115], v[172:175]
    s_add_u32 m0, s68, 24576
    ds_read_b64_tr_b16 a[212:213], v196 offset:28672
    v_mul_f32 v100, s75, v100
    v_mfma_f32_16x16x32_bf16 v[176:179], a[192:195], a[104:107], v[176:179]
    s_xor_b32 s74, s38, 24576
    ds_read_b64_tr_b16 a[214:215], v196 offset:29184
    v_mul_f32 v101, s75, v101
    v_mfma_f32_16x16x32_bf16 v[176:179], a[196:199], a[116:119], v[176:179]
    buffer_load_dwordx4 v252, s[8:11], s74 offen offset:0 nt lds
    v_mfma_f32_16x16x32_bf16 v[180:183], a[200:203], a[96:99], v[180:183]
    ds_read_b64_tr_b16 a[192:193], v197 offset:24576
    v_mul_f32 v102, s75, v102
    v_mfma_f32_16x16x32_bf16 v[180:183], a[204:207], a[108:111], v[180:183]
L_hopa_3:
    s_cbranch_execz L_backa
    ds_read_b64_tr_b16 a[194:195], v197 offset:25088
    v_mul_f32 v103, s75, v103
    v_mfma_f32_16x16x32_bf16 v[184:187], a[200:203], a[100:103], v[184:187]
    ds_read_b64_tr_b16 a[196:197], v197 offset:28672
    v_cvt_pk_bf16_f32 v100, v100, v101
    v_mfma_f32_16x16x32_bf16 v[184:187], a[204:207], a[112:115], v[184:187]
    ds_read_b64_tr_b16 a[198:199], v197 offset:29184
    v_cvt_pk_bf16_f32 v101, v102, v103
    v_mfma_f32_16x16x32_bf16 v[188:191], a[200:203], a[104:107], v[188:191]
    v_mul_f32 v112, s75, v112
    v_mul_f32 v113, s75, v113
    v_mfma_f32_16x16x32_bf16 v[188:191], a[204:207], a[116:119], v[188:191]
    s_waitcnt lgkmcnt(4)
    buffer_load_dwordx4 v253, s[8:11], s74 offen offset:1024 nt lds
    v_mfma_f32_16x16x32_bf16 v[144:147], a[208:211], a[120:123], v[144:147]
    ds_read_b64_tr_b16 a[200:201], v198 offset:24576
    v_mul_f32 v114, s75, v114
    v_mfma_f32_16x16x32_bf16 v[144:147], a[212:215], a[132:135], v[144:147]
    ds_read_b64_tr_b16 a[202:203], v198 offset:25088
    v_mul_f32 v115, s75, v115
    v_mfma_f32_16x16x32_bf16 v[148:151], a[208:211], a[124:127], v[148:151]
    ds_read_b64_tr_b16 a[204:205], v198 offset:28672
    v_cvt_pk_bf16_f32 v112, v112, v113
    v_mfma_f32_16x16x32_bf16 v[148:151], a[212:215], a[136:139], v[148:151]
    ds_read_b64_tr_b16 a[206:207], v198 offset:29184
    v_cvt_pk_bf16_f32 v113, v114, v115
    v_mfma_f32_16x16x32_bf16 v[152:155], a[208:211], a[128:131], v[152:155]
    v_permlane16_swap_b32 v100, v112
    v_mfma_f32_16x16x32_bf16 v[152:155], a[212:215], a[140:143], v[152:155]
    s_waitcnt lgkmcnt(4)
    buffer_load_dwordx4 v254, s[8:11], s74 offen offset:2048 nt lds
    v_mfma_f32_16x16x32_bf16 v[156:159], a[192:195], a[120:123], v[156:159]
    ds_read_b64_tr_b16 a[208:209], v199 offset:24576
    v_mfma_f32_16x16x32_bf16 v[156:159], a[196:199], a[132:135], v[156:159]
    ds_read_b64_tr_b16 a[210:211], v199 offset:25088
    v_mfma_f32_16x16x32_bf16 v[160:163], a[192:195], a[124:127], v[160:163]
    ds_read_b64_tr_b16 a[212:213], v199 offset:28672
    v_mfma_f32_16x16x32_bf16 v[160:163], a[196:199], a[136:139], v[160:163]
    ds_read_b64_tr_b16 a[214:215], v199 offset:29184
    v_mfma_f32_16x16x32_bf16 v[164:167], a[192:195], a[128:131], v[164:167]
    v_permlane16_swap_b32 v101, v113
    v_mfma_f32_16x16x32_bf16 v[164:167], a[196:199], a[140:143], v[164:167]
    s_waitcnt lgkmcnt(4)
    buffer_load_dwordx4 v255, s[8:11], s74 offen offset:3072 nt lds
    v_mfma_f32_16x16x32_bf16 v[168:171], a[200:203], a[120:123], v[168:171]
    v_accvgpr_write_b32 a52, v100
    v_accvgpr_write_b32 a53, v101
    v_mfma_f32_16x16x32_bf16 v[168:171], a[204:207], a[132:135], v[168:171]
    s_waitcnt vmcnt(17) lgkmcnt(0)
    v_accvgpr_write_b32 a54, v112
    v_accvgpr_write_b32 a55, v113
    v_mfma_f32_16x16x32_bf16 v[172:175], a[200:203], a[124:127], v[172:175]
    s_barrier
    ds_read_b64_tr_b16 a[192:193], v192 offset:32768
    ds_read_b64_tr_b16 a[194:195], v192 offset:33280
    v_mfma_f32_16x16x32_bf16 v[172:175], a[204:207], a[136:139], v[172:175]
    s_add_u32 m0, s68, 106496
    ds_read_b64_tr_b16 a[196:197], v192 offset:36864
    v_mul_f32 v104, s75, v104
    v_mfma_f32_16x16x32_bf16 v[176:179], a[200:203], a[128:131], v[176:179]
    s_xor_b32 s74, s38, 24576
    ds_read_b64_tr_b16 a[198:199], v192 offset:37376
    v_mul_f32 v105, s75, v105
    v_mfma_f32_16x16x32_bf16 v[176:179], a[204:207], a[140:143], v[176:179]
    buffer_load_dwordx4 v252, s[12:15], s74 offen offset:0 nt lds
    v_mfma_f32_16x16x32_bf16 v[180:183], a[208:211], a[120:123], v[180:183]
    ds_read_b64_tr_b16 a[200:201], v193 offset:32768
    v_mul_f32 v106, s75, v106
    v_mfma_f32_16x16x32_bf16 v[180:183], a[212:215], a[132:135], v[180:183]
    ds_read_b64_tr_b16 a[202:203], v193 offset:33280
    v_mul_f32 v107, s75, v107
    v_mfma_f32_16x16x32_bf16 v[184:187], a[208:211], a[124:127], v[184:187]
    ds_read_b64_tr_b16 a[204:205], v193 offset:36864
    v_cvt_pk_bf16_f32 v104, v104, v105
    v_mfma_f32_16x16x32_bf16 v[184:187], a[212:215], a[136:139], v[184:187]
    ds_read_b64_tr_b16 a[206:207], v193 offset:37376
    v_cvt_pk_bf16_f32 v105, v106, v107
    v_mfma_f32_16x16x32_bf16 v[188:191], a[208:211], a[128:131], v[188:191]
    v_mul_f32 v116, s75, v116
    v_mul_f32 v117, s75, v117
    v_mfma_f32_16x16x32_bf16 v[188:191], a[212:215], a[140:143], v[188:191]
    s_waitcnt lgkmcnt(4)
    buffer_load_dwordx4 v253, s[12:15], s74 offen offset:1024 nt lds
    v_mfma_f32_16x16x32_bf16 v[144:147], a[192:195], a[144:147], v[144:147]
    ds_read_b64_tr_b16 a[208:209], v194 offset:32768
    ds_read_b128 a[128:131], v212
    v_mfma_f32_16x16x32_bf16 v[144:147], a[196:199], a[156:159], v[144:147]
    ds_read_b64_tr_b16 a[210:211], v194 offset:33280
    v_mul_f32 v118, s75, v118
    v_mfma_f32_16x16x32_bf16 v[148:151], a[192:195], a[148:151], v[148:151]
    ds_read_b64_tr_b16 a[212:213], v194 offset:36864
    ds_read_b128 a[132:135], v213
    v_mfma_f32_16x16x32_bf16 v[148:151], a[196:199], a[160:163], v[148:151]
    ds_read_b64_tr_b16 a[214:215], v194 offset:37376
    v_mul_f32 v119, s75, v119
    v_mfma_f32_16x16x32_bf16 v[152:155], a[192:195], a[152:155], v[152:155]
    ds_read_b128 a[136:139], v214
    v_cvt_pk_bf16_f32 v116, v116, v117
    v_mfma_f32_16x16x32_bf16 v[152:155], a[196:199], a[164:167], v[152:155]
    s_waitcnt lgkmcnt(7)
    buffer_load_dwordx4 v254, s[12:15], s74 offen offset:2048 nt lds
    v_mfma_f32_16x16x32_bf16 v[156:159], a[200:203], a[144:147], v[156:159]
    ds_read_b64_tr_b16 a[192:193], v195 offset:32768
    ds_read_b128 a[140:143], v215
    v_mfma_f32_16x16x32_bf16 v[156:159], a[204:207], a[156:159], v[156:159]
    ds_read_b64_tr_b16 a[194:195], v195 offset:33280
    v_cvt_pk_bf16_f32 v117, v118, v119
    v_mfma_f32_16x16x32_bf16 v[160:163], a[200:203], a[148:151], v[160:163]
    ds_read_b64_tr_b16 a[196:197], v195 offset:36864
    ds_read_b128 a[96:99], v240 offset:0
    v_mfma_f32_16x16x32_bf16 v[160:163], a[204:207], a[160:163], v[160:163]
    ds_read_b64_tr_b16 a[198:199], v195 offset:37376
    v_mfma_f32_16x16x32_bf16 v[164:167], a[200:203], a[152:155], v[164:167]
    ds_read_b128 a[100:103], v241 offset:0
    v_mfma_f32_16x16x32_bf16 v[164:167], a[204:207], a[164:167], v[164:167]
    s_waitcnt lgkmcnt(8)
    buffer_load_dwordx4 v255, s[12:15], s74 offen offset:3072 nt lds
    v_mfma_f32_16x16x32_bf16 v[168:171], a[208:211], a[144:147], v[168:171]
    ds_read_b128 a[104:107], v242 offset:0
    v_mfma_f32_16x16x32_bf16 v[168:171], a[212:215], a[156:159], v[168:171]
    s_waitcnt vmcnt(13) lgkmcnt(2)
    v_permlane16_swap_b32 v104, v116
    v_mfma_f32_16x16x32_bf16 v[172:175], a[208:211], a[148:151], v[172:175]
    s_barrier
    ds_read_b64_tr_b16 a[200:201], v196 offset:32768
    ds_read_b128 a[108:111], v243 offset:0
    v_mfma_f32_16x16x32_bf16 v[172:175], a[212:215], a[160:163], v[172:175]
    ds_read_b64_tr_b16 a[202:203], v196 offset:33280
    v_mfma_f32_16x16x32_bf16 v[176:179], a[208:211], a[152:155], v[176:179]
    ds_read_b64_tr_b16 a[204:205], v196 offset:36864
    ds_read_b128 a[112:115], v240 offset:4096
    v_mfma_f32_16x16x32_bf16 v[176:179], a[212:215], a[164:167], v[176:179]
    ds_read_b64_tr_b16 a[206:207], v196 offset:37376
    v_mfma_f32_16x16x32_bf16 v[180:183], a[192:195], a[144:147], v[180:183]
    ds_read_b64_tr_b16 a[208:209], v197 offset:32768
    ds_read_b128 a[116:119], v241 offset:4096
    v_mfma_f32_16x16x32_bf16 v[180:183], a[196:199], a[156:159], v[180:183]
    ds_read_b64_tr_b16 a[210:211], v197 offset:33280
    v_mfma_f32_16x16x32_bf16 v[184:187], a[192:195], a[148:151], v[184:187]
    ds_read_b64_tr_b16 a[212:213], v197 offset:36864
    ds_read_b128 a[120:123], v242 offset:4096
    v_mfma_f32_16x16x32_bf16 v[184:187], a[196:199], a[160:163], v[184:187]
    ds_read_b64_tr_b16 a[214:215], v197 offset:37376
    v_mfma_f32_16x16x32_bf16 v[188:191], a[192:195], a[152:155], v[188:191]
    ds_read_b128 a[124:127], v243 offset:4096
    v_mfma_f32_16x16x32_bf16 v[188:191], a[196:199], a[164:167], v[188:191]
    s_waitcnt lgkmcnt(7)
    v_permlane16_swap_b32 v105, v117
    v_mfma_f32_16x16x32_bf16 v[144:147], a[200:203], a[168:171], v[144:147]
    s_add_u32 m0, s68, 32768
    ds_read_b64_tr_b16 a[192:193], v198 offset:32768
    v_accvgpr_write_b32 a56, v104
    v_mfma_f32_16x16x32_bf16 v[144:147], a[204:207], a[180:183], v[144:147]
    s_xor_b32 s74, s38, 32768
    ds_read_b64_tr_b16 a[194:195], v198 offset:33280
    v_accvgpr_write_b32 a57, v105
    v_mfma_f32_16x16x32_bf16 v[148:151], a[200:203], a[172:175], v[148:151]
    ds_read_b64_tr_b16 a[196:197], v198 offset:36864
    v_accvgpr_write_b32 a58, v116
    v_mfma_f32_16x16x32_bf16 v[148:151], a[204:207], a[184:187], v[148:151]
    buffer_load_dwordx4 v252, s[8:11], s74 offen offset:0 nt lds
    v_mfma_f32_16x16x32_bf16 v[152:155], a[200:203], a[176:179], v[152:155]
    ds_read_b64_tr_b16 a[198:199], v198 offset:37376
    v_accvgpr_write_b32 a59, v117
    v_mfma_f32_16x16x32_bf16 v[152:155], a[204:207], a[188:191], v[152:155]
    s_waitcnt lgkmcnt(5)
    v_mul_f32 v120, s75, v120
    v_mul_f32 v121, s75, v121
    v_mfma_f32_16x16x32_bf16 v[156:159], a[208:211], a[168:171], v[156:159]
    ds_read_b64_tr_b16 a[200:201], v199 offset:32768
    v_mul_f32 v122, s75, v122
    v_mfma_f32_16x16x32_bf16 v[156:159], a[212:215], a[180:183], v[156:159]
    ds_read_b64_tr_b16 a[202:203], v199 offset:33280
    v_mul_f32 v123, s75, v123
    v_mfma_f32_16x16x32_bf16 v[160:163], a[208:211], a[172:175], v[160:163]
    ds_read_b64_tr_b16 a[204:205], v199 offset:36864
    v_cvt_pk_bf16_f32 v120, v120, v121
    v_mfma_f32_16x16x32_bf16 v[160:163], a[212:215], a[184:187], v[160:163]
    ds_read_b64_tr_b16 a[206:207], v199 offset:37376
    v_cvt_pk_bf16_f32 v121, v122, v123
    v_mfma_f32_16x16x32_bf16 v[164:167], a[208:211], a[176:179], v[164:167]
    v_mul_f32 v132, s75, v132
    v_mul_f32 v133, s75, v133
    v_mfma_f32_16x16x32_bf16 v[164:167], a[212:215], a[188:191], v[164:167]
    s_waitcnt lgkmcnt(4)
    v_mul_f32 v134, s75, v134
    v_mul_f32 v135, s75, v135
    v_mfma_f32_16x16x32_bf16 v[168:171], a[192:195], a[168:171], v[168:171]
    v_cvt_pk_bf16_f32 v132, v132, v133
    v_cvt_pk_bf16_f32 v133, v134, v135
    v_mfma_f32_16x16x32_bf16 v[168:171], a[196:199], a[180:183], v[168:171]
    s_waitcnt lgkmcnt(0)
    v_mul_f32 v144, s75, v144
    v_mul_f32 v145, s75, v145
    v_mfma_f32_16x16x32_bf16 v[172:175], a[192:195], a[172:175], v[172:175]
    s_barrier
    v_permlane16_swap_b32 v120, v132
    v_mfma_f32_16x16x32_bf16 v[172:175], a[196:199], a[184:187], v[172:175]
    v_permlane16_swap_b32 v121, v133
    v_mfma_f32_16x16x32_bf16 v[176:179], a[192:195], a[176:179], v[176:179]
    v_accvgpr_write_b32 a60, v120
    v_accvgpr_write_b32 a61, v121
    v_mfma_f32_16x16x32_bf16 v[176:179], a[196:199], a[188:191], v[176:179]
    v_accvgpr_write_b32 a62, v132
    v_accvgpr_write_b32 a63, v133
    v_mfma_f32_16x16x32_bf16 v[180:183], a[200:203], a[168:171], v[180:183]
    v_mul_f32 v146, s75, v146
    v_mul_f32 v147, s75, v147
    v_mfma_f32_16x16x32_bf16 v[180:183], a[204:207], a[180:183], v[180:183]
    v_cvt_pk_bf16_f32 v144, v144, v145
    v_cvt_pk_bf16_f32 v145, v146, v147
    v_mfma_f32_16x16x32_bf16 v[184:187], a[200:203], a[172:175], v[184:187]
    buffer_load_dwordx4 v253, s[8:11], s74 offen offset:1024 nt lds
    v_mfma_f32_16x16x32_bf16 v[184:187], a[204:207], a[184:187], v[184:187]
    v_mul_f32 v156, s75, v156
    v_mul_f32 v157, s75, v157
    v_mfma_f32_16x16x32_bf16 v[188:191], a[200:203], a[176:179], v[188:191]
    v_mul_f32 v158, s75, v158
    v_mul_f32 v159, s75, v159
    v_mfma_f32_16x16x32_bf16 v[188:191], a[204:207], a[188:191], v[188:191]
    v_cvt_pk_bf16_f32 v156, v156, v157
    v_cvt_pk_bf16_f32 v157, v158, v159
    v_mfma_f32_16x16x32_bf16 v[216:219], a[128:131], a[0:3], 0
    v_mul_f32 v124, s75, v124
    v_mul_f32 v125, s75, v125
    v_mfma_f32_16x16x32_bf16 v[216:219], a[132:135], a[12:15], v[216:219]
    v_permlane16_swap_b32 v144, v156
    v_mfma_f32_16x16x32_bf16 v[216:219], a[136:139], a[24:27], v[216:219]
    v_permlane16_swap_b32 v145, v157
    v_mfma_f32_16x16x32_bf16 v[216:219], a[140:143], a[36:39], v[216:219]
    v_accvgpr_write_b32 a72, v144
    v_accvgpr_write_b32 a73, v145
    v_mfma_f32_16x16x32_bf16 v[220:223], a[128:131], a[4:7], 0
    v_accvgpr_write_b32 a74, v156
    v_accvgpr_write_b32 a75, v157
    v_mfma_f32_16x16x32_bf16 v[220:223], a[132:135], a[16:19], v[220:223]
    v_mul_f32 v148, s75, v148
    v_mul_f32 v149, s75, v149
    v_mfma_f32_16x16x32_bf16 v[220:223], a[136:139], a[28:31], v[220:223]
    v_mul_f32 v150, s75, v150
    v_mul_f32 v151, s75, v151
    v_mfma_f32_16x16x32_bf16 v[220:223], a[140:143], a[40:43], v[220:223]
    v_cvt_pk_bf16_f32 v148, v148, v149
    v_cvt_pk_bf16_f32 v149, v150, v151
    v_mfma_f32_16x16x32_bf16 v[224:227], a[128:131], a[8:11], 0
    v_mul_f32 v160, s75, v160
    v_mul_f32 v161, s75, v161
    v_mfma_f32_16x16x32_bf16 v[224:227], a[132:135], a[20:23], v[224:227]
    v_mul_f32 v162, s75, v162
    v_mul_f32 v163, s75, v163
    v_mfma_f32_16x16x32_bf16 v[224:227], a[136:139], a[32:35], v[224:227]
    v_cvt_pk_bf16_f32 v160, v160, v161
    v_cvt_pk_bf16_f32 v161, v162, v163
    v_mfma_f32_16x16x32_bf16 v[224:227], a[140:143], a[44:47], v[224:227]
    v_permlane16_swap_b32 v148, v160
    v_permlane16_swap_b32 v149, v161
    v_accvgpr_write_b32 a76, v148
    v_accvgpr_write_b32 a77, v149
    v_accvgpr_write_b32 a78, v160
    v_accvgpr_write_b32 a79, v161
    v_mul_f32 v152, s75, v152
    v_mul_f32 v153, s75, v153
    v_mul_f32 v154, s75, v154
    v_mul_f32 v155, s75, v155
    v_cvt_pk_bf16_f32 v152, v152, v153
    v_cvt_pk_bf16_f32 v153, v154, v155
    v_mul_f32 v164, s75, v164
    v_mul_f32 v165, s75, v165
    v_mul_f32 v166, s75, v166
    v_mul_f32 v167, s75, v167
    v_cvt_pk_bf16_f32 v164, v164, v165
    v_cvt_pk_bf16_f32 v165, v166, v167
    s_nop 0
    v_permlane16_swap_b32 v152, v164
    v_permlane16_swap_b32 v153, v165
    v_accvgpr_write_b32 a80, v152
    v_accvgpr_write_b32 a81, v153
    v_accvgpr_write_b32 a82, v164
    v_accvgpr_write_b32 a83, v165
    v_mul_f32 v168, s75, v168
    v_mul_f32 v169, s75, v169
    v_mul_f32 v170, s75, v170
    v_mul_f32 v171, s75, v171
    v_cvt_pk_bf16_f32 v168, v168, v169
    v_cvt_pk_bf16_f32 v169, v170, v171
    v_mul_f32 v180, s75, v180
    v_mul_f32 v181, s75, v181
    v_mul_f32 v182, s75, v182
    v_mul_f32 v183, s75, v183
    v_cvt_pk_bf16_f32 v180, v180, v181
    v_cvt_pk_bf16_f32 v181, v182, v183
    s_nop 0
    v_permlane16_swap_b32 v168, v180
    v_permlane16_swap_b32 v169, v181
    v_accvgpr_write_b32 a84, v168
    v_accvgpr_write_b32 a85, v169
    v_accvgpr_write_b32 a86, v180
    v_accvgpr_write_b32 a87, v181
    v_mfma_f32_16x16x32_bf16 v[228:231], a[128:131], a[48:51], 0
    buffer_load_dwordx4 v254, s[8:11], s74 offen offset:2048 nt lds
    v_mfma_f32_16x16x32_bf16 v[228:231], a[132:135], a[60:63], v[228:231]
    v_mul_f32 v126, s75, v126
    v_mul_f32 v127, s75, v127
    v_mfma_f32_16x16x32_bf16 v[228:231], a[136:139], a[72:75], v[228:231]
    v_cvt_pk_bf16_f32 v124, v124, v125
    v_cvt_pk_bf16_f32 v125, v126, v127
    v_mfma_f32_16x16x32_bf16 v[228:231], a[140:143], a[84:87], v[228:231]
    v_mul_f32 v136, s75, v136
    v_mul_f32 v137, s75, v137
    v_mul_f32 v138, s75, v138
    v_mul_f32 v139, s75, v139
    v_cvt_pk_bf16_f32 v136, v136, v137
    v_cvt_pk_bf16_f32 v137, v138, v139
    s_nop 0
    v_permlane16_swap_b32 v124, v136
    v_permlane16_swap_b32 v125, v137
    v_accvgpr_write_b32 a64, v124
    v_accvgpr_write_b32 a65, v125
    v_accvgpr_write_b32 a66, v136
    v_accvgpr_write_b32 a67, v137
    v_mul_f32 v172, s75, v172
    v_mul_f32 v173, s75, v173
    v_mul_f32 v174, s75, v174
    v_mul_f32 v175, s75, v175
    v_cvt_pk_bf16_f32 v172, v172, v173
    v_cvt_pk_bf16_f32 v173, v174, v175
    v_mul_f32 v184, s75, v184
    v_mul_f32 v185, s75, v185
    v_mul_f32 v186, s75, v186
    v_mul_f32 v187, s75, v187
    v_cvt_pk_bf16_f32 v184, v184, v185
    v_cvt_pk_bf16_f32 v185, v186, v187
    s_nop 0
    v_permlane16_swap_b32 v172, v184
    v_permlane16_swap_b32 v173, v185
    v_accvgpr_write_b32 a88, v172
    v_accvgpr_write_b32 a89, v173
    v_accvgpr_write_b32 a90, v184
    v_accvgpr_write_b32 a91, v185
    v_mfma_f32_16x16x32_bf16 v[232:235], a[128:131], a[52:55], 0
    v_mul_f32 v128, s75, v128
    v_mul_f32 v129, s75, v129
    v_mfma_f32_16x16x32_bf16 v[232:235], a[132:135], a[64:67], v[232:235]
    v_mul_f32 v130, s75, v130
    v_mul_f32 v131, s75, v131
    v_mfma_f32_16x16x32_bf16 v[232:235], a[136:139], a[76:79], v[232:235]
    v_cvt_pk_bf16_f32 v128, v128, v129
    v_cvt_pk_bf16_f32 v129, v130, v131
    v_mfma_f32_16x16x32_bf16 v[232:235], a[140:143], a[88:91], v[232:235]
    v_mul_f32 v140, s75, v140
    v_mul_f32 v141, s75, v141
    v_mul_f32 v142, s75, v142
    v_mul_f32 v143, s75, v143
    v_cvt_pk_bf16_f32 v140, v140, v141
    v_cvt_pk_bf16_f32 v141, v142, v143
    s_nop 0
    v_permlane16_swap_b32 v128, v140
    v_permlane16_swap_b32 v129, v141
    v_accvgpr_write_b32 a68, v128
    v_accvgpr_write_b32 a69, v129
    v_accvgpr_write_b32 a70, v140
    v_accvgpr_write_b32 a71, v141
    v_mul_f32 v176, s75, v176
    v_mul_f32 v177, s75, v177
    v_mul_f32 v178, s75, v178
    v_mul_f32 v179, s75, v179
    v_cvt_pk_bf16_f32 v176, v176, v177
    v_cvt_pk_bf16_f32 v177, v178, v179
    v_mul_f32 v188, s75, v188
    v_mul_f32 v189, s75, v189
    v_mul_f32 v190, s75, v190
    v_mul_f32 v191, s75, v191
    v_cvt_pk_bf16_f32 v188, v188, v189
    v_cvt_pk_bf16_f32 v189, v190, v191
    s_nop 0
    v_permlane16_swap_b32 v176, v188
    v_permlane16_swap_b32 v177, v189
    v_accvgpr_write_b32 a92, v176
    v_accvgpr_write_b32 a93, v177
    v_accvgpr_write_b32 a94, v188
    v_accvgpr_write_b32 a95, v189
    v_mfma_f32_16x16x32_bf16 v[236:239], a[128:131], a[56:59], 0
    ds_read_b64_tr_b16 a[144:145], v244 offset:0
    ds_read_b64_tr_b16 a[146:147], v244 offset:4096
    v_mfma_f32_16x16x32_bf16 v[236:239], a[132:135], a[68:71], v[236:239]
    ds_read_b64_tr_b16 a[148:149], v245 offset:0
    ds_read_b64_tr_b16 a[150:151], v245 offset:4096
    v_mfma_f32_16x16x32_bf16 v[236:239], a[136:139], a[80:83], v[236:239]
    ds_read_b64_tr_b16 a[152:153], v246 offset:0
    ds_read_b64_tr_b16 a[154:155], v246 offset:4096
    v_mfma_f32_16x16x32_bf16 v[236:239], a[140:143], a[92:95], v[236:239]
    ds_read_b64_tr_b16 a[156:157], v247 offset:0
    ds_read_b64_tr_b16 a[158:159], v247 offset:4096
    ds_read_b64_tr_b16 a[160:161], v248 offset:0
    ds_read_b64_tr_b16 a[162:163], v248 offset:4096
    ds_read_b64_tr_b16 a[164:165], v249 offset:0
    ds_read_b64_tr_b16 a[166:167], v249 offset:4096
    ds_read_b64_tr_b16 a[168:169], v250 offset:0
    ds_read_b64_tr_b16 a[170:171], v250 offset:4096
    ds_read_b64_tr_b16 a[172:173], v251 offset:0
    ds_read_b64_tr_b16 a[174:175], v251 offset:4096
    v_max3_f32 v216, v216, v217, v218
    v_min_f32_e64 v217, -v216, -v219
    v_min_f32_e64 v218, -v216, -v219
    v_mov_b32 v216, v217
    v_mov_b32 v219, v217
    v_max3_f32 v220, v220, v221, v222
    v_min_f32_e64 v221, -v220, -v223
    v_min_f32_e64 v222, -v220, -v223
    v_mov_b32 v220, v221
    v_mov_b32 v223, v221
    v_max3_f32 v224, v224, v225, v226
    v_min_f32_e64 v225, -v224, -v227
    v_min_f32_e64 v226, -v224, -v227
    v_mov_b32 v224, v225
    v_mov_b32 v227, v225
    v_max3_f32 v228, v228, v229, v230
    v_min_f32_e64 v229, -v228, -v231
    v_min_f32_e64 v230, -v228, -v231
    v_mov_b32 v228, v229
    v_mov_b32 v231, v229
    v_max3_f32 v232, v232, v233, v234
    v_min_f32_e64 v233, -v232, -v235
    v_min_f32_e64 v234, -v232, -v235
    v_mov_b32 v232, v233
    v_mov_b32 v235, v233
    v_max3_f32 v236, v236, v237, v238
    v_min_f32_e64 v237, -v236, -v239
    v_min_f32_e64 v238, -v236, -v239
    v_mov_b32 v236, v237
    v_mov_b32 v239, v237
L_attn:
    v_mfma_f32_16x16x32_bf16 v[192:195], a[96:99], a[0:3], v[216:219]
    v_accvgpr_read_b32 v190, a246
    v_add_u32 v190, s68, v190
    v_mfma_f32_16x16x32_bf16 v[192:195], a[100:103], a[12:15], v[192:195]
    v_add_u32 v191, 81920, v190
    v_mfma_f32_16x16x32_bf16 v[192:195], a[104:107], a[24:27], v[192:195]
    v_mfma_f32_16x16x32_bf16 v[192:195], a[108:111], a[36:39], v[192:195]
    v_mfma_f32_16x16x32_bf16 v[196:199], a[112:115], a[0:3], v[216:219]
    buffer_load_dwordx4 v255, s[8:11], s74 offen offset:3072 nt lds
    v_mfma_f32_16x16x32_bf16 v[196:199], a[116:119], a[12:15], v[196:199]
    v_mfma_f32_16x16x32_bf16 v[196:199], a[120:123], a[24:27], v[196:199]
    v_mfma_f32_16x16x32_bf16 v[196:199], a[124:127], a[36:39], v[196:199]
    v_mfma_f32_16x16x32_bf16 v[200:203], a[96:99], a[4:7], v[220:223]
    s_nop 1
    v_exp_f32 v192, v192
    v_mfma_f32_16x16x32_bf16 v[200:203], a[100:103], a[16:19], v[200:203]
    v_exp_f32 v193, v193
    v_mfma_f32_16x16x32_bf16 v[200:203], a[104:107], a[28:31], v[200:203]
    v_exp_f32 v194, v194
    v_mfma_f32_16x16x32_bf16 v[200:203], a[108:111], a[40:43], v[200:203]
    v_exp_f32 v195, v195
    v_mfma_f32_16x16x32_bf16 v[204:207], a[112:115], a[4:7], v[220:223]
    v_cvt_pk_bf16_f32 v208, v192, v193
    v_cvt_pk_bf16_f32 v209, v194, v195
    v_mfma_f32_16x16x32_bf16 v[204:207], a[116:119], a[16:19], v[204:207]
    v_exp_f32 v196, v196
    v_mfma_f32_16x16x32_bf16 v[204:207], a[120:123], a[28:31], v[204:207]
    v_exp_f32 v197, v197
    v_mfma_f32_16x16x32_bf16 v[204:207], a[124:127], a[40:43], v[204:207]
    v_exp_f32 v198, v198
    v_mfma_f32_16x16x32_bf16 v[192:195], a[96:99], a[8:11], v[224:227]
    v_exp_f32 v199, v199
    v_mfma_f32_16x16x32_bf16 v[192:195], a[100:103], a[20:23], v[192:195]
    s_add_u32 m0, s68, 114688
    v_cvt_pk_bf16_f32 v210, v196, v197
    v_cvt_pk_bf16_f32 v211, v198, v199
    v_mfma_f32_16x16x32_bf16 v[192:195], a[104:107], a[32:35], v[192:195]
    s_waitcnt lgkmcnt(0)
    v_exp_f32 v200, v200
    v_mfma_f32_16x16x32_bf16 v[192:195], a[108:111], a[44:47], v[192:195]
    s_barrier
    v_exp_f32 v201, v201
    v_mfma_f32_16x16x32_bf16 v[196:199], a[112:115], a[8:11], v[224:227]
    s_xor_b32 s74, s38, 32768
    ds_write_b128 v190, a[216:219] offset:0
    v_mfma_f32_16x16x32_bf16 v[196:199], a[116:119], a[20:23], v[196:199]
    buffer_load_dwordx4 v252, s[12:15], s74 offen offset:0 nt lds
    v_mfma_f32_16x16x32_bf16 v[196:199], a[120:123], a[32:35], v[196:199]
    v_exp_f32 v202, v202
    v_mfma_f32_16x16x32_bf16 v[196:199], a[124:127], a[44:47], v[196:199]
    v_exp_f32 v203, v203
    v_mfma_f32_16x16x32_bf16 v[0:3], a[144:147], v[208:211], 0
    ds_write_b128 v190, a[220:223] offset:1024
    v_mfma_f32_16x16x32_bf16 v[4:7], a[148:151], v[208:211], 0
    v_cvt_pk_bf16_f32 v212, v200, v201
    v_cvt_pk_bf16_f32 v213, v202, v203
    v_mfma_f32_16x16x32_bf16 v[8:11], a[152:155], v[208:211], 0
    v_exp_f32 v204, v204
    v_mfma_f32_16x16x32_bf16 v[12:15], a[156:159], v[208:211], 0
    v_exp_f32 v205, v205
    v_mfma_f32_16x16x32_bf16 v[16:19], a[160:163], v[208:211], 0
    ds_write_b128 v190, a[224:227] offset:2048
    v_mfma_f32_16x16x32_bf16 v[20:23], a[164:167], v[208:211], 0
    v_exp_f32 v206, v206
    v_mfma_f32_16x16x32_bf16 v[24:27], a[168:171], v[208:211], 0
    v_exp_f32 v207, v207
    v_mfma_f32_16x16x32_bf16 v[28:31], a[172:175], v[208:211], 0
    v_cvt_pk_bf16_f32 v214, v204, v205
    v_cvt_pk_bf16_f32 v215, v206, v207
    v_mfma_f32_16x16x32_bf16 a[216:219], a[240:243], v[208:211], 0
    ds_write_b128 v190, a[228:231] offset:3072
    v_mfma_f32_16x16x32_bf16 v[200:203], a[96:99], a[48:51], v[228:231]
    v_exp_f32 v192, v192
    v_mfma_f32_16x16x32_bf16 v[200:203], a[100:103], a[60:63], v[200:203]
    v_exp_f32 v193, v193
    v_mfma_f32_16x16x32_bf16 v[200:203], a[104:107], a[72:75], v[200:203]
    v_exp_f32 v194, v194
    v_mfma_f32_16x16x32_bf16 v[200:203], a[108:111], a[84:87], v[200:203]
    ds_write_b128 v191, a[232:235] offset:0
    v_mfma_f32_16x16x32_bf16 v[204:207], a[112:115], a[48:51], v[228:231]
    buffer_load_dwordx4 v253, s[12:15], s74 offen offset:1024 nt lds
    v_mfma_f32_16x16x32_bf16 v[204:207], a[116:119], a[60:63], v[204:207]
    v_exp_f32 v195, v195
    v_mfma_f32_16x16x32_bf16 v[204:207], a[120:123], a[72:75], v[204:207]
    v_cvt_pk_bf16_f32 v208, v192, v193
    v_cvt_pk_bf16_f32 v209, v194, v195
    v_mfma_f32_16x16x32_bf16 v[204:207], a[124:127], a[84:87], v[204:207]
    ds_write_b128 v191, a[236:239] offset:1024
    v_mfma_f32_16x16x32_bf16 v[32:35], a[144:147], v[212:215], 0
    v_exp_f32 v196, v196
    v_mfma_f32_16x16x32_bf16 v[36:39], a[148:151], v[212:215], 0
    v_exp_f32 v197, v197
    v_mfma_f32_16x16x32_bf16 v[40:43], a[152:155], v[212:215], 0
    v_exp_f32 v198, v198
    v_mfma_f32_16x16x32_bf16 v[44:47], a[156:159], v[212:215], 0
    ds_write_b128 v191, a[252:255] offset:2048
    v_mfma_f32_16x16x32_bf16 v[48:51], a[160:163], v[212:215], 0
    v_exp_f32 v199, v199
    v_mfma_f32_16x16x32_bf16 v[52:55], a[164:167], v[212:215], 0
    v_cvt_pk_bf16_f32 v210, v196, v197
    v_cvt_pk_bf16_f32 v211, v198, v199
    v_mfma_f32_16x16x32_bf16 v[56:59], a[168:171], v[212:215], 0
    v_exp_f32 v200, v200
    v_mfma_f32_16x16x32_bf16 v[60:63], a[172:175], v[212:215], 0
    ds_write_b128 v191, v[92:95] offset:3072
    v_mfma_f32_16x16x32_bf16 a[220:223], a[240:243], v[212:215], 0
    v_exp_f32 v201, v201
    v_mfma_f32_16x16x32_bf16 v[192:195], a[96:99], a[52:55], v[232:235]
    v_exp_f32 v202, v202
    v_mfma_f32_16x16x32_bf16 v[192:195], a[100:103], a[64:67], v[192:195]
    v_exp_f32 v203, v203
    v_mfma_f32_16x16x32_bf16 v[192:195], a[104:107], a[76:79], v[192:195]
    v_cvt_pk_bf16_f32 v212, v200, v201
    v_cvt_pk_bf16_f32 v213, v202, v203
    v_mfma_f32_16x16x32_bf16 v[192:195], a[108:111], a[88:91], v[192:195]
    buffer_load_dwordx4 v254, s[12:15], s74 offen offset:2048 nt lds
    v_mfma_f32_16x16x32_bf16 v[196:199], a[112:115], a[52:55], v[232:235]
    v_exp_f32 v204, v204
    v_mfma_f32_16x16x32_bf16 v[196:199], a[116:119], a[64:67], v[196:199]
    v_exp_f32 v205, v205
    v_mfma_f32_16x16x32_bf16 v[196:199], a[120:123], a[76:79], v[196:199]
    v_exp_f32 v206, v206
    v_mfma_f32_16x16x32_bf16 v[196:199], a[124:127], a[88:91], v[196:199]
    v_exp_f32 v207, v207
    v_mfma_f32_16x16x32_bf16 v[64:67], a[144:147], v[208:211], 0
    v_cvt_pk_bf16_f32 v214, v204, v205
    v_cvt_pk_bf16_f32 v215, v206, v207
    v_mfma_f32_16x16x32_bf16 v[68:71], a[148:151], v[208:211], 0
    v_exp_f32 v192, v192
    v_mfma_f32_16x16x32_bf16 v[72:75], a[152:155], v[208:211], 0
    v_exp_f32 v193, v193
    v_mfma_f32_16x16x32_bf16 v[76:79], a[156:159], v[208:211], 0
    v_exp_f32 v194, v194
    v_mfma_f32_16x16x32_bf16 v[80:83], a[160:163], v[208:211], 0
    v_exp_f32 v195, v195
    v_mfma_f32_16x16x32_bf16 v[84:87], a[164:167], v[208:211], 0
    v_mfma_f32_16x16x32_bf16 v[88:91], a[168:171], v[208:211], 0
    v_mfma_f32_16x16x32_bf16 v[92:95], a[172:175], v[208:211], 0
    v_mfma_f32_16x16x32_bf16 a[224:227], a[240:243], v[208:211], 0
    s_barrier
    v_mfma_f32_16x16x32_bf16 v[200:203], a[96:99], a[56:59], v[236:239]
    ds_read_b128 a[96:99], v240 offset:8192
    v_cvt_pk_bf16_f32 v208, v192, v193
    v_mfma_f32_16x16x32_bf16 v[200:203], a[100:103], a[68:71], v[200:203]
    v_cvt_pk_bf16_f32 v209, v194, v195
    v_mfma_f32_16x16x32_bf16 v[200:203], a[104:107], a[80:83], v[200:203]
    ds_read_b128 a[100:103], v241 offset:8192
    v_mfma_f32_16x16x32_bf16 v[200:203], a[108:111], a[92:95], v[200:203]
    buffer_load_dwordx4 v255, s[12:15], s74 offen offset:3072 nt lds
    v_mfma_f32_16x16x32_bf16 v[204:207], a[112:115], a[56:59], v[236:239]
    ds_read_b128 a[104:107], v242 offset:8192
    v_mfma_f32_16x16x32_bf16 v[204:207], a[116:119], a[68:71], v[204:207]
    v_exp_f32 v196, v196
    v_mfma_f32_16x16x32_bf16 v[204:207], a[120:123], a[80:83], v[204:207]
    ds_read_b128 a[108:111], v243 offset:8192
    v_mfma_f32_16x16x32_bf16 v[204:207], a[124:127], a[92:95], v[204:207]
    v_exp_f32 v197, v197
    v_mfma_f32_16x16x32_bf16 v[96:99], a[144:147], v[212:215], 0
    ds_read_b128 a[112:115], v240 offset:12288
    v_mfma_f32_16x16x32_bf16 v[100:103], a[148:151], v[212:215], 0
    v_exp_f32 v198, v198
    v_mfma_f32_16x16x32_bf16 v[104:107], a[152:155], v[212:215], 0
    ds_read_b128 a[116:119], v241 offset:12288
    v_mfma_f32_16x16x32_bf16 v[108:111], a[156:159], v[212:215], 0
    v_exp_f32 v199, v199
    v_mfma_f32_16x16x32_bf16 v[112:115], a[160:163], v[212:215], 0
    ds_read_b128 a[120:123], v242 offset:12288
    v_cvt_pk_bf16_f32 v210, v196, v197
    v_mfma_f32_16x16x32_bf16 v[116:119], a[164:167], v[212:215], 0
    v_cvt_pk_bf16_f32 v211, v198, v199
    v_mfma_f32_16x16x32_bf16 v[120:123], a[168:171], v[212:215], 0
    ds_read_b128 a[124:127], v243 offset:12288
    v_mfma_f32_16x16x32_bf16 v[124:127], a[172:175], v[212:215], 0
L_hopa_4:
    s_cbranch_execz L_backa
    v_exp_f32 v200, v200
    v_mfma_f32_16x16x32_bf16 a[228:231], a[240:243], v[212:215], 0
    s_waitcnt lgkmcnt(7)
    v_exp_f32 v201, v201
    v_mfma_f32_16x16x32_bf16 v[192:195], a[96:99], a[0:3], v[216:219]
    s_waitcnt lgkmcnt(6)
    v_exp_f32 v202, v202
    v_mfma_f32_16x16x32_bf16 v[192:195], a[100:103], a[12:15], v[192:195]
    s_waitcnt lgkmcnt(5)
    v_exp_f32 v203, v203
    v_mfma_f32_16x16x32_bf16 v[192:195], a[104:107], a[24:27], v[192:195]
    s_waitcnt lgkmcnt(4)
    v_cvt_pk_bf16_f32 v212, v200, v201
    v_cvt_pk_bf16_f32 v213, v202, v203
    v_mfma_f32_16x16x32_bf16 v[192:195], a[108:111], a[36:39], v[192:195]
    s_waitcnt lgkmcnt(3)
    v_exp_f32 v204, v204
    v_mfma_f32_16x16x32_bf16 v[196:199], a[112:115], a[0:3], v[216:219]
    s_waitcnt lgkmcnt(2)
    v_exp_f32 v205, v205
    v_mfma_f32_16x16x32_bf16 v[196:199], a[116:119], a[12:15], v[196:199]
    s_waitcnt lgkmcnt(1)
    v_exp_f32 v206, v206
    v_mfma_f32_16x16x32_bf16 v[196:199], a[120:123], a[24:27], v[196:199]
    s_waitcnt lgkmcnt(0)
    v_exp_f32 v207, v207
    v_mfma_f32_16x16x32_bf16 v[196:199], a[124:127], a[36:39], v[196:199]
    v_cvt_pk_bf16_f32 v214, v204, v205
    v_cvt_pk_bf16_f32 v215, v206, v207
    v_mfma_f32_16x16x32_bf16 v[128:131], a[144:147], v[208:211], 0
    v_exp_f32 v192, v192
    v_mfma_f32_16x16x32_bf16 v[132:135], a[148:151], v[208:211], 0
    v_exp_f32 v193, v193
    v_mfma_f32_16x16x32_bf16 v[136:139], a[152:155], v[208:211], 0
    v_exp_f32 v194, v194
    v_mfma_f32_16x16x32_bf16 v[140:143], a[156:159], v[208:211], 0
    v_exp_f32 v195, v195
    v_mfma_f32_16x16x32_bf16 v[144:147], a[160:163], v[208:211], 0
    v_mfma_f32_16x16x32_bf16 v[148:151], a[164:167], v[208:211], 0
    v_mfma_f32_16x16x32_bf16 v[152:155], a[168:171], v[208:211], 0
    v_mfma_f32_16x16x32_bf16 v[156:159], a[172:175], v[208:211], 0
    v_mfma_f32_16x16x32_bf16 a[232:235], a[240:243], v[208:211], 0
    v_mfma_f32_16x16x32_bf16 v[200:203], a[96:99], a[4:7], v[220:223]
    v_cvt_pk_bf16_f32 v208, v192, v193
    v_cvt_pk_bf16_f32 v209, v194, v195
    v_mfma_f32_16x16x32_bf16 v[200:203], a[100:103], a[16:19], v[200:203]
    v_exp_f32 v196, v196
    v_mfma_f32_16x16x32_bf16 v[200:203], a[104:107], a[28:31], v[200:203]
    v_exp_f32 v197, v197
    v_mfma_f32_16x16x32_bf16 v[200:203], a[108:111], a[40:43], v[200:203]
    v_exp_f32 v198, v198
    v_mfma_f32_16x16x32_bf16 v[204:207], a[112:115], a[4:7], v[220:223]
    v_exp_f32 v199, v199
    v_mfma_f32_16x16x32_bf16 v[204:207], a[116:119], a[16:19], v[204:207]
    s_add_u32 m0, s68, 8192
    v_cvt_pk_bf16_f32 v210, v196, v197
    v_cvt_pk_bf16_f32 v211, v198, v199
    v_mfma_f32_16x16x32_bf16 v[204:207], a[120:123], a[28:31], v[204:207]
    v_mfma_f32_16x16x32_bf16 v[204:207], a[124:127], a[40:43], v[204:207]
    s_barrier
    v_mfma_f32_16x16x32_bf16 v[160:163], a[144:147], v[212:215], 0
    s_xor_b32 s74, s38, 49152
    ds_read_b64_tr_b16 a[144:145], v244 offset:8192
    ds_read_b64_tr_b16 a[146:147], v244 offset:12288
    v_mfma_f32_16x16x32_bf16 v[164:167], a[148:151], v[212:215], 0
    buffer_load_dwordx4 v252, s[8:11], s74 offen offset:0 nt lds
    v_mfma_f32_16x16x32_bf16 v[168:171], a[152:155], v[212:215], 0
    ds_read_b64_tr_b16 a[148:149], v245 offset:8192
    ds_read_b64_tr_b16 a[150:151], v245 offset:12288
    v_mfma_f32_16x16x32_bf16 v[172:175], a[156:159], v[212:215], 0
    v_exp_f32 v200, v200
    v_mfma_f32_16x16x32_bf16 v[176:179], a[160:163], v[212:215], 0
    ds_read_b64_tr_b16 a[152:153], v246 offset:8192
    ds_read_b64_tr_b16 a[154:155], v246 offset:12288
    v_mfma_f32_16x16x32_bf16 v[180:183], a[164:167], v[212:215], 0
    v_exp_f32 v201, v201
    v_mfma_f32_16x16x32_bf16 v[184:187], a[168:171], v[212:215], 0
    ds_read_b64_tr_b16 a[156:157], v247 offset:8192
    ds_read_b64_tr_b16 a[158:159], v247 offset:12288
    v_mfma_f32_16x16x32_bf16 v[188:191], a[172:175], v[212:215], 0
    v_exp_f32 v202, v202
    v_mfma_f32_16x16x32_bf16 a[236:239], a[240:243], v[212:215], 0
    ds_read_b64_tr_b16 a[160:161], v248 offset:8192
    ds_read_b64_tr_b16 a[162:163], v248 offset:12288
    v_mfma_f32_16x16x32_bf16 v[192:195], a[96:99], a[8:11], v[224:227]
    v_exp_f32 v203, v203
    v_mfma_f32_16x16x32_bf16 v[192:195], a[100:103], a[20:23], v[192:195]
    ds_read_b64_tr_b16 a[164:165], v249 offset:8192
    ds_read_b64_tr_b16 a[166:167], v249 offset:12288
    v_mfma_f32_16x16x32_bf16 v[192:195], a[104:107], a[32:35], v[192:195]
    v_cvt_pk_bf16_f32 v212, v200, v201
    v_cvt_pk_bf16_f32 v213, v202, v203
    v_mfma_f32_16x16x32_bf16 v[192:195], a[108:111], a[44:47], v[192:195]
    ds_read_b64_tr_b16 a[168:169], v250 offset:8192
    ds_read_b64_tr_b16 a[170:171], v250 offset:12288
    v_mfma_f32_16x16x32_bf16 v[196:199], a[112:115], a[8:11], v[224:227]
    v_exp_f32 v204, v204
    v_mfma_f32_16x16x32_bf16 v[196:199], a[116:119], a[20:23], v[196:199]
    ds_read_b64_tr_b16 a[172:173], v251 offset:8192
    ds_read_b64_tr_b16 a[174:175], v251 offset:12288
    v_mfma_f32_16x16x32_bf16 v[196:199], a[120:123], a[32:35], v[196:199]
    v_exp_f32 v205, v205
    v_mfma_f32_16x16x32_bf16 v[196:199], a[124:127], a[44:47], v[196:199]
    s_waitcnt lgkmcnt(14)
    v_exp_f32 v206, v206
    v_mfma_f32_16x16x32_bf16 v[0:3], a[144:147], v[208:211], v[0:3]
    s_waitcnt lgkmcnt(12)
    buffer_load_dwordx4 v253, s[8:11], s74 offen offset:1024 nt lds
    v_mfma_f32_16x16x32_bf16 v[4:7], a[148:151], v[208:211], v[4:7]
    s_waitcnt lgkmcnt(10)
    v_exp_f32 v207, v207
    v_mfma_f32_16x16x32_bf16 v[8:11], a[152:155], v[208:211], v[8:11]
    s_waitcnt lgkmcnt(8)
    v_cvt_pk_bf16_f32 v214, v204, v205
    v_cvt_pk_bf16_f32 v215, v206, v207
    v_mfma_f32_16x16x32_bf16 v[12:15], a[156:159], v[208:211], v[12:15]
    s_waitcnt lgkmcnt(6)
    v_exp_f32 v192, v192
    v_mfma_f32_16x16x32_bf16 v[16:19], a[160:163], v[208:211], v[16:19]
    s_waitcnt lgkmcnt(4)
    v_exp_f32 v193, v193
    v_mfma_f32_16x16x32_bf16 v[20:23], a[164:167], v[208:211], v[20:23]
    s_waitcnt lgkmcnt(2)
    v_exp_f32 v194, v194
    v_mfma_f32_16x16x32_bf16 v[24:27], a[168:171], v[208:211], v[24:27]
    s_waitcnt lgkmcnt(0)
    v_exp_f32 v195, v195
    v_mfma_f32_16x16x32_bf16 v[28:31], a[172:175], v[208:211], v[28:31]
    v_mfma_f32_16x16x32_bf16 a[216:219], a[240:243], v[208:211], a[216:219]
    v_mfma_f32_16x16x32_bf16 v[200:203], a[96:99], a[48:51], v[228:231]
    v_cvt_pk_bf16_f32 v208, v192, v193
    v_cvt_pk_bf16_f32 v209, v194, v195
    v_mfma_f32_16x16x32_bf16 v[200:203], a[100:103], a[60:63], v[200:203]
    v_exp_f32 v196, v196
    v_mfma_f32_16x16x32_bf16 v[200:203], a[104:107], a[72:75], v[200:203]
    v_exp_f32 v197, v197
    v_mfma_f32_16x16x32_bf16 v[200:203], a[108:111], a[84:87], v[200:203]
    v_exp_f32 v198, v198
    v_mfma_f32_16x16x32_bf16 v[204:207], a[112:115], a[48:51], v[228:231]
    v_exp_f32 v199, v199
    v_mfma_f32_16x16x32_bf16 v[204:207], a[116:119], a[60:63], v[204:207]
    v_cvt_pk_bf16_f32 v210, v196, v197
    v_cvt_pk_bf16_f32 v211, v198, v199
    v_mfma_f32_16x16x32_bf16 v[204:207], a[120:123], a[72:75], v[204:207]
    v_mfma_f32_16x16x32_bf16 v[204:207], a[124:127], a[84:87], v[204:207]
    v_mfma_f32_16x16x32_bf16 v[32:35], a[144:147], v[212:215], v[32:35]
    buffer_load_dwordx4 v254, s[8:11], s74 offen offset:2048 nt lds
    v_mfma_f32_16x16x32_bf16 v[36:39], a[148:151], v[212:215], v[36:39]
    v_exp_f32 v200, v200
    v_mfma_f32_16x16x32_bf16 v[40:43], a[152:155], v[212:215], v[40:43]
    v_exp_f32 v201, v201
    v_mfma_f32_16x16x32_bf16 v[44:47], a[156:159], v[212:215], v[44:47]
    v_exp_f32 v202, v202
    v_mfma_f32_16x16x32_bf16 v[48:51], a[160:163], v[212:215], v[48:51]
    v_exp_f32 v203, v203
    v_mfma_f32_16x16x32_bf16 v[52:55], a[164:167], v[212:215], v[52:55]
    v_mfma_f32_16x16x32_bf16 v[56:59], a[168:171], v[212:215], v[56:59]
    v_mfma_f32_16x16x32_bf16 v[60:63], a[172:175], v[212:215], v[60:63]
    v_mfma_f32_16x16x32_bf16 a[220:223], a[240:243], v[212:215], a[220:223]
    v_mfma_f32_16x16x32_bf16 v[192:195], a[96:99], a[52:55], v[232:235]
    v_cvt_pk_bf16_f32 v212, v200, v201
    v_cvt_pk_bf16_f32 v213, v202, v203
    v_mfma_f32_16x16x32_bf16 v[192:195], a[100:103], a[64:67], v[192:195]
    v_exp_f32 v204, v204
    v_mfma_f32_16x16x32_bf16 v[192:195], a[104:107], a[76:79], v[192:195]
    v_exp_f32 v205, v205
    v_mfma_f32_16x16x32_bf16 v[192:195], a[108:111], a[88:91], v[192:195]
    v_exp_f32 v206, v206
    v_mfma_f32_16x16x32_bf16 v[196:199], a[112:115], a[52:55], v[232:235]
    v_exp_f32 v207, v207
    v_mfma_f32_16x16x32_bf16 v[196:199], a[116:119], a[64:67], v[196:199]
    v_cvt_pk_bf16_f32 v214, v204, v205
    v_cvt_pk_bf16_f32 v215, v206, v207
    v_mfma_f32_16x16x32_bf16 v[196:199], a[120:123], a[76:79], v[196:199]
    v_mfma_f32_16x16x32_bf16 v[196:199], a[124:127], a[88:91], v[196:199]
    buffer_load_dwordx4 v255, s[8:11], s74 offen offset:3072 nt lds
    v_mfma_f32_16x16x32_bf16 v[64:67], a[144:147], v[208:211], v[64:67]
    v_exp_f32 v192, v192
    v_mfma_f32_16x16x32_bf16 v[68:71], a[148:151], v[208:211], v[68:71]
    v_exp_f32 v193, v193
    v_mfma_f32_16x16x32_bf16 v[72:75], a[152:155], v[208:211], v[72:75]
    v_exp_f32 v194, v194
    v_mfma_f32_16x16x32_bf16 v[76:79], a[156:159], v[208:211], v[76:79]
    v_exp_f32 v195, v195
    v_mfma_f32_16x16x32_bf16 v[80:83], a[160:163], v[208:211], v[80:83]
    v_mfma_f32_16x16x32_bf16 v[84:87], a[164:167], v[208:211], v[84:87]
    v_mfma_f32_16x16x32_bf16 v[88:91], a[168:171], v[208:211], v[88:91]
    v_mfma_f32_16x16x32_bf16 v[92:95], a[172:175], v[208:211], v[92:95]
    v_mfma_f32_16x16x32_bf16 a[224:227], a[240:243], v[208:211], a[224:227]
    s_barrier
    v_mfma_f32_16x16x32_bf16 v[200:203], a[96:99], a[56:59], v[236:239]
    ds_read_b128 a[96:99], v240 offset:16384
    v_cvt_pk_bf16_f32 v208, v192, v193
    v_mfma_f32_16x16x32_bf16 v[200:203], a[100:103], a[68:71], v[200:203]
    v_cvt_pk_bf16_f32 v209, v194, v195
    v_mfma_f32_16x16x32_bf16 v[200:203], a[104:107], a[80:83], v[200:203]
    ds_read_b128 a[100:103], v241 offset:16384
    v_mfma_f32_16x16x32_bf16 v[200:203], a[108:111], a[92:95], v[200:203]
    s_add_u32 m0, s68, 90112
    v_exp_f32 v196, v196
    v_mfma_f32_16x16x32_bf16 v[204:207], a[112:115], a[56:59], v[236:239]
    s_xor_b32 s74, s38, 49152
    ds_read_b128 a[104:107], v242 offset:16384
    v_mfma_f32_16x16x32_bf16 v[204:207], a[116:119], a[68:71], v[204:207]
    v_exp_f32 v197, v197
    v_mfma_f32_16x16x32_bf16 v[204:207], a[120:123], a[80:83], v[204:207]
    ds_read_b128 a[108:111], v243 offset:16384
    v_mfma_f32_16x16x32_bf16 v[204:207], a[124:127], a[92:95], v[204:207]
    buffer_load_dwordx4 v252, s[12:15], s74 offen offset:0 nt lds
    v_mfma_f32_16x16x32_bf16 v[96:99], a[144:147], v[212:215], v[96:99]
    ds_read_b128 a[112:115], v240 offset:20480
    v_mfma_f32_16x16x32_bf16 v[100:103], a[148:151], v[212:215], v[100:103]
    v_exp_f32 v198, v198
    v_mfma_f32_16x16x32_bf16 v[104:107], a[152:155], v[212:215], v[104:107]
    ds_read_b128 a[116:119], v241 offset:20480
    v_mfma_f32_16x16x32_bf16 v[108:111], a[156:159], v[212:215], v[108:111]
    v_exp_f32 v199, v199
    v_mfma_f32_16x16x32_bf16 v[112:115], a[160:163], v[212:215], v[112:115]
    ds_read_b128 a[120:123], v242 offset:20480
    v_cvt_pk_bf16_f32 v210, v196, v197
    v_mfma_f32_16x16x32_bf16 v[116:119], a[164:167], v[212:215], v[116:119]
    v_cvt_pk_bf16_f32 v211, v198, v199
    v_mfma_f32_16x16x32_bf16 v[120:123], a[168:171], v[212:215], v[120:123]
    ds_read_b128 a[124:127], v243 offset:20480
    v_mfma_f32_16x16x32_bf16 v[124:127], a[172:175], v[212:215], v[124:127]
    v_exp_f32 v200, v200
    v_mfma_f32_16x16x32_bf16 a[228:231], a[240:243], v[212:215], a[228:231]
    s_waitcnt lgkmcnt(7)
    v_exp_f32 v201, v201
    v_mfma_f32_16x16x32_bf16 v[192:195], a[96:99], a[0:3], v[216:219]
    s_waitcnt lgkmcnt(6)
    v_exp_f32 v202, v202
    v_mfma_f32_16x16x32_bf16 v[192:195], a[100:103], a[12:15], v[192:195]
    s_waitcnt lgkmcnt(5)
    v_exp_f32 v203, v203
    v_mfma_f32_16x16x32_bf16 v[192:195], a[104:107], a[24:27], v[192:195]
    s_waitcnt lgkmcnt(4)
    v_cvt_pk_bf16_f32 v212, v200, v201
    v_cvt_pk_bf16_f32 v213, v202, v203
    v_mfma_f32_16x16x32_bf16 v[192:195], a[108:111], a[36:39], v[192:195]
    s_waitcnt lgkmcnt(3)
    v_exp_f32 v204, v204
    v_mfma_f32_16x16x32_bf16 v[196:199], a[112:115], a[0:3], v[216:219]
    s_waitcnt lgkmcnt(2)
    v_exp_f32 v205, v205
    v_mfma_f32_16x16x32_bf16 v[196:199], a[116:119], a[12:15], v[196:199]
    s_waitcnt lgkmcnt(1)
    v_exp_f32 v206, v206
    v_mfma_f32_16x16x32_bf16 v[196:199], a[120:123], a[24:27], v[196:199]
    s_waitcnt lgkmcnt(0)
    buffer_load_dwordx4 v253, s[12:15], s74 offen offset:1024 nt lds
    v_mfma_f32_16x16x32_bf16 v[196:199], a[124:127], a[36:39], v[196:199]
    v_exp_f32 v207, v207
    v_mfma_f32_16x16x32_bf16 v[128:131], a[144:147], v[208:211], v[128:131]
    v_cvt_pk_bf16_f32 v214, v204, v205
    v_cvt_pk_bf16_f32 v215, v206, v207
    v_mfma_f32_16x16x32_bf16 v[132:135], a[148:151], v[208:211], v[132:135]
    v_exp_f32 v192, v192
    v_mfma_f32_16x16x32_bf16 v[136:139], a[152:155], v[208:211], v[136:139]
    v_exp_f32 v193, v193
    v_mfma_f32_16x16x32_bf16 v[140:143], a[156:159], v[208:211], v[140:143]
    v_exp_f32 v194, v194
    v_mfma_f32_16x16x32_bf16 v[144:147], a[160:163], v[208:211], v[144:147]
    v_exp_f32 v195, v195
    v_mfma_f32_16x16x32_bf16 v[148:151], a[164:167], v[208:211], v[148:151]
    v_mfma_f32_16x16x32_bf16 v[152:155], a[168:171], v[208:211], v[152:155]
    v_mfma_f32_16x16x32_bf16 v[156:159], a[172:175], v[208:211], v[156:159]
    v_mfma_f32_16x16x32_bf16 a[232:235], a[240:243], v[208:211], a[232:235]
    v_mfma_f32_16x16x32_bf16 v[200:203], a[96:99], a[4:7], v[220:223]
    v_cvt_pk_bf16_f32 v208, v192, v193
    v_cvt_pk_bf16_f32 v209, v194, v195
    v_mfma_f32_16x16x32_bf16 v[200:203], a[100:103], a[16:19], v[200:203]
    v_exp_f32 v196, v196
    v_mfma_f32_16x16x32_bf16 v[200:203], a[104:107], a[28:31], v[200:203]
    v_exp_f32 v197, v197
    v_mfma_f32_16x16x32_bf16 v[200:203], a[108:111], a[40:43], v[200:203]
    v_exp_f32 v198, v198
    v_mfma_f32_16x16x32_bf16 v[204:207], a[112:115], a[4:7], v[220:223]
    v_exp_f32 v199, v199
    v_mfma_f32_16x16x32_bf16 v[204:207], a[116:119], a[16:19], v[204:207]
    v_cvt_pk_bf16_f32 v210, v196, v197
    v_cvt_pk_bf16_f32 v211, v198, v199
    v_mfma_f32_16x16x32_bf16 v[204:207], a[120:123], a[28:31], v[204:207]
    s_waitcnt vmcnt(22)
    buffer_load_dwordx4 v254, s[12:15], s74 offen offset:2048 nt lds
    v_mfma_f32_16x16x32_bf16 v[204:207], a[124:127], a[40:43], v[204:207]
    s_barrier
    v_mfma_f32_16x16x32_bf16 v[160:163], a[144:147], v[212:215], v[160:163]
    ds_read_b64_tr_b16 a[144:145], v244 offset:16384
    ds_read_b64_tr_b16 a[146:147], v244 offset:20480
    v_mfma_f32_16x16x32_bf16 v[164:167], a[148:151], v[212:215], v[164:167]
    v_exp_f32 v200, v200
    v_mfma_f32_16x16x32_bf16 v[168:171], a[152:155], v[212:215], v[168:171]
    ds_read_b64_tr_b16 a[148:149], v245 offset:16384
    ds_read_b64_tr_b16 a[150:151], v245 offset:20480
    v_mfma_f32_16x16x32_bf16 v[172:175], a[156:159], v[212:215], v[172:175]
    v_exp_f32 v201, v201
    v_mfma_f32_16x16x32_bf16 v[176:179], a[160:163], v[212:215], v[176:179]
    ds_read_b64_tr_b16 a[152:153], v246 offset:16384
    ds_read_b64_tr_b16 a[154:155], v246 offset:20480
    v_mfma_f32_16x16x32_bf16 v[180:183], a[164:167], v[212:215], v[180:183]
    v_exp_f32 v202, v202
    v_mfma_f32_16x16x32_bf16 v[184:187], a[168:171], v[212:215], v[184:187]
    ds_read_b64_tr_b16 a[156:157], v247 offset:16384
    ds_read_b64_tr_b16 a[158:159], v247 offset:20480
    v_mfma_f32_16x16x32_bf16 v[188:191], a[172:175], v[212:215], v[188:191]
    v_exp_f32 v203, v203
    v_mfma_f32_16x16x32_bf16 a[236:239], a[240:243], v[212:215], a[236:239]
    ds_read_b64_tr_b16 a[160:161], v248 offset:16384
    ds_read_b64_tr_b16 a[162:163], v248 offset:20480
    v_mfma_f32_16x16x32_bf16 v[192:195], a[96:99], a[8:11], v[224:227]
    v_cvt_pk_bf16_f32 v212, v200, v201
    v_cvt_pk_bf16_f32 v213, v202, v203
    v_mfma_f32_16x16x32_bf16 v[192:195], a[100:103], a[20:23], v[192:195]
    ds_read_b64_tr_b16 a[164:165], v249 offset:16384
    ds_read_b64_tr_b16 a[166:167], v249 offset:20480
    v_mfma_f32_16x16x32_bf16 v[192:195], a[104:107], a[32:35], v[192:195]
    v_exp_f32 v204, v204
    v_mfma_f32_16x16x32_bf16 v[192:195], a[108:111], a[44:47], v[192:195]
    ds_read_b64_tr_b16 a[168:169], v250 offset:16384
    ds_read_b64_tr_b16 a[170:171], v250 offset:20480
    v_mfma_f32_16x16x32_bf16 v[196:199], a[112:115], a[8:11], v[224:227]
    v_exp_f32 v205, v205
    v_mfma_f32_16x16x32_bf16 v[196:199], a[116:119], a[20:23], v[196:199]
    ds_read_b64_tr_b16 a[172:173], v251 offset:16384
    ds_read_b64_tr_b16 a[174:175], v251 offset:20480
    v_mfma_f32_16x16x32_bf16 v[196:199], a[120:123], a[32:35], v[196:199]
    buffer_load_dwordx4 v255, s[12:15], s74 offen offset:3072 nt lds
    v_mfma_f32_16x16x32_bf16 v[196:199], a[124:127], a[44:47], v[196:199]
    s_waitcnt lgkmcnt(14)
    v_exp_f32 v206, v206
    v_mfma_f32_16x16x32_bf16 v[0:3], a[144:147], v[208:211], v[0:3]
    s_waitcnt lgkmcnt(12)
    v_exp_f32 v207, v207
    v_mfma_f32_16x16x32_bf16 v[4:7], a[148:151], v[208:211], v[4:7]
    s_waitcnt lgkmcnt(10)
    v_cvt_pk_bf16_f32 v214, v204, v205
    v_cvt_pk_bf16_f32 v215, v206, v207
    v_mfma_f32_16x16x32_bf16 v[8:11], a[152:155], v[208:211], v[8:11]
    s_waitcnt lgkmcnt(8)
    v_exp_f32 v192, v192
    v_mfma_f32_16x16x32_bf16 v[12:15], a[156:159], v[208:211], v[12:15]
    s_waitcnt lgkmcnt(6)
    v_exp_f32 v193, v193
    v_mfma_f32_16x16x32_bf16 v[16:19], a[160:163], v[208:211], v[16:19]
    s_waitcnt lgkmcnt(4)
    v_exp_f32 v194, v194
    v_mfma_f32_16x16x32_bf16 v[20:23], a[164:167], v[208:211], v[20:23]
    s_waitcnt lgkmcnt(2)
    v_exp_f32 v195, v195
    v_mfma_f32_16x16x32_bf16 v[24:27], a[168:171], v[208:211], v[24:27]
    s_waitcnt lgkmcnt(0)
    v_mfma_f32_16x16x32_bf16 v[28:31], a[172:175], v[208:211], v[28:31]
    v_mfma_f32_16x16x32_bf16 a[216:219], a[240:243], v[208:211], a[216:219]
    v_mfma_f32_16x16x32_bf16 v[200:203], a[96:99], a[48:51], v[228:231]
    v_cvt_pk_bf16_f32 v208, v192, v193
    v_cvt_pk_bf16_f32 v209, v194, v195
    v_mfma_f32_16x16x32_bf16 v[200:203], a[100:103], a[60:63], v[200:203]
    s_add_u32 m0, s68, 16384
    v_exp_f32 v196, v196
    v_mfma_f32_16x16x32_bf16 v[200:203], a[104:107], a[72:75], v[200:203]
    s_xor_b32 s74, s38, 57344
    v_exp_f32 v197, v197
    v_mfma_f32_16x16x32_bf16 v[200:203], a[108:111], a[84:87], v[200:203]
    v_exp_f32 v198, v198
    v_mfma_f32_16x16x32_bf16 v[204:207], a[112:115], a[48:51], v[228:231]
    v_exp_f32 v199, v199
    v_mfma_f32_16x16x32_bf16 v[204:207], a[116:119], a[60:63], v[204:207]
    buffer_load_dwordx4 v252, s[8:11], s74 offen offset:0 nt lds
    v_mfma_f32_16x16x32_bf16 v[204:207], a[120:123], a[72:75], v[204:207]
    v_cvt_pk_bf16_f32 v210, v196, v197
    v_cvt_pk_bf16_f32 v211, v198, v199
    v_mfma_f32_16x16x32_bf16 v[204:207], a[124:127], a[84:87], v[204:207]
    v_mfma_f32_16x16x32_bf16 v[32:35], a[144:147], v[212:215], v[32:35]
    v_exp_f32 v200, v200
    v_mfma_f32_16x16x32_bf16 v[36:39], a[148:151], v[212:215], v[36:39]
    v_exp_f32 v201, v201
    v_mfma_f32_16x16x32_bf16 v[40:43], a[152:155], v[212:215], v[40:43]
    v_exp_f32 v202, v202
    v_mfma_f32_16x16x32_bf16 v[44:47], a[156:159], v[212:215], v[44:47]
    v_exp_f32 v203, v203
    v_mfma_f32_16x16x32_bf16 v[48:51], a[160:163], v[212:215], v[48:51]
    v_mfma_f32_16x16x32_bf16 v[52:55], a[164:167], v[212:215], v[52:55]
    v_mfma_f32_16x16x32_bf16 v[56:59], a[168:171], v[212:215], v[56:59]
    v_mfma_f32_16x16x32_bf16 v[60:63], a[172:175], v[212:215], v[60:63]
    v_mfma_f32_16x16x32_bf16 a[220:223], a[240:243], v[212:215], a[220:223]
    v_mfma_f32_16x16x32_bf16 v[192:195], a[96:99], a[52:55], v[232:235]
    v_cvt_pk_bf16_f32 v212, v200, v201
    v_cvt_pk_bf16_f32 v213, v202, v203
    v_mfma_f32_16x16x32_bf16 v[192:195], a[100:103], a[64:67], v[192:195]
    v_exp_f32 v204, v204
    v_mfma_f32_16x16x32_bf16 v[192:195], a[104:107], a[76:79], v[192:195]
    v_exp_f32 v205, v205
    v_mfma_f32_16x16x32_bf16 v[192:195], a[108:111], a[88:91], v[192:195]
    v_exp_f32 v206, v206
    v_mfma_f32_16x16x32_bf16 v[196:199], a[112:115], a[52:55], v[232:235]
    buffer_load_dwordx4 v253, s[8:11], s74 offen offset:1024 nt lds
    v_mfma_f32_16x16x32_bf16 v[196:199], a[116:119], a[64:67], v[196:199]
    v_exp_f32 v207, v207
    v_mfma_f32_16x16x32_bf16 v[196:199], a[120:123], a[76:79], v[196:199]
    v_cvt_pk_bf16_f32 v214, v204, v205
    v_cvt_pk_bf16_f32 v215, v206, v207
    v_mfma_f32_16x16x32_bf16 v[196:199], a[124:127], a[88:91], v[196:199]
    v_mfma_f32_16x16x32_bf16 v[64:67], a[144:147], v[208:211], v[64:67]
    v_exp_f32 v192, v192
    v_mfma_f32_16x16x32_bf16 v[68:71], a[148:151], v[208:211], v[68:71]
    v_exp_f32 v193, v193
    v_mfma_f32_16x16x32_bf16 v[72:75], a[152:155], v[208:211], v[72:75]
    v_exp_f32 v194, v194
    v_mfma_f32_16x16x32_bf16 v[76:79], a[156:159], v[208:211], v[76:79]
    v_exp_f32 v195, v195
    v_mfma_f32_16x16x32_bf16 v[80:83], a[160:163], v[208:211], v[80:83]
    v_mfma_f32_16x16x32_bf16 v[84:87], a[164:167], v[208:211], v[84:87]
    v_mfma_f32_16x16x32_bf16 v[88:91], a[168:171], v[208:211], v[88:91]
    v_mfma_f32_16x16x32_bf16 v[92:95], a[172:175], v[208:211], v[92:95]
    s_waitcnt vmcnt(22)
    v_mfma_f32_16x16x32_bf16 a[224:227], a[240:243], v[208:211], a[224:227]
    s_barrier
    v_mfma_f32_16x16x32_bf16 v[200:203], a[96:99], a[56:59], v[236:239]
    ds_read_b128 a[96:99], v240 offset:24576
    v_cvt_pk_bf16_f32 v208, v192, v193
    v_mfma_f32_16x16x32_bf16 v[200:203], a[100:103], a[68:71], v[200:203]
    v_cvt_pk_bf16_f32 v209, v194, v195
    v_mfma_f32_16x16x32_bf16 v[200:203], a[104:107], a[80:83], v[200:203]
    ds_read_b128 a[100:103], v241 offset:24576
    v_mfma_f32_16x16x32_bf16 v[200:203], a[108:111], a[92:95], v[200:203]
    v_exp_f32 v196, v196
    v_mfma_f32_16x16x32_bf16 v[204:207], a[112:115], a[56:59], v[236:239]
    ds_read_b128 a[104:107], v242 offset:24576
    v_mfma_f32_16x16x32_bf16 v[204:207], a[116:119], a[68:71], v[204:207]
    buffer_load_dwordx4 v254, s[8:11], s74 offen offset:2048 nt lds
    v_mfma_f32_16x16x32_bf16 v[204:207], a[120:123], a[80:83], v[204:207]
    ds_read_b128 a[108:111], v243 offset:24576
    v_mfma_f32_16x16x32_bf16 v[204:207], a[124:127], a[92:95], v[204:207]
    v_exp_f32 v197, v197
    v_mfma_f32_16x16x32_bf16 v[96:99], a[144:147], v[212:215], v[96:99]
    ds_read_b128 a[112:115], v240 offset:28672
    v_mfma_f32_16x16x32_bf16 v[100:103], a[148:151], v[212:215], v[100:103]
    v_exp_f32 v198, v198
    v_mfma_f32_16x16x32_bf16 v[104:107], a[152:155], v[212:215], v[104:107]
    ds_read_b128 a[116:119], v241 offset:28672
    v_mfma_f32_16x16x32_bf16 v[108:111], a[156:159], v[212:215], v[108:111]
    v_exp_f32 v199, v199
    v_mfma_f32_16x16x32_bf16 v[112:115], a[160:163], v[212:215], v[112:115]
    ds_read_b128 a[120:123], v242 offset:28672
    v_cvt_pk_bf16_f32 v210, v196, v197
    v_mfma_f32_16x16x32_bf16 v[116:119], a[164:167], v[212:215], v[116:119]
    v_cvt_pk_bf16_f32 v211, v198, v199
    v_mfma_f32_16x16x32_bf16 v[120:123], a[168:171], v[212:215], v[120:123]
    ds_read_b128 a[124:127], v243 offset:28672
    v_mfma_f32_16x16x32_bf16 v[124:127], a[172:175], v[212:215], v[124:127]
    v_exp_f32 v200, v200
    v_mfma_f32_16x16x32_bf16 a[228:231], a[240:243], v[212:215], a[228:231]
    s_waitcnt lgkmcnt(7)
    v_exp_f32 v201, v201
    v_mfma_f32_16x16x32_bf16 v[192:195], a[96:99], a[0:3], v[216:219]
    s_waitcnt lgkmcnt(6)
    v_exp_f32 v202, v202
    v_mfma_f32_16x16x32_bf16 v[192:195], a[100:103], a[12:15], v[192:195]
    s_waitcnt lgkmcnt(5)
    v_exp_f32 v203, v203
    v_mfma_f32_16x16x32_bf16 v[192:195], a[104:107], a[24:27], v[192:195]
    s_waitcnt lgkmcnt(4)
    v_cvt_pk_bf16_f32 v212, v200, v201
    v_cvt_pk_bf16_f32 v213, v202, v203
    v_mfma_f32_16x16x32_bf16 v[192:195], a[108:111], a[36:39], v[192:195]
    s_waitcnt lgkmcnt(3)
    buffer_load_dwordx4 v255, s[8:11], s74 offen offset:3072 nt lds
    v_mfma_f32_16x16x32_bf16 v[196:199], a[112:115], a[0:3], v[216:219]
    s_waitcnt lgkmcnt(2)
    v_exp_f32 v204, v204
    v_mfma_f32_16x16x32_bf16 v[196:199], a[116:119], a[12:15], v[196:199]
    s_waitcnt lgkmcnt(1)
    v_exp_f32 v205, v205
    v_mfma_f32_16x16x32_bf16 v[196:199], a[120:123], a[24:27], v[196:199]
    s_waitcnt lgkmcnt(0)
    v_exp_f32 v206, v206
    v_mfma_f32_16x16x32_bf16 v[196:199], a[124:127], a[36:39], v[196:199]
    v_exp_f32 v207, v207
    v_mfma_f32_16x16x32_bf16 v[128:131], a[144:147], v[208:211], v[128:131]
    v_cvt_pk_bf16_f32 v214, v204, v205
    v_cvt_pk_bf16_f32 v215, v206, v207
    v_mfma_f32_16x16x32_bf16 v[132:135], a[148:151], v[208:211], v[132:135]
    v_exp_f32 v192, v192
    v_mfma_f32_16x16x32_bf16 v[136:139], a[152:155], v[208:211], v[136:139]
    v_exp_f32 v193, v193
    v_mfma_f32_16x16x32_bf16 v[140:143], a[156:159], v[208:211], v[140:143]
    v_exp_f32 v194, v194
    v_mfma_f32_16x16x32_bf16 v[144:147], a[160:163], v[208:211], v[144:147]
    v_exp_f32 v195, v195
    v_mfma_f32_16x16x32_bf16 v[148:151], a[164:167], v[208:211], v[148:151]
    v_mfma_f32_16x16x32_bf16 v[152:155], a[168:171], v[208:211], v[152:155]
    v_mfma_f32_16x16x32_bf16 v[156:159], a[172:175], v[208:211], v[156:159]
    v_mfma_f32_16x16x32_bf16 a[232:235], a[240:243], v[208:211], a[232:235]
    s_add_u32 m0, s68, 98304
    v_mfma_f32_16x16x32_bf16 v[200:203], a[96:99], a[4:7], v[220:223]
    s_xor_b32 s74, s38, 57344
    v_cvt_pk_bf16_f32 v208, v192, v193
    v_cvt_pk_bf16_f32 v209, v194, v195
    v_mfma_f32_16x16x32_bf16 v[200:203], a[100:103], a[16:19], v[200:203]
    v_exp_f32 v196, v196
    v_mfma_f32_16x16x32_bf16 v[200:203], a[104:107], a[28:31], v[200:203]
    v_exp_f32 v197, v197
    v_mfma_f32_16x16x32_bf16 v[200:203], a[108:111], a[40:43], v[200:203]
    buffer_load_dwordx4 v252, s[12:15], s74 offen offset:0 nt lds
    v_mfma_f32_16x16x32_bf16 v[204:207], a[112:115], a[4:7], v[220:223]
    v_exp_f32 v198, v198
    v_mfma_f32_16x16x32_bf16 v[204:207], a[116:119], a[16:19], v[204:207]
    v_exp_f32 v199, v199
    v_mfma_f32_16x16x32_bf16 v[204:207], a[120:123], a[28:31], v[204:207]
    s_waitcnt vmcnt(21)
    v_cvt_pk_bf16_f32 v210, v196, v197
    v_cvt_pk_bf16_f32 v211, v198, v199
    v_mfma_f32_16x16x32_bf16 v[204:207], a[124:127], a[40:43], v[204:207]
    s_barrier
    v_mfma_f32_16x16x32_bf16 v[160:163], a[144:147], v[212:215], v[160:163]
    ds_read_b64_tr_b16 a[144:145], v244 offset:24576
    ds_read_b64_tr_b16 a[146:147], v244 offset:28672
    v_mfma_f32_16x16x32_bf16 v[164:167], a[148:151], v[212:215], v[164:167]
    v_exp_f32 v200, v200
    v_mfma_f32_16x16x32_bf16 v[168:171], a[152:155], v[212:215], v[168:171]
    ds_read_b64_tr_b16 a[148:149], v245 offset:24576
    ds_read_b64_tr_b16 a[150:151], v245 offset:28672
    v_mfma_f32_16x16x32_bf16 v[172:175], a[156:159], v[212:215], v[172:175]
    v_exp_f32 v201, v201
    v_mfma_f32_16x16x32_bf16 v[176:179], a[160:163], v[212:215], v[176:179]
    ds_read_b64_tr_b16 a[152:153], v246 offset:24576
    ds_read_b64_tr_b16 a[154:155], v246 offset:28672
    v_mfma_f32_16x16x32_bf16 v[180:183], a[164:167], v[212:215], v[180:183]
    v_exp_f32 v202, v202
    v_mfma_f32_16x16x32_bf16 v[184:187], a[168:171], v[212:215], v[184:187]
    ds_read_b64_tr_b16 a[156:157], v247 offset:24576
    ds_read_b64_tr_b16 a[158:159], v247 offset:28672
    v_mfma_f32_16x16x32_bf16 v[188:191], a[172:175], v[212:215], v[188:191]
    v_exp_f32 v203, v203
    v_mfma_f32_16x16x32_bf16 a[236:239], a[240:243], v[212:215], a[236:239]
    ds_read_b64_tr_b16 a[160:161], v248 offset:24576
    ds_read_b64_tr_b16 a[162:163], v248 offset:28672
    v_mfma_f32_16x16x32_bf16 v[192:195], a[96:99], a[8:11], v[224:227]
    v_cvt_pk_bf16_f32 v212, v200, v201
    v_cvt_pk_bf16_f32 v213, v202, v203
    v_mfma_f32_16x16x32_bf16 v[192:195], a[100:103], a[20:23], v[192:195]
    ds_read_b64_tr_b16 a[164:165], v249 offset:24576
    ds_read_b64_tr_b16 a[166:167], v249 offset:28672
    v_mfma_f32_16x16x32_bf16 v[192:195], a[104:107], a[32:35], v[192:195]
    buffer_load_dwordx4 v253, s[12:15], s74 offen offset:1024 nt lds
    v_mfma_f32_16x16x32_bf16 v[192:195], a[108:111], a[44:47], v[192:195]
    ds_read_b64_tr_b16 a[168:169], v250 offset:24576
    ds_read_b64_tr_b16 a[170:171], v250 offset:28672
    v_mfma_f32_16x16x32_bf16 v[196:199], a[112:115], a[8:11], v[224:227]
    v_exp_f32 v204, v204
    v_mfma_f32_16x16x32_bf16 v[196:199], a[116:119], a[20:23], v[196:199]
    ds_read_b64_tr_b16 a[172:173], v251 offset:24576
    ds_read_b64_tr_b16 a[174:175], v251 offset:28672
    v_mfma_f32_16x16x32_bf16 v[196:199], a[120:123], a[32:35], v[196:199]
    v_exp_f32 v205, v205
    v_mfma_f32_16x16x32_bf16 v[196:199], a[124:127], a[44:47], v[196:199]
    s_waitcnt lgkmcnt(14)
    v_exp_f32 v206, v206
    v_mfma_f32_16x16x32_bf16 v[0:3], a[144:147], v[208:211], v[0:3]
    s_waitcnt lgkmcnt(12)
    v_exp_f32 v207, v207
    v_mfma_f32_16x16x32_bf16 v[4:7], a[148:151], v[208:211], v[4:7]
    s_waitcnt lgkmcnt(10)
    v_cvt_pk_bf16_f32 v214, v204, v205
    v_cvt_pk_bf16_f32 v215, v206, v207
    v_mfma_f32_16x16x32_bf16 v[8:11], a[152:155], v[208:211], v[8:11]
    s_waitcnt lgkmcnt(8)
    v_exp_f32 v192, v192
    v_mfma_f32_16x16x32_bf16 v[12:15], a[156:159], v[208:211], v[12:15]
    s_waitcnt lgkmcnt(6)
    v_exp_f32 v193, v193
    v_mfma_f32_16x16x32_bf16 v[16:19], a[160:163], v[208:211], v[16:19]
    s_waitcnt lgkmcnt(4)
    v_exp_f32 v194, v194
    v_mfma_f32_16x16x32_bf16 v[20:23], a[164:167], v[208:211], v[20:23]
    s_waitcnt lgkmcnt(2)
    v_exp_f32 v195, v195
    v_mfma_f32_16x16x32_bf16 v[24:27], a[168:171], v[208:211], v[24:27]
    s_waitcnt lgkmcnt(0)
    v_mfma_f32_16x16x32_bf16 v[28:31], a[172:175], v[208:211], v[28:31]
    v_mfma_f32_16x16x32_bf16 a[216:219], a[240:243], v[208:211], a[216:219]
    v_mfma_f32_16x16x32_bf16 v[200:203], a[96:99], a[48:51], v[228:231]
    v_cvt_pk_bf16_f32 v208, v192, v193
    v_cvt_pk_bf16_f32 v209, v194, v195
    v_mfma_f32_16x16x32_bf16 v[200:203], a[100:103], a[60:63], v[200:203]
    v_exp_f32 v196, v196
    v_mfma_f32_16x16x32_bf16 v[200:203], a[104:107], a[72:75], v[200:203]
    buffer_load_dwordx4 v254, s[12:15], s74 offen offset:2048 nt lds
    v_mfma_f32_16x16x32_bf16 v[200:203], a[108:111], a[84:87], v[200:203]
    v_exp_f32 v197, v197
    v_mfma_f32_16x16x32_bf16 v[204:207], a[112:115], a[48:51], v[228:231]
    v_exp_f32 v198, v198
    v_mfma_f32_16x16x32_bf16 v[204:207], a[116:119], a[60:63], v[204:207]
    v_exp_f32 v199, v199
    v_mfma_f32_16x16x32_bf16 v[204:207], a[120:123], a[72:75], v[204:207]
    v_cvt_pk_bf16_f32 v210, v196, v197
    v_cvt_pk_bf16_f32 v211, v198, v199
    v_mfma_f32_16x16x32_bf16 v[204:207], a[124:127], a[84:87], v[204:207]
    v_mfma_f32_16x16x32_bf16 v[32:35], a[144:147], v[212:215], v[32:35]
    v_exp_f32 v200, v200
    v_mfma_f32_16x16x32_bf16 v[36:39], a[148:151], v[212:215], v[36:39]
    v_exp_f32 v201, v201
    v_mfma_f32_16x16x32_bf16 v[40:43], a[152:155], v[212:215], v[40:43]
    v_exp_f32 v202, v202
    v_mfma_f32_16x16x32_bf16 v[44:47], a[156:159], v[212:215], v[44:47]
L_hopa_5:
    s_cbranch_execz L_backa
    v_exp_f32 v203, v203
    v_mfma_f32_16x16x32_bf16 v[48:51], a[160:163], v[212:215], v[48:51]
    v_mfma_f32_16x16x32_bf16 v[52:55], a[164:167], v[212:215], v[52:55]
    v_mfma_f32_16x16x32_bf16 v[56:59], a[168:171], v[212:215], v[56:59]
    v_mfma_f32_16x16x32_bf16 v[60:63], a[172:175], v[212:215], v[60:63]
    v_mfma_f32_16x16x32_bf16 a[220:223], a[240:243], v[212:215], a[220:223]
    v_mfma_f32_16x16x32_bf16 v[192:195], a[96:99], a[52:55], v[232:235]
    v_cvt_pk_bf16_f32 v212, v200, v201
    v_cvt_pk_bf16_f32 v213, v202, v203
    v_mfma_f32_16x16x32_bf16 v[192:195], a[100:103], a[64:67], v[192:195]
    buffer_load_dwordx4 v255, s[12:15], s74 offen offset:3072 nt lds
    v_mfma_f32_16x16x32_bf16 v[192:195], a[104:107], a[76:79], v[192:195]
    v_exp_f32 v204, v204
    v_mfma_f32_16x16x32_bf16 v[192:195], a[108:111], a[88:91], v[192:195]
    v_exp_f32 v205, v205
    v_mfma_f32_16x16x32_bf16 v[196:199], a[112:115], a[52:55], v[232:235]
    v_exp_f32 v206, v206
    v_mfma_f32_16x16x32_bf16 v[196:199], a[116:119], a[64:67], v[196:199]
    v_exp_f32 v207, v207
    v_mfma_f32_16x16x32_bf16 v[196:199], a[120:123], a[76:79], v[196:199]
    v_cvt_pk_bf16_f32 v214, v204, v205
    v_cvt_pk_bf16_f32 v215, v206, v207
    v_mfma_f32_16x16x32_bf16 v[196:199], a[124:127], a[88:91], v[196:199]
    v_mfma_f32_16x16x32_bf16 v[64:67], a[144:147], v[208:211], v[64:67]
    v_exp_f32 v192, v192
    v_mfma_f32_16x16x32_bf16 v[68:71], a[148:151], v[208:211], v[68:71]
    v_exp_f32 v193, v193
    v_mfma_f32_16x16x32_bf16 v[72:75], a[152:155], v[208:211], v[72:75]
    v_exp_f32 v194, v194
    v_mfma_f32_16x16x32_bf16 v[76:79], a[156:159], v[208:211], v[76:79]
    v_exp_f32 v195, v195
    v_mfma_f32_16x16x32_bf16 v[80:83], a[160:163], v[208:211], v[80:83]
    v_mfma_f32_16x16x32_bf16 v[84:87], a[164:167], v[208:211], v[84:87]
    v_mfma_f32_16x16x32_bf16 v[88:91], a[168:171], v[208:211], v[88:91]
    s_add_u32 m0, s68, 24576
    v_mfma_f32_16x16x32_bf16 v[92:95], a[172:175], v[208:211], v[92:95]
    s_waitcnt vmcnt(16)
    v_mfma_f32_16x16x32_bf16 a[224:227], a[240:243], v[208:211], a[224:227]
    s_barrier
    v_mfma_f32_16x16x32_bf16 v[200:203], a[96:99], a[56:59], v[236:239]
    s_xor_b32 s74, s38, 65536
    ds_read_b128 a[96:99], v240 offset:32768
    v_cvt_pk_bf16_f32 v208, v192, v193
    v_mfma_f32_16x16x32_bf16 v[200:203], a[100:103], a[68:71], v[200:203]
    buffer_load_dwordx4 v252, s[8:11], s74 offen offset:0 nt lds
    v_mfma_f32_16x16x32_bf16 v[200:203], a[104:107], a[80:83], v[200:203]
    ds_read_b128 a[100:103], v241 offset:32768
    v_cvt_pk_bf16_f32 v209, v194, v195
    v_mfma_f32_16x16x32_bf16 v[200:203], a[108:111], a[92:95], v[200:203]
    v_exp_f32 v196, v196
    v_mfma_f32_16x16x32_bf16 v[204:207], a[112:115], a[56:59], v[236:239]
    ds_read_b128 a[104:107], v242 offset:32768
    v_mfma_f32_16x16x32_bf16 v[204:207], a[116:119], a[68:71], v[204:207]
    v_exp_f32 v197, v197
    v_mfma_f32_16x16x32_bf16 v[204:207], a[120:123], a[80:83], v[204:207]
    ds_read_b128 a[108:111], v243 offset:32768
    v_mfma_f32_16x16x32_bf16 v[204:207], a[124:127], a[92:95], v[204:207]
    v_exp_f32 v198, v198
    v_mfma_f32_16x16x32_bf16 v[96:99], a[144:147], v[212:215], v[96:99]
    ds_read_b128 a[112:115], v240 offset:36864
    v_mfma_f32_16x16x32_bf16 v[100:103], a[148:151], v[212:215], v[100:103]
    v_exp_f32 v199, v199
    v_mfma_f32_16x16x32_bf16 v[104:107], a[152:155], v[212:215], v[104:107]
    ds_read_b128 a[116:119], v241 offset:36864
    v_cvt_pk_bf16_f32 v210, v196, v197
    v_mfma_f32_16x16x32_bf16 v[108:111], a[156:159], v[212:215], v[108:111]
    v_cvt_pk_bf16_f32 v211, v198, v199
    v_mfma_f32_16x16x32_bf16 v[112:115], a[160:163], v[212:215], v[112:115]
    ds_read_b128 a[120:123], v242 offset:36864
    v_mfma_f32_16x16x32_bf16 v[116:119], a[164:167], v[212:215], v[116:119]
    v_exp_f32 v200, v200
    v_mfma_f32_16x16x32_bf16 v[120:123], a[168:171], v[212:215], v[120:123]
    ds_read_b128 a[124:127], v243 offset:36864
    v_mfma_f32_16x16x32_bf16 v[124:127], a[172:175], v[212:215], v[124:127]
    v_exp_f32 v201, v201
    v_mfma_f32_16x16x32_bf16 a[228:231], a[240:243], v[212:215], a[228:231]
    s_waitcnt lgkmcnt(7)
    v_exp_f32 v202, v202
    v_mfma_f32_16x16x32_bf16 v[192:195], a[96:99], a[0:3], v[216:219]
    s_waitcnt lgkmcnt(6)
    buffer_load_dwordx4 v253, s[8:11], s74 offen offset:1024 nt lds
    v_mfma_f32_16x16x32_bf16 v[192:195], a[100:103], a[12:15], v[192:195]
    s_waitcnt lgkmcnt(5)
    v_exp_f32 v203, v203
    v_mfma_f32_16x16x32_bf16 v[192:195], a[104:107], a[24:27], v[192:195]
    s_waitcnt lgkmcnt(4)
    v_cvt_pk_bf16_f32 v212, v200, v201
    v_cvt_pk_bf16_f32 v213, v202, v203
    v_mfma_f32_16x16x32_bf16 v[192:195], a[108:111], a[36:39], v[192:195]
    s_waitcnt lgkmcnt(3)
    v_exp_f32 v204, v204
    v_mfma_f32_16x16x32_bf16 v[196:199], a[112:115], a[0:3], v[216:219]
    s_waitcnt lgkmcnt(2)
    v_exp_f32 v205, v205
    v_mfma_f32_16x16x32_bf16 v[196:199], a[116:119], a[12:15], v[196:199]
    s_waitcnt lgkmcnt(1)
    v_exp_f32 v206, v206
    v_mfma_f32_16x16x32_bf16 v[196:199], a[120:123], a[24:27], v[196:199]
    s_waitcnt lgkmcnt(0)
    v_exp_f32 v207, v207
    v_mfma_f32_16x16x32_bf16 v[196:199], a[124:127], a[36:39], v[196:199]
    v_cvt_pk_bf16_f32 v214, v204, v205
    v_cvt_pk_bf16_f32 v215, v206, v207
    v_mfma_f32_16x16x32_bf16 v[128:131], a[144:147], v[208:211], v[128:131]
    v_exp_f32 v192, v192
    v_mfma_f32_16x16x32_bf16 v[132:135], a[148:151], v[208:211], v[132:135]
    v_exp_f32 v193, v193
    v_mfma_f32_16x16x32_bf16 v[136:139], a[152:155], v[208:211], v[136:139]
    v_exp_f32 v194, v194
    v_mfma_f32_16x16x32_bf16 v[140:143], a[156:159], v[208:211], v[140:143]
    v_exp_f32 v195, v195
    v_mfma_f32_16x16x32_bf16 v[144:147], a[160:163], v[208:211], v[144:147]
    v_mfma_f32_16x16x32_bf16 v[148:151], a[164:167], v[208:211], v[148:151]
    v_mfma_f32_16x16x32_bf16 v[152:155], a[168:171], v[208:211], v[152:155]
    v_mfma_f32_16x16x32_bf16 v[156:159], a[172:175], v[208:211], v[156:159]
    v_mfma_f32_16x16x32_bf16 a[232:235], a[240:243], v[208:211], a[232:235]
    v_mfma_f32_16x16x32_bf16 v[200:203], a[96:99], a[4:7], v[220:223]
    buffer_load_dwordx4 v254, s[8:11], s74 offen offset:2048 nt lds
    v_mfma_f32_16x16x32_bf16 v[200:203], a[100:103], a[16:19], v[200:203]
    v_cvt_pk_bf16_f32 v208, v192, v193
    v_cvt_pk_bf16_f32 v209, v194, v195
    v_mfma_f32_16x16x32_bf16 v[200:203], a[104:107], a[28:31], v[200:203]
    v_exp_f32 v196, v196
    v_mfma_f32_16x16x32_bf16 v[200:203], a[108:111], a[40:43], v[200:203]
    v_exp_f32 v197, v197
    v_mfma_f32_16x16x32_bf16 v[204:207], a[112:115], a[4:7], v[220:223]
    v_exp_f32 v198, v198
    v_mfma_f32_16x16x32_bf16 v[204:207], a[116:119], a[16:19], v[204:207]
    v_exp_f32 v199, v199
    v_mfma_f32_16x16x32_bf16 v[204:207], a[120:123], a[28:31], v[204:207]
    v_cvt_pk_bf16_f32 v210, v196, v197
    v_cvt_pk_bf16_f32 v211, v198, v199
    v_mfma_f32_16x16x32_bf16 v[204:207], a[124:127], a[40:43], v[204:207]
    v_mfma_f32_16x16x32_bf16 v[160:163], a[144:147], v[212:215], v[160:163]
    ds_read_b64_tr_b16 a[144:145], v244 offset:32768
    ds_read_b64_tr_b16 a[146:147], v244 offset:36864
    v_mfma_f32_16x16x32_bf16 v[164:167], a[148:151], v[212:215], v[164:167]
    v_exp_f32 v200, v200
    v_mfma_f32_16x16x32_bf16 v[168:171], a[152:155], v[212:215], v[168:171]
    ds_read_b64_tr_b16 a[148:149], v245 offset:32768
    ds_read_b64_tr_b16 a[150:151], v245 offset:36864
    v_mfma_f32_16x16x32_bf16 v[172:175], a[156:159], v[212:215], v[172:175]
    v_exp_f32 v201, v201
    v_mfma_f32_16x16x32_bf16 v[176:179], a[160:163], v[212:215], v[176:179]
    ds_read_b64_tr_b16 a[152:153], v246 offset:32768
    ds_read_b64_tr_b16 a[154:155], v246 offset:36864
    v_mfma_f32_16x16x32_bf16 v[180:183], a[164:167], v[212:215], v[180:183]
    v_exp_f32 v202, v202
    v_mfma_f32_16x16x32_bf16 v[184:187], a[168:171], v[212:215], v[184:187]
    ds_read_b64_tr_b16 a[156:157], v247 offset:32768
    ds_read_b64_tr_b16 a[158:159], v247 offset:36864
    v_mfma_f32_16x16x32_bf16 v[188:191], a[172:175], v[212:215], v[188:191]
    v_exp_f32 v203, v203
    v_mfma_f32_16x16x32_bf16 a[236:239], a[240:243], v[212:215], a[236:239]
    ds_read_b64_tr_b16 a[160:161], v248 offset:32768
    ds_read_b64_tr_b16 a[162:163], v248 offset:36864
    v_mfma_f32_16x16x32_bf16 v[192:195], a[96:99], a[8:11], v[224:227]
    buffer_load_dwordx4 v255, s[8:11], s74 offen offset:3072 nt lds
    v_mfma_f32_16x16x32_bf16 v[192:195], a[100:103], a[20:23], v[192:195]
    ds_read_b64_tr_b16 a[164:165], v249 offset:32768
    ds_read_b64_tr_b16 a[166:167], v249 offset:36864
    v_mfma_f32_16x16x32_bf16 v[192:195], a[104:107], a[32:35], v[192:195]
    v_cvt_pk_bf16_f32 v212, v200, v201
    v_cvt_pk_bf16_f32 v213, v202, v203
    v_mfma_f32_16x16x32_bf16 v[192:195], a[108:111], a[44:47], v[192:195]
    ds_read_b64_tr_b16 a[168:169], v250 offset:32768
    ds_read_b64_tr_b16 a[170:171], v250 offset:36864
    v_mfma_f32_16x16x32_bf16 v[196:199], a[112:115], a[8:11], v[224:227]
    v_exp_f32 v204, v204
    v_mfma_f32_16x16x32_bf16 v[196:199], a[116:119], a[20:23], v[196:199]
    ds_read_b64_tr_b16 a[172:173], v251 offset:32768
    ds_read_b64_tr_b16 a[174:175], v251 offset:36864
    v_mfma_f32_16x16x32_bf16 v[196:199], a[120:123], a[32:35], v[196:199]
    v_exp_f32 v205, v205
    v_mfma_f32_16x16x32_bf16 v[196:199], a[124:127], a[44:47], v[196:199]
    s_waitcnt lgkmcnt(14)
    v_exp_f32 v206, v206
    v_mfma_f32_16x16x32_bf16 v[0:3], a[144:147], v[208:211], v[0:3]
    s_waitcnt lgkmcnt(12)
    v_exp_f32 v207, v207
    v_mfma_f32_16x16x32_bf16 v[4:7], a[148:151], v[208:211], v[4:7]
    s_waitcnt lgkmcnt(10)
    v_cvt_pk_bf16_f32 v214, v204, v205
    v_cvt_pk_bf16_f32 v215, v206, v207
    v_mfma_f32_16x16x32_bf16 v[8:11], a[152:155], v[208:211], v[8:11]
    s_waitcnt lgkmcnt(8)
    v_exp_f32 v192, v192
    v_mfma_f32_16x16x32_bf16 v[12:15], a[156:159], v[208:211], v[12:15]
    s_waitcnt lgkmcnt(6)
    v_exp_f32 v193, v193
    v_mfma_f32_16x16x32_bf16 v[16:19], a[160:163], v[208:211], v[16:19]
    s_waitcnt lgkmcnt(4)
    s_add_u32 m0, s68, 106496
    v_exp_f32 v194, v194
    v_mfma_f32_16x16x32_bf16 v[20:23], a[164:167], v[208:211], v[20:23]
    s_waitcnt lgkmcnt(2)
    s_xor_b32 s74, s38, 65536
    v_exp_f32 v195, v195
    v_mfma_f32_16x16x32_bf16 v[24:27], a[168:171], v[208:211], v[24:27]
    s_waitcnt lgkmcnt(0)
    v_mfma_f32_16x16x32_bf16 v[28:31], a[172:175], v[208:211], v[28:31]
    v_mfma_f32_16x16x32_bf16 a[216:219], a[240:243], v[208:211], a[216:219]
    buffer_load_dwordx4 v252, s[12:15], s74 offen offset:0 nt lds
    v_mfma_f32_16x16x32_bf16 v[200:203], a[96:99], a[48:51], v[228:231]
    v_cvt_pk_bf16_f32 v208, v192, v193
    v_cvt_pk_bf16_f32 v209, v194, v195
    v_mfma_f32_16x16x32_bf16 v[200:203], a[100:103], a[60:63], v[200:203]
    v_exp_f32 v196, v196
    v_mfma_f32_16x16x32_bf16 v[200:203], a[104:107], a[72:75], v[200:203]
    v_exp_f32 v197, v197
    v_mfma_f32_16x16x32_bf16 v[200:203], a[108:111], a[84:87], v[200:203]
    v_exp_f32 v198, v198
    v_mfma_f32_16x16x32_bf16 v[204:207], a[112:115], a[48:51], v[228:231]
    v_exp_f32 v199, v199
    v_mfma_f32_16x16x32_bf16 v[204:207], a[116:119], a[60:63], v[204:207]
    v_cvt_pk_bf16_f32 v210, v196, v197
    v_cvt_pk_bf16_f32 v211, v198, v199
    v_mfma_f32_16x16x32_bf16 v[204:207], a[120:123], a[72:75], v[204:207]
    v_mfma_f32_16x16x32_bf16 v[204:207], a[124:127], a[84:87], v[204:207]
    v_mfma_f32_16x16x32_bf16 v[32:35], a[144:147], v[212:215], v[32:35]
    v_exp_f32 v200, v200
    v_mfma_f32_16x16x32_bf16 v[36:39], a[148:151], v[212:215], v[36:39]
    v_exp_f32 v201, v201
    v_mfma_f32_16x16x32_bf16 v[40:43], a[152:155], v[212:215], v[40:43]
    v_exp_f32 v202, v202
    v_mfma_f32_16x16x32_bf16 v[44:47], a[156:159], v[212:215], v[44:47]
    v_exp_f32 v203, v203
    v_mfma_f32_16x16x32_bf16 v[48:51], a[160:163], v[212:215], v[48:51]
    v_mfma_f32_16x16x32_bf16 v[52:55], a[164:167], v[212:215], v[52:55]
    v_mfma_f32_16x16x32_bf16 v[56:59], a[168:171], v[212:215], v[56:59]
    v_mfma_f32_16x16x32_bf16 v[60:63], a[172:175], v[212:215], v[60:63]
    buffer_load_dwordx4 v253, s[12:15], s74 offen offset:1024 nt lds
    v_mfma_f32_16x16x32_bf16 a[220:223], a[240:243], v[212:215], a[220:223]
    v_mfma_f32_16x16x32_bf16 v[192:195], a[96:99], a[52:55], v[232:235]
    v_cvt_pk_bf16_f32 v212, v200, v201
    v_cvt_pk_bf16_f32 v213, v202, v203
    v_mfma_f32_16x16x32_bf16 v[192:195], a[100:103], a[64:67], v[192:195]
    v_exp_f32 v204, v204
    v_mfma_f32_16x16x32_bf16 v[192:195], a[104:107], a[76:79], v[192:195]
    v_exp_f32 v205, v205
    v_mfma_f32_16x16x32_bf16 v[192:195], a[108:111], a[88:91], v[192:195]
    v_exp_f32 v206, v206
    v_mfma_f32_16x16x32_bf16 v[196:199], a[112:115], a[52:55], v[232:235]
    v_exp_f32 v207, v207
    v_mfma_f32_16x16x32_bf16 v[196:199], a[116:119], a[64:67], v[196:199]
    v_cvt_pk_bf16_f32 v214, v204, v205
    v_cvt_pk_bf16_f32 v215, v206, v207
    v_mfma_f32_16x16x32_bf16 v[196:199], a[120:123], a[76:79], v[196:199]
    v_mfma_f32_16x16x32_bf16 v[196:199], a[124:127], a[88:91], v[196:199]
    v_mfma_f32_16x16x32_bf16 v[64:67], a[144:147], v[208:211], v[64:67]
    v_exp_f32 v192, v192
    v_mfma_f32_16x16x32_bf16 v[68:71], a[148:151], v[208:211], v[68:71]
    v_exp_f32 v193, v193
    v_mfma_f32_16x16x32_bf16 v[72:75], a[152:155], v[208:211], v[72:75]
    v_exp_f32 v194, v194
    v_mfma_f32_16x16x32_bf16 v[76:79], a[156:159], v[208:211], v[76:79]
    v_exp_f32 v195, v195
    v_mfma_f32_16x16x32_bf16 v[80:83], a[160:163], v[208:211], v[80:83]
    v_mfma_f32_16x16x32_bf16 v[84:87], a[164:167], v[208:211], v[84:87]
    v_mfma_f32_16x16x32_bf16 v[88:91], a[168:171], v[208:211], v[88:91]
    v_mfma_f32_16x16x32_bf16 v[92:95], a[172:175], v[208:211], v[92:95]
    buffer_load_dwordx4 v254, s[12:15], s74 offen offset:2048 nt lds
    v_mfma_f32_16x16x32_bf16 a[224:227], a[240:243], v[208:211], a[224:227]
    s_barrier
    v_mfma_f32_16x16x32_bf16 v[200:203], a[96:99], a[56:59], v[236:239]
    ds_read_b128 a[96:99], v240 offset:0
    v_cvt_pk_bf16_f32 v208, v192, v193
    v_mfma_f32_16x16x32_bf16 v[200:203], a[100:103], a[68:71], v[200:203]
    v_cvt_pk_bf16_f32 v209, v194, v195
    v_mfma_f32_16x16x32_bf16 v[200:203], a[104:107], a[80:83], v[200:203]
    ds_read_b128 a[100:103], v241 offset:0
    v_mfma_f32_16x16x32_bf16 v[200:203], a[108:111], a[92:95], v[200:203]
    v_exp_f32 v196, v196
    v_mfma_f32_16x16x32_bf16 v[204:207], a[112:115], a[56:59], v[236:239]
    ds_read_b128 a[104:107], v242 offset:0
    v_mfma_f32_16x16x32_bf16 v[204:207], a[116:119], a[68:71], v[204:207]
    v_exp_f32 v197, v197
    v_mfma_f32_16x16x32_bf16 v[204:207], a[120:123], a[80:83], v[204:207]
    ds_read_b128 a[108:111], v243 offset:0
    v_mfma_f32_16x16x32_bf16 v[204:207], a[124:127], a[92:95], v[204:207]
    v_exp_f32 v198, v198
    v_mfma_f32_16x16x32_bf16 v[96:99], a[144:147], v[212:215], v[96:99]
    ds_read_b128 a[112:115], v240 offset:4096
    v_mfma_f32_16x16x32_bf16 v[100:103], a[148:151], v[212:215], v[100:103]
    v_exp_f32 v199, v199
    v_mfma_f32_16x16x32_bf16 v[104:107], a[152:155], v[212:215], v[104:107]
    ds_read_b128 a[116:119], v241 offset:4096
    v_cvt_pk_bf16_f32 v210, v196, v197
    v_mfma_f32_16x16x32_bf16 v[108:111], a[156:159], v[212:215], v[108:111]
    v_cvt_pk_bf16_f32 v211, v198, v199
    v_mfma_f32_16x16x32_bf16 v[112:115], a[160:163], v[212:215], v[112:115]
    ds_read_b128 a[120:123], v242 offset:4096
    v_mfma_f32_16x16x32_bf16 v[116:119], a[164:167], v[212:215], v[116:119]
    v_exp_f32 v200, v200
    v_mfma_f32_16x16x32_bf16 v[120:123], a[168:171], v[212:215], v[120:123]
    ds_read_b128 a[124:127], v243 offset:4096
    v_mfma_f32_16x16x32_bf16 v[124:127], a[172:175], v[212:215], v[124:127]
    buffer_load_dwordx4 v255, s[12:15], s74 offen offset:3072 nt lds
    v_mfma_f32_16x16x32_bf16 a[228:231], a[240:243], v[212:215], a[228:231]
    s_waitcnt lgkmcnt(7)
    v_exp_f32 v201, v201
    v_mfma_f32_16x16x32_bf16 v[192:195], a[96:99], a[0:3], v[216:219]
    s_waitcnt lgkmcnt(6)
    v_exp_f32 v202, v202
    v_mfma_f32_16x16x32_bf16 v[192:195], a[100:103], a[12:15], v[192:195]
    s_waitcnt lgkmcnt(5)
    v_exp_f32 v203, v203
    v_mfma_f32_16x16x32_bf16 v[192:195], a[104:107], a[24:27], v[192:195]
    s_waitcnt lgkmcnt(4)
    v_cvt_pk_bf16_f32 v212, v200, v201
    v_cvt_pk_bf16_f32 v213, v202, v203
    v_mfma_f32_16x16x32_bf16 v[192:195], a[108:111], a[36:39], v[192:195]
    s_waitcnt lgkmcnt(3)
    v_exp_f32 v204, v204
    v_mfma_f32_16x16x32_bf16 v[196:199], a[112:115], a[0:3], v[216:219]
    s_waitcnt lgkmcnt(2)
    v_exp_f32 v205, v205
    v_mfma_f32_16x16x32_bf16 v[196:199], a[116:119], a[12:15], v[196:199]
    s_waitcnt lgkmcnt(1)
    v_exp_f32 v206, v206
    v_mfma_f32_16x16x32_bf16 v[196:199], a[120:123], a[24:27], v[196:199]
    s_waitcnt lgkmcnt(0)
    v_exp_f32 v207, v207
    v_mfma_f32_16x16x32_bf16 v[196:199], a[124:127], a[36:39], v[196:199]
    v_cvt_pk_bf16_f32 v214, v204, v205
    v_cvt_pk_bf16_f32 v215, v206, v207
    v_mfma_f32_16x16x32_bf16 v[128:131], a[144:147], v[208:211], v[128:131]
    v_exp_f32 v192, v192
    v_mfma_f32_16x16x32_bf16 v[132:135], a[148:151], v[208:211], v[132:135]
    v_exp_f32 v193, v193
    v_mfma_f32_16x16x32_bf16 v[136:139], a[152:155], v[208:211], v[136:139]
    s_add_u32 m0, s68, 32768
    v_exp_f32 v194, v194
    v_mfma_f32_16x16x32_bf16 v[140:143], a[156:159], v[208:211], v[140:143]
    s_xor_b32 s74, s38, 73728
    v_exp_f32 v195, v195
    v_mfma_f32_16x16x32_bf16 v[144:147], a[160:163], v[208:211], v[144:147]
    v_mfma_f32_16x16x32_bf16 v[148:151], a[164:167], v[208:211], v[148:151]
    v_mfma_f32_16x16x32_bf16 v[152:155], a[168:171], v[208:211], v[152:155]
    buffer_load_dwordx4 v252, s[8:11], s74 offen offset:0 nt lds
    v_mfma_f32_16x16x32_bf16 v[156:159], a[172:175], v[208:211], v[156:159]
    v_mfma_f32_16x16x32_bf16 a[232:235], a[240:243], v[208:211], a[232:235]
    v_mfma_f32_16x16x32_bf16 v[200:203], a[96:99], a[4:7], v[220:223]
    v_cvt_pk_bf16_f32 v208, v192, v193
    v_cvt_pk_bf16_f32 v209, v194, v195
    v_mfma_f32_16x16x32_bf16 v[200:203], a[100:103], a[16:19], v[200:203]
    v_exp_f32 v196, v196
    v_mfma_f32_16x16x32_bf16 v[200:203], a[104:107], a[28:31], v[200:203]
    v_exp_f32 v197, v197
    v_mfma_f32_16x16x32_bf16 v[200:203], a[108:111], a[40:43], v[200:203]
    v_exp_f32 v198, v198
    v_mfma_f32_16x16x32_bf16 v[204:207], a[112:115], a[4:7], v[220:223]
    v_exp_f32 v199, v199
    v_mfma_f32_16x16x32_bf16 v[204:207], a[116:119], a[16:19], v[204:207]
    v_cvt_pk_bf16_f32 v210, v196, v197
    v_cvt_pk_bf16_f32 v211, v198, v199
    v_mfma_f32_16x16x32_bf16 v[204:207], a[120:123], a[28:31], v[204:207]
    v_mfma_f32_16x16x32_bf16 v[204:207], a[124:127], a[40:43], v[204:207]
    v_mfma_f32_16x16x32_bf16 v[160:163], a[144:147], v[212:215], v[160:163]
    ds_read_b64_tr_b16 a[144:145], v244 offset:0
    ds_read_b64_tr_b16 a[146:147], v244 offset:4096
    v_mfma_f32_16x16x32_bf16 v[164:167], a[148:151], v[212:215], v[164:167]
    v_exp_f32 v200, v200
    v_mfma_f32_16x16x32_bf16 v[168:171], a[152:155], v[212:215], v[168:171]
    ds_read_b64_tr_b16 a[148:149], v245 offset:0
    ds_read_b64_tr_b16 a[150:151], v245 offset:4096
    v_mfma_f32_16x16x32_bf16 v[172:175], a[156:159], v[212:215], v[172:175]
    v_exp_f32 v201, v201
    v_mfma_f32_16x16x32_bf16 v[176:179], a[160:163], v[212:215], v[176:179]
    ds_read_b64_tr_b16 a[152:153], v246 offset:0
    ds_read_b64_tr_b16 a[154:155], v246 offset:4096
    v_mfma_f32_16x16x32_bf16 v[180:183], a[164:167], v[212:215], v[180:183]
    buffer_load_dwordx4 v253, s[8:11], s74 offen offset:1024 nt lds
    v_mfma_f32_16x16x32_bf16 v[184:187], a[168:171], v[212:215], v[184:187]
    ds_read_b64_tr_b16 a[156:157], v247 offset:0
    ds_read_b64_tr_b16 a[158:159], v247 offset:4096
    v_mfma_f32_16x16x32_bf16 v[188:191], a[172:175], v[212:215], v[188:191]
    v_exp_f32 v202, v202
    v_mfma_f32_16x16x32_bf16 a[236:239], a[240:243], v[212:215], a[236:239]
    ds_read_b64_tr_b16 a[160:161], v248 offset:0
    ds_read_b64_tr_b16 a[162:163], v248 offset:4096
    v_mfma_f32_16x16x32_bf16 v[192:195], a[96:99], a[8:11], v[224:227]
    v_exp_f32 v203, v203
    v_mfma_f32_16x16x32_bf16 v[192:195], a[100:103], a[20:23], v[192:195]
    ds_read_b64_tr_b16 a[164:165], v249 offset:0
    ds_read_b64_tr_b16 a[166:167], v249 offset:4096
    v_mfma_f32_16x16x32_bf16 v[192:195], a[104:107], a[32:35], v[192:195]
    v_cvt_pk_bf16_f32 v212, v200, v201
    v_cvt_pk_bf16_f32 v213, v202, v203
    v_mfma_f32_16x16x32_bf16 v[192:195], a[108:111], a[44:47], v[192:195]
    ds_read_b64_tr_b16 a[168:169], v250 offset:0
    ds_read_b64_tr_b16 a[170:171], v250 offset:4096
    v_mfma_f32_16x16x32_bf16 v[196:199], a[112:115], a[8:11], v[224:227]
    v_exp_f32 v204, v204
    v_mfma_f32_16x16x32_bf16 v[196:199], a[116:119], a[20:23], v[196:199]
    ds_read_b64_tr_b16 a[172:173], v251 offset:0
    ds_read_b64_tr_b16 a[174:175], v251 offset:4096
    v_mfma_f32_16x16x32_bf16 v[196:199], a[120:123], a[32:35], v[196:199]
    v_exp_f32 v205, v205
    v_mfma_f32_16x16x32_bf16 v[196:199], a[124:127], a[44:47], v[196:199]
    s_waitcnt lgkmcnt(14)
    v_exp_f32 v206, v206
    v_mfma_f32_16x16x32_bf16 v[0:3], a[144:147], v[208:211], v[0:3]
    s_waitcnt lgkmcnt(12)
    v_exp_f32 v207, v207
    v_mfma_f32_16x16x32_bf16 v[4:7], a[148:151], v[208:211], v[4:7]
    s_waitcnt lgkmcnt(10)
    v_cvt_pk_bf16_f32 v214, v204, v205
    v_cvt_pk_bf16_f32 v215, v206, v207
    v_mfma_f32_16x16x32_bf16 v[8:11], a[152:155], v[208:211], v[8:11]
    s_waitcnt lgkmcnt(8)
    v_exp_f32 v192, v192
    v_mfma_f32_16x16x32_bf16 v[12:15], a[156:159], v[208:211], v[12:15]
    s_waitcnt lgkmcnt(6)
    v_exp_f32 v193, v193
    v_mfma_f32_16x16x32_bf16 v[16:19], a[160:163], v[208:211], v[16:19]
    s_waitcnt lgkmcnt(4)
    v_exp_f32 v194, v194
    v_mfma_f32_16x16x32_bf16 v[20:23], a[164:167], v[208:211], v[20:23]
    s_waitcnt lgkmcnt(2)
    buffer_load_dwordx4 v254, s[8:11], s74 offen offset:2048 nt lds
    v_mfma_f32_16x16x32_bf16 v[24:27], a[168:171], v[208:211], v[24:27]
    s_waitcnt lgkmcnt(0)
    v_exp_f32 v195, v195
    v_mfma_f32_16x16x32_bf16 v[28:31], a[172:175], v[208:211], v[28:31]
    v_mfma_f32_16x16x32_bf16 a[216:219], a[240:243], v[208:211], a[216:219]
    v_mfma_f32_16x16x32_bf16 v[200:203], a[96:99], a[48:51], v[228:231]
    v_cvt_pk_bf16_f32 v208, v192, v193
    v_cvt_pk_bf16_f32 v209, v194, v195
    v_mfma_f32_16x16x32_bf16 v[200:203], a[100:103], a[60:63], v[200:203]
    v_exp_f32 v196, v196
    v_mfma_f32_16x16x32_bf16 v[200:203], a[104:107], a[72:75], v[200:203]
    v_exp_f32 v197, v197
    v_mfma_f32_16x16x32_bf16 v[200:203], a[108:111], a[84:87], v[200:203]
    v_exp_f32 v198, v198
    v_mfma_f32_16x16x32_bf16 v[204:207], a[112:115], a[48:51], v[228:231]
    v_exp_f32 v199, v199
    v_mfma_f32_16x16x32_bf16 v[204:207], a[116:119], a[60:63], v[204:207]
    v_cvt_pk_bf16_f32 v210, v196, v197
    v_cvt_pk_bf16_f32 v211, v198, v199
    v_mfma_f32_16x16x32_bf16 v[204:207], a[120:123], a[72:75], v[204:207]
    v_mfma_f32_16x16x32_bf16 v[204:207], a[124:127], a[84:87], v[204:207]
    v_mfma_f32_16x16x32_bf16 v[32:35], a[144:147], v[212:215], v[32:35]
    v_exp_f32 v200, v200
    v_mfma_f32_16x16x32_bf16 v[36:39], a[148:151], v[212:215], v[36:39]
    v_exp_f32 v201, v201
    v_mfma_f32_16x16x32_bf16 v[40:43], a[152:155], v[212:215], v[40:43]
    v_exp_f32 v202, v202
    v_mfma_f32_16x16x32_bf16 v[44:47], a[156:159], v[212:215], v[44:47]
    v_exp_f32 v203, v203
    v_mfma_f32_16x16x32_bf16 v[48:51], a[160:163], v[212:215], v[48:51]
    buffer_load_dwordx4 v255, s[8:11], s74 offen offset:3072 nt lds
    v_mfma_f32_16x16x32_bf16 v[52:55], a[164:167], v[212:215], v[52:55]
    v_mfma_f32_16x16x32_bf16 v[56:59], a[168:171], v[212:215], v[56:59]
    v_mfma_f32_16x16x32_bf16 v[60:63], a[172:175], v[212:215], v[60:63]
    v_mfma_f32_16x16x32_bf16 a[220:223], a[240:243], v[212:215], a[220:223]
    v_mfma_f32_16x16x32_bf16 v[192:195], a[96:99], a[52:55], v[232:235]
    v_cvt_pk_bf16_f32 v212, v200, v201
    v_cvt_pk_bf16_f32 v213, v202, v203
    v_mfma_f32_16x16x32_bf16 v[192:195], a[100:103], a[64:67], v[192:195]
    v_exp_f32 v204, v204
    v_mfma_f32_16x16x32_bf16 v[192:195], a[104:107], a[76:79], v[192:195]
    v_exp_f32 v205, v205
    v_mfma_f32_16x16x32_bf16 v[192:195], a[108:111], a[88:91], v[192:195]
    v_exp_f32 v206, v206
    v_mfma_f32_16x16x32_bf16 v[196:199], a[112:115], a[52:55], v[232:235]
    v_exp_f32 v207, v207
    v_mfma_f32_16x16x32_bf16 v[196:199], a[116:119], a[64:67], v[196:199]
    v_cvt_pk_bf16_f32 v214, v204, v205
    v_cvt_pk_bf16_f32 v215, v206, v207
    v_mfma_f32_16x16x32_bf16 v[196:199], a[120:123], a[76:79], v[196:199]
    v_mfma_f32_16x16x32_bf16 v[196:199], a[124:127], a[88:91], v[196:199]
    v_mfma_f32_16x16x32_bf16 v[64:67], a[144:147], v[208:211], v[64:67]
    s_add_u32 m0, s68, 114688
    v_exp_f32 v192, v192
    v_mfma_f32_16x16x32_bf16 v[68:71], a[148:151], v[208:211], v[68:71]
    s_xor_b32 s74, s38, 73728
    v_exp_f32 v193, v193
    v_mfma_f32_16x16x32_bf16 v[72:75], a[152:155], v[208:211], v[72:75]
    v_exp_f32 v194, v194
    v_mfma_f32_16x16x32_bf16 v[76:79], a[156:159], v[208:211], v[76:79]
    v_exp_f32 v195, v195
    v_mfma_f32_16x16x32_bf16 v[80:83], a[160:163], v[208:211], v[80:83]
    buffer_load_dwordx4 v252, s[12:15], s74 offen offset:0 nt lds
    v_mfma_f32_16x16x32_bf16 v[84:87], a[164:167], v[208:211], v[84:87]
    v_mfma_f32_16x16x32_bf16 v[88:91], a[168:171], v[208:211], v[88:91]
    v_mfma_f32_16x16x32_bf16 v[92:95], a[172:175], v[208:211], v[92:95]
    s_waitcnt vmcnt(21)
    v_mfma_f32_16x16x32_bf16 a[224:227], a[240:243], v[208:211], a[224:227]
    s_barrier
    v_mfma_f32_16x16x32_bf16 v[200:203], a[96:99], a[56:59], v[236:239]
    ds_read_b128 a[96:99], v240 offset:8192
    v_cvt_pk_bf16_f32 v208, v192, v193
    v_mfma_f32_16x16x32_bf16 v[200:203], a[100:103], a[68:71], v[200:203]
    v_cvt_pk_bf16_f32 v209, v194, v195
    v_mfma_f32_16x16x32_bf16 v[200:203], a[104:107], a[80:83], v[200:203]
    ds_read_b128 a[100:103], v241 offset:8192
    v_mfma_f32_16x16x32_bf16 v[200:203], a[108:111], a[92:95], v[200:203]
    v_exp_f32 v196, v196
    v_mfma_f32_16x16x32_bf16 v[204:207], a[112:115], a[56:59], v[236:239]
    ds_read_b128 a[104:107], v242 offset:8192
    v_mfma_f32_16x16x32_bf16 v[204:207], a[116:119], a[68:71], v[204:207]
    v_exp_f32 v197, v197
    v_mfma_f32_16x16x32_bf16 v[204:207], a[120:123], a[80:83], v[204:207]
    ds_read_b128 a[108:111], v243 offset:8192
    v_mfma_f32_16x16x32_bf16 v[204:207], a[124:127], a[92:95], v[204:207]
    v_exp_f32 v198, v198
    v_mfma_f32_16x16x32_bf16 v[96:99], a[144:147], v[212:215], v[96:99]
    ds_read_b128 a[112:115], v240 offset:12288
    v_mfma_f32_16x16x32_bf16 v[100:103], a[148:151], v[212:215], v[100:103]
    v_exp_f32 v199, v199
    v_mfma_f32_16x16x32_bf16 v[104:107], a[152:155], v[212:215], v[104:107]
    ds_read_b128 a[116:119], v241 offset:12288
    v_cvt_pk_bf16_f32 v210, v196, v197
    v_mfma_f32_16x16x32_bf16 v[108:111], a[156:159], v[212:215], v[108:111]
    buffer_load_dwordx4 v253, s[12:15], s74 offen offset:1024 nt lds
    v_mfma_f32_16x16x32_bf16 v[112:115], a[160:163], v[212:215], v[112:115]
    ds_read_b128 a[120:123], v242 offset:12288
    v_cvt_pk_bf16_f32 v211, v198, v199
    v_mfma_f32_16x16x32_bf16 v[116:119], a[164:167], v[212:215], v[116:119]
    v_exp_f32 v200, v200
    v_mfma_f32_16x16x32_bf16 v[120:123], a[168:171], v[212:215], v[120:123]
    ds_read_b128 a[124:127], v243 offset:12288
    v_mfma_f32_16x16x32_bf16 v[124:127], a[172:175], v[212:215], v[124:127]
    v_exp_f32 v201, v201
    v_mfma_f32_16x16x32_bf16 a[228:231], a[240:243], v[212:215], a[228:231]
    s_waitcnt lgkmcnt(7)
    v_exp_f32 v202, v202
    v_mfma_f32_16x16x32_bf16 v[192:195], a[96:99], a[0:3], v[216:219]
    s_waitcnt lgkmcnt(6)
    v_exp_f32 v203, v203
    v_mfma_f32_16x16x32_bf16 v[192:195], a[100:103], a[12:15], v[192:195]
    s_waitcnt lgkmcnt(5)
    v_cvt_pk_bf16_f32 v212, v200, v201
    v_cvt_pk_bf16_f32 v213, v202, v203
    v_mfma_f32_16x16x32_bf16 v[192:195], a[104:107], a[24:27], v[192:195]
    s_waitcnt lgkmcnt(4)
    v_exp_f32 v204, v204
    v_mfma_f32_16x16x32_bf16 v[192:195], a[108:111], a[36:39], v[192:195]
    s_waitcnt lgkmcnt(3)
    v_exp_f32 v205, v205
    v_mfma_f32_16x16x32_bf16 v[196:199], a[112:115], a[0:3], v[216:219]
    s_waitcnt lgkmcnt(2)
    v_exp_f32 v206, v206
    v_mfma_f32_16x16x32_bf16 v[196:199], a[116:119], a[12:15], v[196:199]
    s_waitcnt lgkmcnt(1)
    v_exp_f32 v207, v207
    v_mfma_f32_16x16x32_bf16 v[196:199], a[120:123], a[24:27], v[196:199]
    s_waitcnt lgkmcnt(0)
    v_cvt_pk_bf16_f32 v214, v204, v205
    v_cvt_pk_bf16_f32 v215, v206, v207
    v_mfma_f32_16x16x32_bf16 v[196:199], a[124:127], a[36:39], v[196:199]
    v_mfma_f32_16x16x32_bf16 v[128:131], a[144:147], v[208:211], v[128:131]
    v_exp_f32 v192, v192
    v_mfma_f32_16x16x32_bf16 v[132:135], a[148:151], v[208:211], v[132:135]
    v_exp_f32 v193, v193
    v_mfma_f32_16x16x32_bf16 v[136:139], a[152:155], v[208:211], v[136:139]
    v_exp_f32 v194, v194
    v_mfma_f32_16x16x32_bf16 v[140:143], a[156:159], v[208:211], v[140:143]
    buffer_load_dwordx4 v254, s[12:15], s74 offen offset:2048 nt lds
    v_mfma_f32_16x16x32_bf16 v[144:147], a[160:163], v[208:211], v[144:147]
    v_exp_f32 v195, v195
    v_mfma_f32_16x16x32_bf16 v[148:151], a[164:167], v[208:211], v[148:151]
    v_mfma_f32_16x16x32_bf16 v[152:155], a[168:171], v[208:211], v[152:155]
    v_mfma_f32_16x16x32_bf16 v[156:159], a[172:175], v[208:211], v[156:159]
    v_mfma_f32_16x16x32_bf16 a[232:235], a[240:243], v[208:211], a[232:235]
    v_mfma_f32_16x16x32_bf16 v[200:203], a[96:99], a[4:7], v[220:223]
    v_cvt_pk_bf16_f32 v208, v192, v193
    v_cvt_pk_bf16_f32 v209, v194, v195
    v_mfma_f32_16x16x32_bf16 v[200:203], a[100:103], a[16:19], v[200:203]
    v_exp_f32 v196, v196
    v_mfma_f32_16x16x32_bf16 v[200:203], a[104:107], a[28:31], v[200:203]
    v_exp_f32 v197, v197
    v_mfma_f32_16x16x32_bf16 v[200:203], a[108:111], a[40:43], v[200:203]
    v_exp_f32 v198, v198
    v_mfma_f32_16x16x32_bf16 v[204:207], a[112:115], a[4:7], v[220:223]
    v_exp_f32 v199, v199
    v_mfma_f32_16x16x32_bf16 v[204:207], a[116:119], a[16:19], v[204:207]
    v_cvt_pk_bf16_f32 v210, v196, v197
    v_cvt_pk_bf16_f32 v211, v198, v199
    v_mfma_f32_16x16x32_bf16 v[204:207], a[120:123], a[28:31], v[204:207]
    v_mfma_f32_16x16x32_bf16 v[204:207], a[124:127], a[40:43], v[204:207]
    v_mfma_f32_16x16x32_bf16 v[160:163], a[144:147], v[212:215], v[160:163]
    ds_read_b64_tr_b16 a[144:145], v244 offset:8192
    ds_read_b64_tr_b16 a[146:147], v244 offset:12288
    v_mfma_f32_16x16x32_bf16 v[164:167], a[148:151], v[212:215], v[164:167]
    v_exp_f32 v200, v200
    v_mfma_f32_16x16x32_bf16 v[168:171], a[152:155], v[212:215], v[168:171]
    ds_read_b64_tr_b16 a[148:149], v245 offset:8192
    ds_read_b64_tr_b16 a[150:151], v245 offset:12288
    v_mfma_f32_16x16x32_bf16 v[172:175], a[156:159], v[212:215], v[172:175]
    buffer_load_dwordx4 v255, s[12:15], s74 offen offset:3072 nt lds
    v_mfma_f32_16x16x32_bf16 v[176:179], a[160:163], v[212:215], v[176:179]
    ds_read_b64_tr_b16 a[152:153], v246 offset:8192
    ds_read_b64_tr_b16 a[154:155], v246 offset:12288
    v_mfma_f32_16x16x32_bf16 v[180:183], a[164:167], v[212:215], v[180:183]
L_hopa_6:
    s_cbranch_execz L_backa
    v_exp_f32 v201, v201
    v_mfma_f32_16x16x32_bf16 v[184:187], a[168:171], v[212:215], v[184:187]
    ds_read_b64_tr_b16 a[156:157], v247 offset:8192
    ds_read_b64_tr_b16 a[158:159], v247 offset:12288
    v_mfma_f32_16x16x32_bf16 v[188:191], a[172:175], v[212:215], v[188:191]
    v_exp_f32 v202, v202
    v_mfma_f32_16x16x32_bf16 a[236:239], a[240:243], v[212:215], a[236:239]
    ds_read_b64_tr_b16 a[160:161], v248 offset:8192
    ds_read_b64_tr_b16 a[162:163], v248 offset:12288
    v_mfma_f32_16x16x32_bf16 v[192:195], a[96:99], a[8:11], v[224:227]
    v_exp_f32 v203, v203
    v_mfma_f32_16x16x32_bf16 v[192:195], a[100:103], a[20:23], v[192:195]
    ds_read_b64_tr_b16 a[164:165], v249 offset:8192
    ds_read_b64_tr_b16 a[166:167], v249 offset:12288
    v_mfma_f32_16x16x32_bf16 v[192:195], a[104:107], a[32:35], v[192:195]
    v_cvt_pk_bf16_f32 v212, v200, v201
    v_cvt_pk_bf16_f32 v213, v202, v203
    v_mfma_f32_16x16x32_bf16 v[192:195], a[108:111], a[44:47], v[192:195]
    ds_read_b64_tr_b16 a[168:169], v250 offset:8192
    ds_read_b64_tr_b16 a[170:171], v250 offset:12288
    v_mfma_f32_16x16x32_bf16 v[196:199], a[112:115], a[8:11], v[224:227]
    v_exp_f32 v204, v204
    v_mfma_f32_16x16x32_bf16 v[196:199], a[116:119], a[20:23], v[196:199]
    ds_read_b64_tr_b16 a[172:173], v251 offset:8192
    ds_read_b64_tr_b16 a[174:175], v251 offset:12288
    v_mfma_f32_16x16x32_bf16 v[196:199], a[120:123], a[32:35], v[196:199]
    s_add_u32 m0, s68, 0
    v_exp_f32 v205, v205
    v_mfma_f32_16x16x32_bf16 v[196:199], a[124:127], a[44:47], v[196:199]
    s_waitcnt lgkmcnt(14)
    s_xor_b32 s74, s38, 81920
    v_exp_f32 v206, v206
    v_mfma_f32_16x16x32_bf16 v[0:3], a[144:147], v[208:211], v[0:3]
    s_waitcnt lgkmcnt(12)
    v_exp_f32 v207, v207
    v_mfma_f32_16x16x32_bf16 v[4:7], a[148:151], v[208:211], v[4:7]
    s_waitcnt lgkmcnt(10)
    v_cvt_pk_bf16_f32 v214, v204, v205
    v_cvt_pk_bf16_f32 v215, v206, v207
    v_mfma_f32_16x16x32_bf16 v[8:11], a[152:155], v[208:211], v[8:11]
    s_waitcnt lgkmcnt(8)
    buffer_load_dwordx4 v252, s[8:11], s74 offen offset:0 nt lds
    v_mfma_f32_16x16x32_bf16 v[12:15], a[156:159], v[208:211], v[12:15]
    s_waitcnt lgkmcnt(6)
    v_exp_f32 v192, v192
    v_mfma_f32_16x16x32_bf16 v[16:19], a[160:163], v[208:211], v[16:19]
    s_waitcnt lgkmcnt(4)
    v_exp_f32 v193, v193
    v_mfma_f32_16x16x32_bf16 v[20:23], a[164:167], v[208:211], v[20:23]
    s_waitcnt lgkmcnt(2)
    v_exp_f32 v194, v194
    v_mfma_f32_16x16x32_bf16 v[24:27], a[168:171], v[208:211], v[24:27]
    s_waitcnt lgkmcnt(0)
    v_exp_f32 v195, v195
    v_mfma_f32_16x16x32_bf16 v[28:31], a[172:175], v[208:211], v[28:31]
    v_mfma_f32_16x16x32_bf16 a[216:219], a[240:243], v[208:211], a[216:219]
    v_mfma_f32_16x16x32_bf16 v[200:203], a[96:99], a[48:51], v[228:231]
    v_cvt_pk_bf16_f32 v208, v192, v193
    v_cvt_pk_bf16_f32 v209, v194, v195
    v_mfma_f32_16x16x32_bf16 v[200:203], a[100:103], a[60:63], v[200:203]
    v_exp_f32 v196, v196
    v_mfma_f32_16x16x32_bf16 v[200:203], a[104:107], a[72:75], v[200:203]
    v_exp_f32 v197, v197
    v_mfma_f32_16x16x32_bf16 v[200:203], a[108:111], a[84:87], v[200:203]
    v_exp_f32 v198, v198
    v_mfma_f32_16x16x32_bf16 v[204:207], a[112:115], a[48:51], v[228:231]
    v_exp_f32 v199, v199
    v_mfma_f32_16x16x32_bf16 v[204:207], a[116:119], a[60:63], v[204:207]
    v_cvt_pk_bf16_f32 v210, v196, v197
    v_cvt_pk_bf16_f32 v211, v198, v199
    v_mfma_f32_16x16x32_bf16 v[204:207], a[120:123], a[72:75], v[204:207]
    v_mfma_f32_16x16x32_bf16 v[204:207], a[124:127], a[84:87], v[204:207]
    v_mfma_f32_16x16x32_bf16 v[32:35], a[144:147], v[212:215], v[32:35]
    v_exp_f32 v200, v200
    v_mfma_f32_16x16x32_bf16 v[36:39], a[148:151], v[212:215], v[36:39]
    buffer_load_dwordx4 v253, s[8:11], s74 offen offset:1024 nt lds
    v_mfma_f32_16x16x32_bf16 v[40:43], a[152:155], v[212:215], v[40:43]
    v_exp_f32 v201, v201
    v_mfma_f32_16x16x32_bf16 v[44:47], a[156:159], v[212:215], v[44:47]
    v_exp_f32 v202, v202
    v_mfma_f32_16x16x32_bf16 v[48:51], a[160:163], v[212:215], v[48:51]
    v_exp_f32 v203, v203
    v_mfma_f32_16x16x32_bf16 v[52:55], a[164:167], v[212:215], v[52:55]
    v_mfma_f32_16x16x32_bf16 v[56:59], a[168:171], v[212:215], v[56:59]
    v_mfma_f32_16x16x32_bf16 v[60:63], a[172:175], v[212:215], v[60:63]
    v_mfma_f32_16x16x32_bf16 a[220:223], a[240:243], v[212:215], a[220:223]
    v_mfma_f32_16x16x32_bf16 v[192:195], a[96:99], a[52:55], v[232:235]
    v_cvt_pk_bf16_f32 v212, v200, v201
    v_cvt_pk_bf16_f32 v213, v202, v203
    v_mfma_f32_16x16x32_bf16 v[192:195], a[100:103], a[64:67], v[192:195]
    v_exp_f32 v204, v204
    v_mfma_f32_16x16x32_bf16 v[192:195], a[104:107], a[76:79], v[192:195]
    v_exp_f32 v205, v205
    v_mfma_f32_16x16x32_bf16 v[192:195], a[108:111], a[88:91], v[192:195]
    v_exp_f32 v206, v206
    v_mfma_f32_16x16x32_bf16 v[196:199], a[112:115], a[52:55], v[232:235]
    v_exp_f32 v207, v207
    v_mfma_f32_16x16x32_bf16 v[196:199], a[116:119], a[64:67], v[196:199]
    v_cvt_pk_bf16_f32 v214, v204, v205
    v_cvt_pk_bf16_f32 v215, v206, v207
    v_mfma_f32_16x16x32_bf16 v[196:199], a[120:123], a[76:79], v[196:199]
    v_mfma_f32_16x16x32_bf16 v[196:199], a[124:127], a[88:91], v[196:199]
    v_mfma_f32_16x16x32_bf16 v[64:67], a[144:147], v[208:211], v[64:67]
    v_exp_f32 v192, v192
    v_mfma_f32_16x16x32_bf16 v[68:71], a[148:151], v[208:211], v[68:71]
    buffer_load_dwordx4 v254, s[8:11], s74 offen offset:2048 nt lds
    v_mfma_f32_16x16x32_bf16 v[72:75], a[152:155], v[208:211], v[72:75]
    v_exp_f32 v193, v193
    v_mfma_f32_16x16x32_bf16 v[76:79], a[156:159], v[208:211], v[76:79]
    v_exp_f32 v194, v194
    v_mfma_f32_16x16x32_bf16 v[80:83], a[160:163], v[208:211], v[80:83]
    v_exp_f32 v195, v195
    v_mfma_f32_16x16x32_bf16 v[84:87], a[164:167], v[208:211], v[84:87]
    v_mfma_f32_16x16x32_bf16 v[88:91], a[168:171], v[208:211], v[88:91]
    v_mfma_f32_16x16x32_bf16 v[92:95], a[172:175], v[208:211], v[92:95]
    s_waitcnt vmcnt(19)
    v_mfma_f32_16x16x32_bf16 a[224:227], a[240:243], v[208:211], a[224:227]
    s_barrier
    v_mfma_f32_16x16x32_bf16 v[200:203], a[96:99], a[56:59], v[236:239]
    ds_read_b128 a[96:99], v240 offset:16384
    v_cvt_pk_bf16_f32 v208, v192, v193
    v_mfma_f32_16x16x32_bf16 v[200:203], a[100:103], a[68:71], v[200:203]
    v_cvt_pk_bf16_f32 v209, v194, v195
    v_mfma_f32_16x16x32_bf16 v[200:203], a[104:107], a[80:83], v[200:203]
    ds_read_b128 a[100:103], v241 offset:16384
    v_mfma_f32_16x16x32_bf16 v[200:203], a[108:111], a[92:95], v[200:203]
    v_exp_f32 v196, v196
    v_mfma_f32_16x16x32_bf16 v[204:207], a[112:115], a[56:59], v[236:239]
    ds_read_b128 a[104:107], v242 offset:16384
    v_mfma_f32_16x16x32_bf16 v[204:207], a[116:119], a[68:71], v[204:207]
    v_exp_f32 v197, v197
    v_mfma_f32_16x16x32_bf16 v[204:207], a[120:123], a[80:83], v[204:207]
    ds_read_b128 a[108:111], v243 offset:16384
    v_mfma_f32_16x16x32_bf16 v[204:207], a[124:127], a[92:95], v[204:207]
    v_exp_f32 v198, v198
    v_mfma_f32_16x16x32_bf16 v[96:99], a[144:147], v[212:215], v[96:99]
    ds_read_b128 a[112:115], v240 offset:20480
    v_mfma_f32_16x16x32_bf16 v[100:103], a[148:151], v[212:215], v[100:103]
    buffer_load_dwordx4 v255, s[8:11], s74 offen offset:3072 nt lds
    v_mfma_f32_16x16x32_bf16 v[104:107], a[152:155], v[212:215], v[104:107]
    ds_read_b128 a[116:119], v241 offset:20480
    v_mfma_f32_16x16x32_bf16 v[108:111], a[156:159], v[212:215], v[108:111]
    v_exp_f32 v199, v199
    v_mfma_f32_16x16x32_bf16 v[112:115], a[160:163], v[212:215], v[112:115]
    ds_read_b128 a[120:123], v242 offset:20480
    v_cvt_pk_bf16_f32 v210, v196, v197
    v_mfma_f32_16x16x32_bf16 v[116:119], a[164:167], v[212:215], v[116:119]
    v_cvt_pk_bf16_f32 v211, v198, v199
    v_mfma_f32_16x16x32_bf16 v[120:123], a[168:171], v[212:215], v[120:123]
    ds_read_b128 a[124:127], v243 offset:20480
    v_mfma_f32_16x16x32_bf16 v[124:127], a[172:175], v[212:215], v[124:127]
    v_exp_f32 v200, v200
    v_mfma_f32_16x16x32_bf16 a[228:231], a[240:243], v[212:215], a[228:231]
    s_waitcnt lgkmcnt(7)
    v_exp_f32 v201, v201
    v_mfma_f32_16x16x32_bf16 v[192:195], a[96:99], a[0:3], v[216:219]
    s_waitcnt lgkmcnt(6)
    v_exp_f32 v202, v202
    v_mfma_f32_16x16x32_bf16 v[192:195], a[100:103], a[12:15], v[192:195]
    s_waitcnt lgkmcnt(5)
    v_exp_f32 v203, v203
    v_mfma_f32_16x16x32_bf16 v[192:195], a[104:107], a[24:27], v[192:195]
    s_waitcnt lgkmcnt(4)
    v_cvt_pk_bf16_f32 v212, v200, v201
    v_cvt_pk_bf16_f32 v213, v202, v203
    v_mfma_f32_16x16x32_bf16 v[192:195], a[108:111], a[36:39], v[192:195]
    s_waitcnt lgkmcnt(3)
    v_exp_f32 v204, v204
    v_mfma_f32_16x16x32_bf16 v[196:199], a[112:115], a[0:3], v[216:219]
    s_waitcnt lgkmcnt(2)
    s_add_u32 m0, s68, 81920
    v_exp_f32 v205, v205
    v_mfma_f32_16x16x32_bf16 v[196:199], a[116:119], a[12:15], v[196:199]
    s_waitcnt lgkmcnt(1)
    s_xor_b32 s74, s38, 81920
    v_exp_f32 v206, v206
    v_mfma_f32_16x16x32_bf16 v[196:199], a[120:123], a[24:27], v[196:199]
    s_waitcnt lgkmcnt(0)
    v_exp_f32 v207, v207
    v_mfma_f32_16x16x32_bf16 v[196:199], a[124:127], a[36:39], v[196:199]
    v_cvt_pk_bf16_f32 v214, v204, v205
    v_cvt_pk_bf16_f32 v215, v206, v207
    v_mfma_f32_16x16x32_bf16 v[128:131], a[144:147], v[208:211], v[128:131]
    buffer_load_dwordx4 v252, s[12:15], s74 offen offset:0 nt lds
    v_mfma_f32_16x16x32_bf16 v[132:135], a[148:151], v[208:211], v[132:135]
    v_exp_f32 v192, v192
    v_mfma_f32_16x16x32_bf16 v[136:139], a[152:155], v[208:211], v[136:139]
    v_exp_f32 v193, v193
    v_mfma_f32_16x16x32_bf16 v[140:143], a[156:159], v[208:211], v[140:143]
    v_exp_f32 v194, v194
    v_mfma_f32_16x16x32_bf16 v[144:147], a[160:163], v[208:211], v[144:147]
    v_exp_f32 v195, v195
    v_mfma_f32_16x16x32_bf16 v[148:151], a[164:167], v[208:211], v[148:151]
    v_mfma_f32_16x16x32_bf16 v[152:155], a[168:171], v[208:211], v[152:155]
    v_mfma_f32_16x16x32_bf16 v[156:159], a[172:175], v[208:211], v[156:159]
    v_mfma_f32_16x16x32_bf16 a[232:235], a[240:243], v[208:211], a[232:235]
    v_mfma_f32_16x16x32_bf16 v[200:203], a[96:99], a[4:7], v[220:223]
    v_cvt_pk_bf16_f32 v208, v192, v193
    v_cvt_pk_bf16_f32 v209, v194, v195
    v_mfma_f32_16x16x32_bf16 v[200:203], a[100:103], a[16:19], v[200:203]
    v_exp_f32 v196, v196
    v_mfma_f32_16x16x32_bf16 v[200:203], a[104:107], a[28:31], v[200:203]
    v_exp_f32 v197, v197
    v_mfma_f32_16x16x32_bf16 v[200:203], a[108:111], a[40:43], v[200:203]
    v_exp_f32 v198, v198
    v_mfma_f32_16x16x32_bf16 v[204:207], a[112:115], a[4:7], v[220:223]
    v_exp_f32 v199, v199
    v_mfma_f32_16x16x32_bf16 v[204:207], a[116:119], a[16:19], v[204:207]
    v_cvt_pk_bf16_f32 v210, v196, v197
    v_cvt_pk_bf16_f32 v211, v198, v199
    v_mfma_f32_16x16x32_bf16 v[204:207], a[120:123], a[28:31], v[204:207]
    v_mfma_f32_16x16x32_bf16 v[204:207], a[124:127], a[40:43], v[204:207]
    buffer_load_dwordx4 v253, s[12:15], s74 offen offset:1024 nt lds
    v_mfma_f32_16x16x32_bf16 v[160:163], a[144:147], v[212:215], v[160:163]
    ds_read_b64_tr_b16 a[144:145], v244 offset:16384
    ds_read_b64_tr_b16 a[146:147], v244 offset:20480
    v_mfma_f32_16x16x32_bf16 v[164:167], a[148:151], v[212:215], v[164:167]
    v_exp_f32 v200, v200
    v_mfma_f32_16x16x32_bf16 v[168:171], a[152:155], v[212:215], v[168:171]
    ds_read_b64_tr_b16 a[148:149], v245 offset:16384
    ds_read_b64_tr_b16 a[150:151], v245 offset:20480
    v_mfma_f32_16x16x32_bf16 v[172:175], a[156:159], v[212:215], v[172:175]
    v_exp_f32 v201, v201
    v_mfma_f32_16x16x32_bf16 v[176:179], a[160:163], v[212:215], v[176:179]
    ds_read_b64_tr_b16 a[152:153], v246 offset:16384
    ds_read_b64_tr_b16 a[154:155], v246 offset:20480
    v_mfma_f32_16x16x32_bf16 v[180:183], a[164:167], v[212:215], v[180:183]
    v_exp_f32 v202, v202
    v_mfma_f32_16x16x32_bf16 v[184:187], a[168:171], v[212:215], v[184:187]
    ds_read_b64_tr_b16 a[156:157], v247 offset:16384
    ds_read_b64_tr_b16 a[158:159], v247 offset:20480
    v_mfma_f32_16x16x32_bf16 v[188:191], a[172:175], v[212:215], v[188:191]
    v_exp_f32 v203, v203
    v_mfma_f32_16x16x32_bf16 a[236:239], a[240:243], v[212:215], a[236:239]
    ds_read_b64_tr_b16 a[160:161], v248 offset:16384
    ds_read_b64_tr_b16 a[162:163], v248 offset:20480
    v_mfma_f32_16x16x32_bf16 v[192:195], a[96:99], a[8:11], v[224:227]
    v_cvt_pk_bf16_f32 v212, v200, v201
    v_cvt_pk_bf16_f32 v213, v202, v203
    v_mfma_f32_16x16x32_bf16 v[192:195], a[100:103], a[20:23], v[192:195]
    ds_read_b64_tr_b16 a[164:165], v249 offset:16384
    ds_read_b64_tr_b16 a[166:167], v249 offset:20480
    v_mfma_f32_16x16x32_bf16 v[192:195], a[104:107], a[32:35], v[192:195]
    v_exp_f32 v204, v204
    v_mfma_f32_16x16x32_bf16 v[192:195], a[108:111], a[44:47], v[192:195]
    ds_read_b64_tr_b16 a[168:169], v250 offset:16384
    ds_read_b64_tr_b16 a[170:171], v250 offset:20480
    v_mfma_f32_16x16x32_bf16 v[196:199], a[112:115], a[8:11], v[224:227]
    v_exp_f32 v205, v205
    v_mfma_f32_16x16x32_bf16 v[196:199], a[116:119], a[20:23], v[196:199]
    ds_read_b64_tr_b16 a[172:173], v251 offset:16384
    ds_read_b64_tr_b16 a[174:175], v251 offset:20480
    v_mfma_f32_16x16x32_bf16 v[196:199], a[120:123], a[32:35], v[196:199]
    v_exp_f32 v206, v206
    v_mfma_f32_16x16x32_bf16 v[196:199], a[124:127], a[44:47], v[196:199]
    s_waitcnt lgkmcnt(14)
    buffer_load_dwordx4 v254, s[12:15], s74 offen offset:2048 nt lds
    v_mfma_f32_16x16x32_bf16 v[0:3], a[144:147], v[208:211], v[0:3]
    s_waitcnt lgkmcnt(12)
    v_exp_f32 v207, v207
    v_mfma_f32_16x16x32_bf16 v[4:7], a[148:151], v[208:211], v[4:7]
    s_waitcnt lgkmcnt(10)
    v_cvt_pk_bf16_f32 v214, v204, v205
    v_cvt_pk_bf16_f32 v215, v206, v207
    v_mfma_f32_16x16x32_bf16 v[8:11], a[152:155], v[208:211], v[8:11]
    s_waitcnt lgkmcnt(8)
    v_exp_f32 v192, v192
    v_mfma_f32_16x16x32_bf16 v[12:15], a[156:159], v[208:211], v[12:15]
    s_waitcnt lgkmcnt(6)
    v_exp_f32 v193, v193
    v_mfma_f32_16x16x32_bf16 v[16:19], a[160:163], v[208:211], v[16:19]
    s_waitcnt lgkmcnt(4)
    v_exp_f32 v194, v194
    v_mfma_f32_16x16x32_bf16 v[20:23], a[164:167], v[208:211], v[20:23]
    s_waitcnt lgkmcnt(2)
    v_exp_f32 v195, v195
    v_mfma_f32_16x16x32_bf16 v[24:27], a[168:171], v[208:211], v[24:27]
    s_waitcnt lgkmcnt(0)
    v_mfma_f32_16x16x32_bf16 v[28:31], a[172:175], v[208:211], v[28:31]
    v_mfma_f32_16x16x32_bf16 a[216:219], a[240:243], v[208:211], a[216:219]
    v_mfma_f32_16x16x32_bf16 v[200:203], a[96:99], a[48:51], v[228:231]
    v_cvt_pk_bf16_f32 v208, v192, v193
    v_cvt_pk_bf16_f32 v209, v194, v195
    v_mfma_f32_16x16x32_bf16 v[200:203], a[100:103], a[60:63], v[200:203]
    v_exp_f32 v196, v196
    v_mfma_f32_16x16x32_bf16 v[200:203], a[104:107], a[72:75], v[200:203]
    v_exp_f32 v197, v197
    v_mfma_f32_16x16x32_bf16 v[200:203], a[108:111], a[84:87], v[200:203]
    v_exp_f32 v198, v198
    v_mfma_f32_16x16x32_bf16 v[204:207], a[112:115], a[48:51], v[228:231]
    v_exp_f32 v199, v199
    v_mfma_f32_16x16x32_bf16 v[204:207], a[116:119], a[60:63], v[204:207]
    v_cvt_pk_bf16_f32 v210, v196, v197
    v_cvt_pk_bf16_f32 v211, v198, v199
    v_mfma_f32_16x16x32_bf16 v[204:207], a[120:123], a[72:75], v[204:207]
    buffer_load_dwordx4 v255, s[12:15], s74 offen offset:3072 nt lds
    v_mfma_f32_16x16x32_bf16 v[204:207], a[124:127], a[84:87], v[204:207]
    v_mfma_f32_16x16x32_bf16 v[32:35], a[144:147], v[212:215], v[32:35]
    v_exp_f32 v200, v200
    v_mfma_f32_16x16x32_bf16 v[36:39], a[148:151], v[212:215], v[36:39]
    v_exp_f32 v201, v201
    v_mfma_f32_16x16x32_bf16 v[40:43], a[152:155], v[212:215], v[40:43]
    v_exp_f32 v202, v202
    v_mfma_f32_16x16x32_bf16 v[44:47], a[156:159], v[212:215], v[44:47]
    v_exp_f32 v203, v203
    v_mfma_f32_16x16x32_bf16 v[48:51], a[160:163], v[212:215], v[48:51]
    v_mfma_f32_16x16x32_bf16 v[52:55], a[164:167], v[212:215], v[52:55]
    v_mfma_f32_16x16x32_bf16 v[56:59], a[168:171], v[212:215], v[56:59]
    v_mfma_f32_16x16x32_bf16 v[60:63], a[172:175], v[212:215], v[60:63]
    v_mfma_f32_16x16x32_bf16 a[220:223], a[240:243], v[212:215], a[220:223]
    v_mfma_f32_16x16x32_bf16 v[192:195], a[96:99], a[52:55], v[232:235]
    v_cvt_pk_bf16_f32 v212, v200, v201
    v_cvt_pk_bf16_f32 v213, v202, v203
    v_mfma_f32_16x16x32_bf16 v[192:195], a[100:103], a[64:67], v[192:195]
    v_exp_f32 v204, v204
    v_mfma_f32_16x16x32_bf16 v[192:195], a[104:107], a[76:79], v[192:195]
    s_add_u32 m0, s68, 8192
    v_exp_f32 v205, v205
    v_mfma_f32_16x16x32_bf16 v[192:195], a[108:111], a[88:91], v[192:195]
    s_xor_b32 s74, s38, 90112
    v_exp_f32 v206, v206
    v_mfma_f32_16x16x32_bf16 v[196:199], a[112:115], a[52:55], v[232:235]
    v_exp_f32 v207, v207
    v_mfma_f32_16x16x32_bf16 v[196:199], a[116:119], a[64:67], v[196:199]
    v_cvt_pk_bf16_f32 v214, v204, v205
    v_cvt_pk_bf16_f32 v215, v206, v207
    v_mfma_f32_16x16x32_bf16 v[196:199], a[120:123], a[76:79], v[196:199]
    buffer_load_dwordx4 v252, s[8:11], s74 offen offset:0 nt lds
    v_mfma_f32_16x16x32_bf16 v[196:199], a[124:127], a[88:91], v[196:199]
    v_mfma_f32_16x16x32_bf16 v[64:67], a[144:147], v[208:211], v[64:67]
    v_exp_f32 v192, v192
    v_mfma_f32_16x16x32_bf16 v[68:71], a[148:151], v[208:211], v[68:71]
    v_exp_f32 v193, v193
    v_mfma_f32_16x16x32_bf16 v[72:75], a[152:155], v[208:211], v[72:75]
    v_exp_f32 v194, v194
    v_mfma_f32_16x16x32_bf16 v[76:79], a[156:159], v[208:211], v[76:79]
    v_exp_f32 v195, v195
    v_mfma_f32_16x16x32_bf16 v[80:83], a[160:163], v[208:211], v[80:83]
    v_mfma_f32_16x16x32_bf16 v[84:87], a[164:167], v[208:211], v[84:87]
    v_mfma_f32_16x16x32_bf16 v[88:91], a[168:171], v[208:211], v[88:91]
    v_mfma_f32_16x16x32_bf16 v[92:95], a[172:175], v[208:211], v[92:95]
    s_waitcnt vmcnt(17)
    v_mfma_f32_16x16x32_bf16 a[224:227], a[240:243], v[208:211], a[224:227]
    s_barrier
    v_mfma_f32_16x16x32_bf16 v[200:203], a[96:99], a[56:59], v[236:239]
    ds_read_b128 a[96:99], v240 offset:24576
    v_cvt_pk_bf16_f32 v208, v192, v193
    v_mfma_f32_16x16x32_bf16 v[200:203], a[100:103], a[68:71], v[200:203]
    v_cvt_pk_bf16_f32 v209, v194, v195
    v_mfma_f32_16x16x32_bf16 v[200:203], a[104:107], a[80:83], v[200:203]
    ds_read_b128 a[100:103], v241 offset:24576
    v_mfma_f32_16x16x32_bf16 v[200:203], a[108:111], a[92:95], v[200:203]
    v_exp_f32 v196, v196
    v_mfma_f32_16x16x32_bf16 v[204:207], a[112:115], a[56:59], v[236:239]
    ds_read_b128 a[104:107], v242 offset:24576
    v_mfma_f32_16x16x32_bf16 v[204:207], a[116:119], a[68:71], v[204:207]
    buffer_load_dwordx4 v253, s[8:11], s74 offen offset:1024 nt lds
    v_mfma_f32_16x16x32_bf16 v[204:207], a[120:123], a[80:83], v[204:207]
    ds_read_b128 a[108:111], v243 offset:24576
    v_mfma_f32_16x16x32_bf16 v[204:207], a[124:127], a[92:95], v[204:207]
    v_exp_f32 v197, v197
    v_mfma_f32_16x16x32_bf16 v[96:99], a[144:147], v[212:215], v[96:99]
    ds_read_b128 a[112:115], v240 offset:28672
    v_mfma_f32_16x16x32_bf16 v[100:103], a[148:151], v[212:215], v[100:103]
    v_exp_f32 v198, v198
    v_mfma_f32_16x16x32_bf16 v[104:107], a[152:155], v[212:215], v[104:107]
    ds_read_b128 a[116:119], v241 offset:28672
    v_mfma_f32_16x16x32_bf16 v[108:111], a[156:159], v[212:215], v[108:111]
    v_exp_f32 v199, v199
    v_mfma_f32_16x16x32_bf16 v[112:115], a[160:163], v[212:215], v[112:115]
    ds_read_b128 a[120:123], v242 offset:28672
    v_cvt_pk_bf16_f32 v210, v196, v197
    v_mfma_f32_16x16x32_bf16 v[116:119], a[164:167], v[212:215], v[116:119]
    v_cvt_pk_bf16_f32 v211, v198, v199
    v_mfma_f32_16x16x32_bf16 v[120:123], a[168:171], v[212:215], v[120:123]
    ds_read_b128 a[124:127], v243 offset:28672
    v_mfma_f32_16x16x32_bf16 v[124:127], a[172:175], v[212:215], v[124:127]
    v_exp_f32 v200, v200
    v_mfma_f32_16x16x32_bf16 a[228:231], a[240:243], v[212:215], a[228:231]
    s_waitcnt lgkmcnt(7)
    v_exp_f32 v201, v201
    v_mfma_f32_16x16x32_bf16 v[192:195], a[96:99], a[0:3], v[216:219]
    s_waitcnt lgkmcnt(6)
    v_exp_f32 v202, v202
    v_mfma_f32_16x16x32_bf16 v[192:195], a[100:103], a[12:15], v[192:195]
    s_waitcnt lgkmcnt(5)
    v_exp_f32 v203, v203
    v_mfma_f32_16x16x32_bf16 v[192:195], a[104:107], a[24:27], v[192:195]
    s_waitcnt lgkmcnt(4)
    v_cvt_pk_bf16_f32 v212, v200, v201
    v_cvt_pk_bf16_f32 v213, v202, v203
    v_mfma_f32_16x16x32_bf16 v[192:195], a[108:111], a[36:39], v[192:195]
    s_waitcnt lgkmcnt(3)
    v_exp_f32 v204, v204
    v_mfma_f32_16x16x32_bf16 v[196:199], a[112:115], a[0:3], v[216:219]
    s_waitcnt lgkmcnt(2)
    v_exp_f32 v205, v205
    v_mfma_f32_16x16x32_bf16 v[196:199], a[116:119], a[12:15], v[196:199]
    s_waitcnt lgkmcnt(1)
    buffer_load_dwordx4 v254, s[8:11], s74 offen offset:2048 nt lds
    v_mfma_f32_16x16x32_bf16 v[196:199], a[120:123], a[24:27], v[196:199]
    s_waitcnt lgkmcnt(0)
    v_exp_f32 v206, v206
    v_mfma_f32_16x16x32_bf16 v[196:199], a[124:127], a[36:39], v[196:199]
    v_exp_f32 v207, v207
    v_mfma_f32_16x16x32_bf16 v[128:131], a[144:147], v[208:211], v[128:131]
    v_cvt_pk_bf16_f32 v214, v204, v205
    v_cvt_pk_bf16_f32 v215, v206, v207
    v_mfma_f32_16x16x32_bf16 v[132:135], a[148:151], v[208:211], v[132:135]
    v_exp_f32 v192, v192
    v_mfma_f32_16x16x32_bf16 v[136:139], a[152:155], v[208:211], v[136:139]
    v_exp_f32 v193, v193
    v_mfma_f32_16x16x32_bf16 v[140:143], a[156:159], v[208:211], v[140:143]
    v_exp_f32 v194, v194
    v_mfma_f32_16x16x32_bf16 v[144:147], a[160:163], v[208:211], v[144:147]
    v_exp_f32 v195, v195
    v_mfma_f32_16x16x32_bf16 v[148:151], a[164:167], v[208:211], v[148:151]
    v_mfma_f32_16x16x32_bf16 v[152:155], a[168:171], v[208:211], v[152:155]
    v_mfma_f32_16x16x32_bf16 v[156:159], a[172:175], v[208:211], v[156:159]
    v_mfma_f32_16x16x32_bf16 a[232:235], a[240:243], v[208:211], a[232:235]
    v_mfma_f32_16x16x32_bf16 v[200:203], a[96:99], a[4:7], v[220:223]
    v_cvt_pk_bf16_f32 v208, v192, v193
    v_cvt_pk_bf16_f32 v209, v194, v195
    v_mfma_f32_16x16x32_bf16 v[200:203], a[100:103], a[16:19], v[200:203]
    v_exp_f32 v196, v196
    v_mfma_f32_16x16x32_bf16 v[200:203], a[104:107], a[28:31], v[200:203]
    v_exp_f32 v197, v197
    v_mfma_f32_16x16x32_bf16 v[200:203], a[108:111], a[40:43], v[200:203]
    v_exp_f32 v198, v198
    v_mfma_f32_16x16x32_bf16 v[204:207], a[112:115], a[4:7], v[220:223]
    buffer_load_dwordx4 v255, s[8:11], s74 offen offset:3072 nt lds
    v_mfma_f32_16x16x32_bf16 v[204:207], a[116:119], a[16:19], v[204:207]
    v_exp_f32 v199, v199
    v_mfma_f32_16x16x32_bf16 v[204:207], a[120:123], a[28:31], v[204:207]
    v_cvt_pk_bf16_f32 v210, v196, v197
    v_cvt_pk_bf16_f32 v211, v198, v199
    v_mfma_f32_16x16x32_bf16 v[204:207], a[124:127], a[40:43], v[204:207]
    v_mfma_f32_16x16x32_bf16 v[160:163], a[144:147], v[212:215], v[160:163]
    ds_read_b64_tr_b16 a[144:145], v244 offset:24576
    ds_read_b64_tr_b16 a[146:147], v244 offset:28672
    v_mfma_f32_16x16x32_bf16 v[164:167], a[148:151], v[212:215], v[164:167]
    v_exp_f32 v200, v200
    v_mfma_f32_16x16x32_bf16 v[168:171], a[152:155], v[212:215], v[168:171]
    ds_read_b64_tr_b16 a[148:149], v245 offset:24576
    ds_read_b64_tr_b16 a[150:151], v245 offset:28672
    v_mfma_f32_16x16x32_bf16 v[172:175], a[156:159], v[212:215], v[172:175]
    v_exp_f32 v201, v201
    v_mfma_f32_16x16x32_bf16 v[176:179], a[160:163], v[212:215], v[176:179]
    ds_read_b64_tr_b16 a[152:153], v246 offset:24576
    ds_read_b64_tr_b16 a[154:155], v246 offset:28672
    v_mfma_f32_16x16x32_bf16 v[180:183], a[164:167], v[212:215], v[180:183]
    v_exp_f32 v202, v202
    v_mfma_f32_16x16x32_bf16 v[184:187], a[168:171], v[212:215], v[184:187]
    ds_read_b64_tr_b16 a[156:157], v247 offset:24576
    ds_read_b64_tr_b16 a[158:159], v247 offset:28672
    v_mfma_f32_16x16x32_bf16 v[188:191], a[172:175], v[212:215], v[188:191]
    v_exp_f32 v203, v203
    v_mfma_f32_16x16x32_bf16 a[236:239], a[240:243], v[212:215], a[236:239]
    ds_read_b64_tr_b16 a[160:161], v248 offset:24576
    ds_read_b64_tr_b16 a[162:163], v248 offset:28672
    v_mfma_f32_16x16x32_bf16 v[192:195], a[96:99], a[8:11], v[224:227]
    s_add_u32 m0, s68, 90112
    v_cvt_pk_bf16_f32 v212, v200, v201
    v_cvt_pk_bf16_f32 v213, v202, v203
    v_mfma_f32_16x16x32_bf16 v[192:195], a[100:103], a[20:23], v[192:195]
    s_xor_b32 s74, s38, 90112
    ds_read_b64_tr_b16 a[164:165], v249 offset:24576
    ds_read_b64_tr_b16 a[166:167], v249 offset:28672
    v_mfma_f32_16x16x32_bf16 v[192:195], a[104:107], a[32:35], v[192:195]
    v_exp_f32 v204, v204
    v_mfma_f32_16x16x32_bf16 v[192:195], a[108:111], a[44:47], v[192:195]
    ds_read_b64_tr_b16 a[168:169], v250 offset:24576
    ds_read_b64_tr_b16 a[170:171], v250 offset:28672
    v_mfma_f32_16x16x32_bf16 v[196:199], a[112:115], a[8:11], v[224:227]
    buffer_load_dwordx4 v252, s[12:15], s74 offen offset:0 nt lds
    v_mfma_f32_16x16x32_bf16 v[196:199], a[116:119], a[20:23], v[196:199]
    ds_read_b64_tr_b16 a[172:173], v251 offset:24576
    ds_read_b64_tr_b16 a[174:175], v251 offset:28672
    v_mfma_f32_16x16x32_bf16 v[196:199], a[120:123], a[32:35], v[196:199]
    v_exp_f32 v205, v205
    v_mfma_f32_16x16x32_bf16 v[196:199], a[124:127], a[44:47], v[196:199]
    s_waitcnt lgkmcnt(14)
    v_exp_f32 v206, v206
    v_mfma_f32_16x16x32_bf16 v[0:3], a[144:147], v[208:211], v[0:3]
    s_waitcnt lgkmcnt(12)
    v_exp_f32 v207, v207
    v_mfma_f32_16x16x32_bf16 v[4:7], a[148:151], v[208:211], v[4:7]
    s_waitcnt lgkmcnt(10)
    v_cvt_pk_bf16_f32 v214, v204, v205
    v_cvt_pk_bf16_f32 v215, v206, v207
    v_mfma_f32_16x16x32_bf16 v[8:11], a[152:155], v[208:211], v[8:11]
    s_waitcnt lgkmcnt(8)
    v_exp_f32 v192, v192
    v_mfma_f32_16x16x32_bf16 v[12:15], a[156:159], v[208:211], v[12:15]
    s_waitcnt lgkmcnt(6)
    v_exp_f32 v193, v193
    v_mfma_f32_16x16x32_bf16 v[16:19], a[160:163], v[208:211], v[16:19]
    s_waitcnt lgkmcnt(4)
    v_exp_f32 v194, v194
    v_mfma_f32_16x16x32_bf16 v[20:23], a[164:167], v[208:211], v[20:23]
    s_waitcnt lgkmcnt(2)
    v_exp_f32 v195, v195
    v_mfma_f32_16x16x32_bf16 v[24:27], a[168:171], v[208:211], v[24:27]
    s_waitcnt lgkmcnt(0)
    v_mfma_f32_16x16x32_bf16 v[28:31], a[172:175], v[208:211], v[28:31]
    v_mfma_f32_16x16x32_bf16 a[216:219], a[240:243], v[208:211], a[216:219]
    v_mfma_f32_16x16x32_bf16 v[200:203], a[96:99], a[48:51], v[228:231]
    v_cvt_pk_bf16_f32 v208, v192, v193
    v_cvt_pk_bf16_f32 v209, v194, v195
    v_mfma_f32_16x16x32_bf16 v[200:203], a[100:103], a[60:63], v[200:203]
    v_exp_f32 v196, v196
    v_mfma_f32_16x16x32_bf16 v[200:203], a[104:107], a[72:75], v[200:203]
    v_exp_f32 v197, v197
    v_mfma_f32_16x16x32_bf16 v[200:203], a[108:111], a[84:87], v[200:203]
    buffer_load_dwordx4 v253, s[12:15], s74 offen offset:1024 nt lds
    v_mfma_f32_16x16x32_bf16 v[204:207], a[112:115], a[48:51], v[228:231]
    v_exp_f32 v198, v198
    v_mfma_f32_16x16x32_bf16 v[204:207], a[116:119], a[60:63], v[204:207]
    v_exp_f32 v199, v199
    v_mfma_f32_16x16x32_bf16 v[204:207], a[120:123], a[72:75], v[204:207]
    v_cvt_pk_bf16_f32 v210, v196, v197
    v_cvt_pk_bf16_f32 v211, v198, v199
    v_mfma_f32_16x16x32_bf16 v[204:207], a[124:127], a[84:87], v[204:207]
    v_mfma_f32_16x16x32_bf16 v[32:35], a[144:147], v[212:215], v[32:35]
    v_exp_f32 v200, v200
    v_mfma_f32_16x16x32_bf16 v[36:39], a[148:151], v[212:215], v[36:39]
    v_exp_f32 v201, v201
    v_mfma_f32_16x16x32_bf16 v[40:43], a[152:155], v[212:215], v[40:43]
    v_exp_f32 v202, v202
    v_mfma_f32_16x16x32_bf16 v[44:47], a[156:159], v[212:215], v[44:47]
    v_exp_f32 v203, v203
    v_mfma_f32_16x16x32_bf16 v[48:51], a[160:163], v[212:215], v[48:51]
    v_mfma_f32_16x16x32_bf16 v[52:55], a[164:167], v[212:215], v[52:55]
    v_mfma_f32_16x16x32_bf16 v[56:59], a[168:171], v[212:215], v[56:59]
    v_mfma_f32_16x16x32_bf16 v[60:63], a[172:175], v[212:215], v[60:63]
    v_mfma_f32_16x16x32_bf16 a[220:223], a[240:243], v[212:215], a[220:223]
    v_mfma_f32_16x16x32_bf16 v[192:195], a[96:99], a[52:55], v[232:235]
    v_cvt_pk_bf16_f32 v212, v200, v201
    v_cvt_pk_bf16_f32 v213, v202, v203
    v_mfma_f32_16x16x32_bf16 v[192:195], a[100:103], a[64:67], v[192:195]
    v_exp_f32 v204, v204
    v_mfma_f32_16x16x32_bf16 v[192:195], a[104:107], a[76:79], v[192:195]
    v_exp_f32 v205, v205
    v_mfma_f32_16x16x32_bf16 v[192:195], a[108:111], a[88:91], v[192:195]
    buffer_load_dwordx4 v254, s[12:15], s74 offen offset:2048 nt lds
    v_mfma_f32_16x16x32_bf16 v[196:199], a[112:115], a[52:55], v[232:235]
    v_exp_f32 v206, v206
    v_mfma_f32_16x16x32_bf16 v[196:199], a[116:119], a[64:67], v[196:199]
    v_exp_f32 v207, v207
    v_mfma_f32_16x16x32_bf16 v[196:199], a[120:123], a[76:79], v[196:199]
    v_cvt_pk_bf16_f32 v214, v204, v205
    v_cvt_pk_bf16_f32 v215, v206, v207
    v_mfma_f32_16x16x32_bf16 v[196:199], a[124:127], a[88:91], v[196:199]
    v_mfma_f32_16x16x32_bf16 v[64:67], a[144:147], v[208:211], v[64:67]
    v_exp_f32 v192, v192
    v_mfma_f32_16x16x32_bf16 v[68:71], a[148:151], v[208:211], v[68:71]
    v_exp_f32 v193, v193
    v_mfma_f32_16x16x32_bf16 v[72:75], a[152:155], v[208:211], v[72:75]
    v_exp_f32 v194, v194
    v_mfma_f32_16x16x32_bf16 v[76:79], a[156:159], v[208:211], v[76:79]
    v_exp_f32 v195, v195
    v_mfma_f32_16x16x32_bf16 v[80:83], a[160:163], v[208:211], v[80:83]
    v_mfma_f32_16x16x32_bf16 v[84:87], a[164:167], v[208:211], v[84:87]
    v_mfma_f32_16x16x32_bf16 v[88:91], a[168:171], v[208:211], v[88:91]
    v_mfma_f32_16x16x32_bf16 v[92:95], a[172:175], v[208:211], v[92:95]
    s_waitcnt vmcnt(15)
    v_mfma_f32_16x16x32_bf16 a[224:227], a[240:243], v[208:211], a[224:227]
    s_barrier
    v_mfma_f32_16x16x32_bf16 v[200:203], a[96:99], a[56:59], v[236:239]
    ds_read_b128 a[96:99], v240 offset:32768
    v_cvt_pk_bf16_f32 v208, v192, v193
    v_mfma_f32_16x16x32_bf16 v[200:203], a[100:103], a[68:71], v[200:203]
    v_cvt_pk_bf16_f32 v209, v194, v195
    v_mfma_f32_16x16x32_bf16 v[200:203], a[104:107], a[80:83], v[200:203]
    ds_read_b128 a[100:103], v241 offset:32768
    v_mfma_f32_16x16x32_bf16 v[200:203], a[108:111], a[92:95], v[200:203]
    buffer_load_dwordx4 v255, s[12:15], s74 offen offset:3072 nt lds
    v_mfma_f32_16x16x32_bf16 v[204:207], a[112:115], a[56:59], v[236:239]
    ds_read_b128 a[104:107], v242 offset:32768
    v_mfma_f32_16x16x32_bf16 v[204:207], a[116:119], a[68:71], v[204:207]
    v_exp_f32 v196, v196
    v_mfma_f32_16x16x32_bf16 v[204:207], a[120:123], a[80:83], v[204:207]
    ds_read_b128 a[108:111], v243 offset:32768
    v_mfma_f32_16x16x32_bf16 v[204:207], a[124:127], a[92:95], v[204:207]
    v_exp_f32 v197, v197
    v_mfma_f32_16x16x32_bf16 v[96:99], a[144:147], v[212:215], v[96:99]
    ds_read_b128 a[112:115], v240 offset:36864
    v_mfma_f32_16x16x32_bf16 v[100:103], a[148:151], v[212:215], v[100:103]
    v_exp_f32 v198, v198
    v_mfma_f32_16x16x32_bf16 v[104:107], a[152:155], v[212:215], v[104:107]
    ds_read_b128 a[116:119], v241 offset:36864
    v_mfma_f32_16x16x32_bf16 v[108:111], a[156:159], v[212:215], v[108:111]
    v_exp_f32 v199, v199
    v_mfma_f32_16x16x32_bf16 v[112:115], a[160:163], v[212:215], v[112:115]
    ds_read_b128 a[120:123], v242 offset:36864
    v_cvt_pk_bf16_f32 v210, v196, v197
    v_mfma_f32_16x16x32_bf16 v[116:119], a[164:167], v[212:215], v[116:119]
    v_cvt_pk_bf16_f32 v211, v198, v199
    v_mfma_f32_16x16x32_bf16 v[120:123], a[168:171], v[212:215], v[120:123]
L_hopa_7:
    s_cbranch_execz L_backa
    ds_read_b128 a[124:127], v243 offset:36864
    v_mfma_f32_16x16x32_bf16 v[124:127], a[172:175], v[212:215], v[124:127]
    s_add_u32 m0, s68, 16384
    v_exp_f32 v200, v200
    v_mfma_f32_16x16x32_bf16 a[228:231], a[240:243], v[212:215], a[228:231]
    s_waitcnt lgkmcnt(7)
    s_xor_b32 s74, s38, 98304
    v_exp_f32 v201, v201
    v_mfma_f32_16x16x32_bf16 v[192:195], a[96:99], a[0:3], v[216:219]
    s_waitcnt lgkmcnt(6)
    v_exp_f32 v202, v202
    v_mfma_f32_16x16x32_bf16 v[192:195], a[100:103], a[12:15], v[192:195]
    s_waitcnt lgkmcnt(5)
    v_exp_f32 v203, v203
    v_mfma_f32_16x16x32_bf16 v[192:195], a[104:107], a[24:27], v[192:195]
    s_waitcnt lgkmcnt(4)
    buffer_load_dwordx4 v252, s[8:11], s74 offen offset:0 nt lds
    v_mfma_f32_16x16x32_bf16 v[192:195], a[108:111], a[36:39], v[192:195]
    s_waitcnt lgkmcnt(3)
    v_cvt_pk_bf16_f32 v212, v200, v201
    v_cvt_pk_bf16_f32 v213, v202, v203
    v_mfma_f32_16x16x32_bf16 v[196:199], a[112:115], a[0:3], v[216:219]
    s_waitcnt lgkmcnt(2)
    v_exp_f32 v204, v204
    v_mfma_f32_16x16x32_bf16 v[196:199], a[116:119], a[12:15], v[196:199]
    s_waitcnt lgkmcnt(1)
    v_exp_f32 v205, v205
    v_mfma_f32_16x16x32_bf16 v[196:199], a[120:123], a[24:27], v[196:199]
    s_waitcnt lgkmcnt(0)
    v_exp_f32 v206, v206
    v_mfma_f32_16x16x32_bf16 v[196:199], a[124:127], a[36:39], v[196:199]
    v_exp_f32 v207, v207
    v_mfma_f32_16x16x32_bf16 v[128:131], a[144:147], v[208:211], v[128:131]
    v_cvt_pk_bf16_f32 v214, v204, v205
    v_cvt_pk_bf16_f32 v215, v206, v207
    v_mfma_f32_16x16x32_bf16 v[132:135], a[148:151], v[208:211], v[132:135]
    v_exp_f32 v192, v192
    v_mfma_f32_16x16x32_bf16 v[136:139], a[152:155], v[208:211], v[136:139]
    v_exp_f32 v193, v193
    v_mfma_f32_16x16x32_bf16 v[140:143], a[156:159], v[208:211], v[140:143]
    v_exp_f32 v194, v194
    v_mfma_f32_16x16x32_bf16 v[144:147], a[160:163], v[208:211], v[144:147]
    v_exp_f32 v195, v195
    v_mfma_f32_16x16x32_bf16 v[148:151], a[164:167], v[208:211], v[148:151]
    v_mfma_f32_16x16x32_bf16 v[152:155], a[168:171], v[208:211], v[152:155]
    v_mfma_f32_16x16x32_bf16 v[156:159], a[172:175], v[208:211], v[156:159]
    v_mfma_f32_16x16x32_bf16 a[232:235], a[240:243], v[208:211], a[232:235]
    v_mfma_f32_16x16x32_bf16 v[200:203], a[96:99], a[4:7], v[220:223]
    v_cvt_pk_bf16_f32 v208, v192, v193
    v_cvt_pk_bf16_f32 v209, v194, v195
    v_mfma_f32_16x16x32_bf16 v[200:203], a[100:103], a[16:19], v[200:203]
    buffer_load_dwordx4 v253, s[8:11], s74 offen offset:1024 nt lds
    v_mfma_f32_16x16x32_bf16 v[200:203], a[104:107], a[28:31], v[200:203]
    v_exp_f32 v196, v196
    v_mfma_f32_16x16x32_bf16 v[200:203], a[108:111], a[40:43], v[200:203]
    v_exp_f32 v197, v197
    v_mfma_f32_16x16x32_bf16 v[204:207], a[112:115], a[4:7], v[220:223]
    v_exp_f32 v198, v198
    v_mfma_f32_16x16x32_bf16 v[204:207], a[116:119], a[16:19], v[204:207]
    v_exp_f32 v199, v199
    v_mfma_f32_16x16x32_bf16 v[204:207], a[120:123], a[28:31], v[204:207]
    v_cvt_pk_bf16_f32 v210, v196, v197
    v_cvt_pk_bf16_f32 v211, v198, v199
    v_mfma_f32_16x16x32_bf16 v[204:207], a[124:127], a[40:43], v[204:207]
    v_mfma_f32_16x16x32_bf16 v[160:163], a[144:147], v[212:215], v[160:163]
    ds_read_b64_tr_b16 a[144:145], v244 offset:32768
    ds_read_b64_tr_b16 a[146:147], v244 offset:36864
    v_mfma_f32_16x16x32_bf16 v[164:167], a[148:151], v[212:215], v[164:167]
    v_exp_f32 v200, v200
    v_mfma_f32_16x16x32_bf16 v[168:171], a[152:155], v[212:215], v[168:171]
    ds_read_b64_tr_b16 a[148:149], v245 offset:32768
    ds_read_b64_tr_b16 a[150:151], v245 offset:36864
    v_mfma_f32_16x16x32_bf16 v[172:175], a[156:159], v[212:215], v[172:175]
    v_exp_f32 v201, v201
    v_mfma_f32_16x16x32_bf16 v[176:179], a[160:163], v[212:215], v[176:179]
    ds_read_b64_tr_b16 a[152:153], v246 offset:32768
    ds_read_b64_tr_b16 a[154:155], v246 offset:36864
    v_mfma_f32_16x16x32_bf16 v[180:183], a[164:167], v[212:215], v[180:183]
    v_exp_f32 v202, v202
    v_mfma_f32_16x16x32_bf16 v[184:187], a[168:171], v[212:215], v[184:187]
    ds_read_b64_tr_b16 a[156:157], v247 offset:32768
    ds_read_b64_tr_b16 a[158:159], v247 offset:36864
    v_mfma_f32_16x16x32_bf16 v[188:191], a[172:175], v[212:215], v[188:191]
    v_exp_f32 v203, v203
    v_mfma_f32_16x16x32_bf16 a[236:239], a[240:243], v[212:215], a[236:239]
    ds_read_b64_tr_b16 a[160:161], v248 offset:32768
    ds_read_b64_tr_b16 a[162:163], v248 offset:36864
    v_mfma_f32_16x16x32_bf16 v[192:195], a[96:99], a[8:11], v[224:227]
    v_cvt_pk_bf16_f32 v212, v200, v201
    v_cvt_pk_bf16_f32 v213, v202, v203
    v_mfma_f32_16x16x32_bf16 v[192:195], a[100:103], a[20:23], v[192:195]
    ds_read_b64_tr_b16 a[164:165], v249 offset:32768
    ds_read_b64_tr_b16 a[166:167], v249 offset:36864
    v_mfma_f32_16x16x32_bf16 v[192:195], a[104:107], a[32:35], v[192:195]
    buffer_load_dwordx4 v254, s[8:11], s74 offen offset:2048 nt lds
    v_mfma_f32_16x16x32_bf16 v[192:195], a[108:111], a[44:47], v[192:195]
    ds_read_b64_tr_b16 a[168:169], v250 offset:32768
    ds_read_b64_tr_b16 a[170:171], v250 offset:36864
    v_mfma_f32_16x16x32_bf16 v[196:199], a[112:115], a[8:11], v[224:227]
    v_exp_f32 v204, v204
    v_mfma_f32_16x16x32_bf16 v[196:199], a[116:119], a[20:23], v[196:199]
    ds_read_b64_tr_b16 a[172:173], v251 offset:32768
    ds_read_b64_tr_b16 a[174:175], v251 offset:36864
    v_mfma_f32_16x16x32_bf16 v[196:199], a[120:123], a[32:35], v[196:199]
    v_exp_f32 v205, v205
    v_mfma_f32_16x16x32_bf16 v[196:199], a[124:127], a[44:47], v[196:199]
    s_waitcnt lgkmcnt(14)
    v_exp_f32 v206, v206
    v_mfma_f32_16x16x32_bf16 v[0:3], a[144:147], v[208:211], v[0:3]
    s_waitcnt lgkmcnt(12)
    v_exp_f32 v207, v207
    v_mfma_f32_16x16x32_bf16 v[4:7], a[148:151], v[208:211], v[4:7]
    s_waitcnt lgkmcnt(10)
    v_cvt_pk_bf16_f32 v214, v204, v205
    v_cvt_pk_bf16_f32 v215, v206, v207
    v_mfma_f32_16x16x32_bf16 v[8:11], a[152:155], v[208:211], v[8:11]
    s_waitcnt lgkmcnt(8)
    v_exp_f32 v192, v192
    v_mfma_f32_16x16x32_bf16 v[12:15], a[156:159], v[208:211], v[12:15]
    s_waitcnt lgkmcnt(6)
    v_exp_f32 v193, v193
    v_mfma_f32_16x16x32_bf16 v[16:19], a[160:163], v[208:211], v[16:19]
    s_waitcnt lgkmcnt(4)
    v_exp_f32 v194, v194
    v_mfma_f32_16x16x32_bf16 v[20:23], a[164:167], v[208:211], v[20:23]
    s_waitcnt lgkmcnt(2)
    v_exp_f32 v195, v195
    v_mfma_f32_16x16x32_bf16 v[24:27], a[168:171], v[208:211], v[24:27]
    s_waitcnt lgkmcnt(0)
    v_mfma_f32_16x16x32_bf16 v[28:31], a[172:175], v[208:211], v[28:31]
    v_mfma_f32_16x16x32_bf16 a[216:219], a[240:243], v[208:211], a[216:219]
    v_mfma_f32_16x16x32_bf16 v[200:203], a[96:99], a[48:51], v[228:231]
    buffer_load_dwordx4 v255, s[8:11], s74 offen offset:3072 nt lds
    v_mfma_f32_16x16x32_bf16 v[200:203], a[100:103], a[60:63], v[200:203]
    v_cvt_pk_bf16_f32 v208, v192, v193
    v_cvt_pk_bf16_f32 v209, v194, v195
    v_mfma_f32_16x16x32_bf16 v[200:203], a[104:107], a[72:75], v[200:203]
    v_exp_f32 v196, v196
    v_mfma_f32_16x16x32_bf16 v[200:203], a[108:111], a[84:87], v[200:203]
    v_exp_f32 v197, v197
    v_mfma_f32_16x16x32_bf16 v[204:207], a[112:115], a[48:51], v[228:231]
    v_exp_f32 v198, v198
    v_mfma_f32_16x16x32_bf16 v[204:207], a[116:119], a[60:63], v[204:207]
    v_exp_f32 v199, v199
    v_mfma_f32_16x16x32_bf16 v[204:207], a[120:123], a[72:75], v[204:207]
    v_cvt_pk_bf16_f32 v210, v196, v197
    v_cvt_pk_bf16_f32 v211, v198, v199
    v_mfma_f32_16x16x32_bf16 v[204:207], a[124:127], a[84:87], v[204:207]
    v_mfma_f32_16x16x32_bf16 v[32:35], a[144:147], v[212:215], v[32:35]
    v_exp_f32 v200, v200
    v_mfma_f32_16x16x32_bf16 v[36:39], a[148:151], v[212:215], v[36:39]
    v_exp_f32 v201, v201
    v_mfma_f32_16x16x32_bf16 v[40:43], a[152:155], v[212:215], v[40:43]
    v_exp_f32 v202, v202
    v_mfma_f32_16x16x32_bf16 v[44:47], a[156:159], v[212:215], v[44:47]
    v_exp_f32 v203, v203
    v_mfma_f32_16x16x32_bf16 v[48:51], a[160:163], v[212:215], v[48:51]
    v_mfma_f32_16x16x32_bf16 v[52:55], a[164:167], v[212:215], v[52:55]
    s_add_u32 m0, s68, 98304
    v_mfma_f32_16x16x32_bf16 v[56:59], a[168:171], v[212:215], v[56:59]
    s_xor_b32 s74, s38, 98304
    v_mfma_f32_16x16x32_bf16 v[60:63], a[172:175], v[212:215], v[60:63]
    v_mfma_f32_16x16x32_bf16 a[220:223], a[240:243], v[212:215], a[220:223]
    v_mfma_f32_16x16x32_bf16 v[192:195], a[96:99], a[52:55], v[232:235]
    buffer_load_dwordx4 v252, s[12:15], s74 offen offset:0 nt lds
    v_mfma_f32_16x16x32_bf16 v[192:195], a[100:103], a[64:67], v[192:195]
    v_cvt_pk_bf16_f32 v212, v200, v201
    v_cvt_pk_bf16_f32 v213, v202, v203
    v_mfma_f32_16x16x32_bf16 v[192:195], a[104:107], a[76:79], v[192:195]
    v_exp_f32 v204, v204
    v_mfma_f32_16x16x32_bf16 v[192:195], a[108:111], a[88:91], v[192:195]
    v_exp_f32 v205, v205
    v_mfma_f32_16x16x32_bf16 v[196:199], a[112:115], a[52:55], v[232:235]
    v_exp_f32 v206, v206
    v_mfma_f32_16x16x32_bf16 v[196:199], a[116:119], a[64:67], v[196:199]
    v_exp_f32 v207, v207
    v_mfma_f32_16x16x32_bf16 v[196:199], a[120:123], a[76:79], v[196:199]
    v_cvt_pk_bf16_f32 v214, v204, v205
    v_cvt_pk_bf16_f32 v215, v206, v207
    v_mfma_f32_16x16x32_bf16 v[196:199], a[124:127], a[88:91], v[196:199]
    v_mfma_f32_16x16x32_bf16 v[64:67], a[144:147], v[208:211], v[64:67]
    v_exp_f32 v192, v192
    v_mfma_f32_16x16x32_bf16 v[68:71], a[148:151], v[208:211], v[68:71]
    v_exp_f32 v193, v193
    v_mfma_f32_16x16x32_bf16 v[72:75], a[152:155], v[208:211], v[72:75]
    v_exp_f32 v194, v194
    v_mfma_f32_16x16x32_bf16 v[76:79], a[156:159], v[208:211], v[76:79]
    v_exp_f32 v195, v195
    v_mfma_f32_16x16x32_bf16 v[80:83], a[160:163], v[208:211], v[80:83]
    v_mfma_f32_16x16x32_bf16 v[84:87], a[164:167], v[208:211], v[84:87]
    v_mfma_f32_16x16x32_bf16 v[88:91], a[168:171], v[208:211], v[88:91]
    v_mfma_f32_16x16x32_bf16 v[92:95], a[172:175], v[208:211], v[92:95]
    s_waitcnt vmcnt(13)
    v_mfma_f32_16x16x32_bf16 a[224:227], a[240:243], v[208:211], a[224:227]
    s_barrier
    buffer_load_dwordx4 v253, s[12:15], s74 offen offset:1024 nt lds
    v_mfma_f32_16x16x32_bf16 v[200:203], a[96:99], a[56:59], v[236:239]
    ds_read_b128 a[96:99], v240 offset:0
    v_cvt_pk_bf16_f32 v208, v192, v193
    v_mfma_f32_16x16x32_bf16 v[200:203], a[100:103], a[68:71], v[200:203]
    v_cvt_pk_bf16_f32 v209, v194, v195
    v_mfma_f32_16x16x32_bf16 v[200:203], a[104:107], a[80:83], v[200:203]
    ds_read_b128 a[100:103], v241 offset:0
    v_mfma_f32_16x16x32_bf16 v[200:203], a[108:111], a[92:95], v[200:203]
    v_exp_f32 v196, v196
    v_mfma_f32_16x16x32_bf16 v[204:207], a[112:115], a[56:59], v[236:239]
    ds_read_b128 a[104:107], v242 offset:0
    v_mfma_f32_16x16x32_bf16 v[204:207], a[116:119], a[68:71], v[204:207]
    v_exp_f32 v197, v197
    v_mfma_f32_16x16x32_bf16 v[204:207], a[120:123], a[80:83], v[204:207]
    ds_read_b128 a[108:111], v243 offset:0
    v_mfma_f32_16x16x32_bf16 v[204:207], a[124:127], a[92:95], v[204:207]
    v_exp_f32 v198, v198
    v_mfma_f32_16x16x32_bf16 v[96:99], a[144:147], v[212:215], v[96:99]
    ds_read_b128 a[112:115], v240 offset:4096
    v_mfma_f32_16x16x32_bf16 v[100:103], a[148:151], v[212:215], v[100:103]
    v_exp_f32 v199, v199
    v_mfma_f32_16x16x32_bf16 v[104:107], a[152:155], v[212:215], v[104:107]
    ds_read_b128 a[116:119], v241 offset:4096
    v_cvt_pk_bf16_f32 v210, v196, v197
    v_mfma_f32_16x16x32_bf16 v[108:111], a[156:159], v[212:215], v[108:111]
    v_cvt_pk_bf16_f32 v211, v198, v199
    v_mfma_f32_16x16x32_bf16 v[112:115], a[160:163], v[212:215], v[112:115]
    ds_read_b128 a[120:123], v242 offset:4096
    v_mfma_f32_16x16x32_bf16 v[116:119], a[164:167], v[212:215], v[116:119]
    v_exp_f32 v200, v200
    v_mfma_f32_16x16x32_bf16 v[120:123], a[168:171], v[212:215], v[120:123]
    ds_read_b128 a[124:127], v243 offset:4096
    v_mfma_f32_16x16x32_bf16 v[124:127], a[172:175], v[212:215], v[124:127]
    v_exp_f32 v201, v201
    v_mfma_f32_16x16x32_bf16 a[228:231], a[240:243], v[212:215], a[228:231]
    s_waitcnt lgkmcnt(7)
    buffer_load_dwordx4 v254, s[12:15], s74 offen offset:2048 nt lds
    v_mfma_f32_16x16x32_bf16 v[192:195], a[96:99], a[0:3], v[216:219]
    s_waitcnt lgkmcnt(6)
    v_exp_f32 v202, v202
    v_mfma_f32_16x16x32_bf16 v[192:195], a[100:103], a[12:15], v[192:195]
    s_waitcnt lgkmcnt(5)
    v_exp_f32 v203, v203
    v_mfma_f32_16x16x32_bf16 v[192:195], a[104:107], a[24:27], v[192:195]
    s_waitcnt lgkmcnt(4)
    v_cvt_pk_bf16_f32 v212, v200, v201
    v_cvt_pk_bf16_f32 v213, v202, v203
    v_mfma_f32_16x16x32_bf16 v[192:195], a[108:111], a[36:39], v[192:195]
    s_waitcnt lgkmcnt(3)
    v_exp_f32 v204, v204
    v_mfma_f32_16x16x32_bf16 v[196:199], a[112:115], a[0:3], v[216:219]
    s_waitcnt lgkmcnt(2)
    v_exp_f32 v205, v205
    v_mfma_f32_16x16x32_bf16 v[196:199], a[116:119], a[12:15], v[196:199]
    s_waitcnt lgkmcnt(1)
    v_exp_f32 v206, v206
    v_mfma_f32_16x16x32_bf16 v[196:199], a[120:123], a[24:27], v[196:199]
    s_waitcnt lgkmcnt(0)
    v_exp_f32 v207, v207
    v_mfma_f32_16x16x32_bf16 v[196:199], a[124:127], a[36:39], v[196:199]
    v_cvt_pk_bf16_f32 v214, v204, v205
    v_cvt_pk_bf16_f32 v215, v206, v207
    v_mfma_f32_16x16x32_bf16 v[128:131], a[144:147], v[208:211], v[128:131]
    v_exp_f32 v192, v192
    v_mfma_f32_16x16x32_bf16 v[132:135], a[148:151], v[208:211], v[132:135]
    v_exp_f32 v193, v193
    v_mfma_f32_16x16x32_bf16 v[136:139], a[152:155], v[208:211], v[136:139]
    v_exp_f32 v194, v194
    v_mfma_f32_16x16x32_bf16 v[140:143], a[156:159], v[208:211], v[140:143]
    v_exp_f32 v195, v195
    v_mfma_f32_16x16x32_bf16 v[144:147], a[160:163], v[208:211], v[144:147]
    v_mfma_f32_16x16x32_bf16 v[148:151], a[164:167], v[208:211], v[148:151]
    v_mfma_f32_16x16x32_bf16 v[152:155], a[168:171], v[208:211], v[152:155]
    v_mfma_f32_16x16x32_bf16 v[156:159], a[172:175], v[208:211], v[156:159]
    buffer_load_dwordx4 v255, s[12:15], s74 offen offset:3072 nt lds
    v_mfma_f32_16x16x32_bf16 a[232:235], a[240:243], v[208:211], a[232:235]
    v_mfma_f32_16x16x32_bf16 v[200:203], a[96:99], a[4:7], v[220:223]
    v_cvt_pk_bf16_f32 v208, v192, v193
    v_cvt_pk_bf16_f32 v209, v194, v195
    v_mfma_f32_16x16x32_bf16 v[200:203], a[100:103], a[16:19], v[200:203]
    v_exp_f32 v196, v196
    v_mfma_f32_16x16x32_bf16 v[200:203], a[104:107], a[28:31], v[200:203]
    v_exp_f32 v197, v197
    v_mfma_f32_16x16x32_bf16 v[200:203], a[108:111], a[40:43], v[200:203]
    v_exp_f32 v198, v198
    v_mfma_f32_16x16x32_bf16 v[204:207], a[112:115], a[4:7], v[220:223]
    v_exp_f32 v199, v199
    v_mfma_f32_16x16x32_bf16 v[204:207], a[116:119], a[16:19], v[204:207]
    v_cvt_pk_bf16_f32 v210, v196, v197
    v_cvt_pk_bf16_f32 v211, v198, v199
    v_mfma_f32_16x16x32_bf16 v[204:207], a[120:123], a[28:31], v[204:207]
    v_mfma_f32_16x16x32_bf16 v[204:207], a[124:127], a[40:43], v[204:207]
    v_mfma_f32_16x16x32_bf16 v[160:163], a[144:147], v[212:215], v[160:163]
    ds_read_b64_tr_b16 a[144:145], v244 offset:0
    ds_read_b64_tr_b16 a[146:147], v244 offset:4096
    v_mfma_f32_16x16x32_bf16 v[164:167], a[148:151], v[212:215], v[164:167]
    v_exp_f32 v200, v200
    v_mfma_f32_16x16x32_bf16 v[168:171], a[152:155], v[212:215], v[168:171]
    ds_read_b64_tr_b16 a[148:149], v245 offset:0
    ds_read_b64_tr_b16 a[150:151], v245 offset:4096
    v_mfma_f32_16x16x32_bf16 v[172:175], a[156:159], v[212:215], v[172:175]
    s_add_u32 m0, s68, 24576
    v_exp_f32 v201, v201
    v_mfma_f32_16x16x32_bf16 v[176:179], a[160:163], v[212:215], v[176:179]
    s_xor_b32 s74, s38, 106496
    ds_read_b64_tr_b16 a[152:153], v246 offset:0
    ds_read_b64_tr_b16 a[154:155], v246 offset:4096
    v_mfma_f32_16x16x32_bf16 v[180:183], a[164:167], v[212:215], v[180:183]
    v_exp_f32 v202, v202
    v_mfma_f32_16x16x32_bf16 v[184:187], a[168:171], v[212:215], v[184:187]
    ds_read_b64_tr_b16 a[156:157], v247 offset:0
    ds_read_b64_tr_b16 a[158:159], v247 offset:4096
    v_mfma_f32_16x16x32_bf16 v[188:191], a[172:175], v[212:215], v[188:191]
    buffer_load_dwordx4 v252, s[8:11], s74 offen offset:0 nt lds
    v_mfma_f32_16x16x32_bf16 a[236:239], a[240:243], v[212:215], a[236:239]
    ds_read_b64_tr_b16 a[160:161], v248 offset:0
    ds_read_b64_tr_b16 a[162:163], v248 offset:4096
    v_mfma_f32_16x16x32_bf16 v[192:195], a[96:99], a[8:11], v[224:227]
    v_exp_f32 v203, v203
    v_mfma_f32_16x16x32_bf16 v[192:195], a[100:103], a[20:23], v[192:195]
    ds_read_b64_tr_b16 a[164:165], v249 offset:0
    ds_read_b64_tr_b16 a[166:167], v249 offset:4096
    v_mfma_f32_16x16x32_bf16 v[192:195], a[104:107], a[32:35], v[192:195]
    v_cvt_pk_bf16_f32 v212, v200, v201
    v_cvt_pk_bf16_f32 v213, v202, v203
    v_mfma_f32_16x16x32_bf16 v[192:195], a[108:111], a[44:47], v[192:195]
    ds_read_b64_tr_b16 a[168:169], v250 offset:0
    ds_read_b64_tr_b16 a[170:171], v250 offset:4096
    v_mfma_f32_16x16x32_bf16 v[196:199], a[112:115], a[8:11], v[224:227]
    v_exp_f32 v204, v204
    v_mfma_f32_16x16x32_bf16 v[196:199], a[116:119], a[20:23], v[196:199]
    ds_read_b64_tr_b16 a[172:173], v251 offset:0
    ds_read_b64_tr_b16 a[174:175], v251 offset:4096
    v_mfma_f32_16x16x32_bf16 v[196:199], a[120:123], a[32:35], v[196:199]
    v_exp_f32 v205, v205
    v_mfma_f32_16x16x32_bf16 v[196:199], a[124:127], a[44:47], v[196:199]
    s_waitcnt lgkmcnt(14)
    v_exp_f32 v206, v206
    v_mfma_f32_16x16x32_bf16 v[0:3], a[144:147], v[208:211], v[0:3]
    s_waitcnt lgkmcnt(12)
    v_exp_f32 v207, v207
    v_mfma_f32_16x16x32_bf16 v[4:7], a[148:151], v[208:211], v[4:7]
    s_waitcnt lgkmcnt(10)
    v_cvt_pk_bf16_f32 v214, v204, v205
    v_cvt_pk_bf16_f32 v215, v206, v207
    v_mfma_f32_16x16x32_bf16 v[8:11], a[152:155], v[208:211], v[8:11]
    s_waitcnt lgkmcnt(8)
    v_exp_f32 v192, v192
    v_mfma_f32_16x16x32_bf16 v[12:15], a[156:159], v[208:211], v[12:15]
    s_waitcnt lgkmcnt(6)
    v_exp_f32 v193, v193
    v_mfma_f32_16x16x32_bf16 v[16:19], a[160:163], v[208:211], v[16:19]
    s_waitcnt lgkmcnt(4)
    v_exp_f32 v194, v194
    v_mfma_f32_16x16x32_bf16 v[20:23], a[164:167], v[208:211], v[20:23]
    s_waitcnt lgkmcnt(2)
    v_exp_f32 v195, v195
    v_mfma_f32_16x16x32_bf16 v[24:27], a[168:171], v[208:211], v[24:27]
    s_waitcnt lgkmcnt(0)
    buffer_load_dwordx4 v253, s[8:11], s74 offen offset:1024 nt lds
    v_mfma_f32_16x16x32_bf16 v[28:31], a[172:175], v[208:211], v[28:31]
    v_mfma_f32_16x16x32_bf16 a[216:219], a[240:243], v[208:211], a[216:219]
    v_mfma_f32_16x16x32_bf16 v[200:203], a[96:99], a[48:51], v[228:231]
    v_cvt_pk_bf16_f32 v208, v192, v193
    v_cvt_pk_bf16_f32 v209, v194, v195
    v_mfma_f32_16x16x32_bf16 v[200:203], a[100:103], a[60:63], v[200:203]
    v_exp_f32 v196, v196
    v_mfma_f32_16x16x32_bf16 v[200:203], a[104:107], a[72:75], v[200:203]
    v_exp_f32 v197, v197
    v_mfma_f32_16x16x32_bf16 v[200:203], a[108:111], a[84:87], v[200:203]
    v_exp_f32 v198, v198
    v_mfma_f32_16x16x32_bf16 v[204:207], a[112:115], a[48:51], v[228:231]
    v_exp_f32 v199, v199
    v_mfma_f32_16x16x32_bf16 v[204:207], a[116:119], a[60:63], v[204:207]
    v_cvt_pk_bf16_f32 v210, v196, v197
    v_cvt_pk_bf16_f32 v211, v198, v199
    v_mfma_f32_16x16x32_bf16 v[204:207], a[120:123], a[72:75], v[204:207]
    v_mfma_f32_16x16x32_bf16 v[204:207], a[124:127], a[84:87], v[204:207]
    v_mfma_f32_16x16x32_bf16 v[32:35], a[144:147], v[212:215], v[32:35]
    v_exp_f32 v200, v200
    v_mfma_f32_16x16x32_bf16 v[36:39], a[148:151], v[212:215], v[36:39]
    v_exp_f32 v201, v201
    v_mfma_f32_16x16x32_bf16 v[40:43], a[152:155], v[212:215], v[40:43]
    v_exp_f32 v202, v202
    v_mfma_f32_16x16x32_bf16 v[44:47], a[156:159], v[212:215], v[44:47]
    v_exp_f32 v203, v203
    v_mfma_f32_16x16x32_bf16 v[48:51], a[160:163], v[212:215], v[48:51]
    v_mfma_f32_16x16x32_bf16 v[52:55], a[164:167], v[212:215], v[52:55]
    v_mfma_f32_16x16x32_bf16 v[56:59], a[168:171], v[212:215], v[56:59]
    buffer_load_dwordx4 v254, s[8:11], s74 offen offset:2048 nt lds
    v_mfma_f32_16x16x32_bf16 v[60:63], a[172:175], v[212:215], v[60:63]
    v_mfma_f32_16x16x32_bf16 a[220:223], a[240:243], v[212:215], a[220:223]
    v_mfma_f32_16x16x32_bf16 v[192:195], a[96:99], a[52:55], v[232:235]
    v_cvt_pk_bf16_f32 v212, v200, v201
    v_cvt_pk_bf16_f32 v213, v202, v203
    v_mfma_f32_16x16x32_bf16 v[192:195], a[100:103], a[64:67], v[192:195]
    v_exp_f32 v204, v204
    v_mfma_f32_16x16x32_bf16 v[192:195], a[104:107], a[76:79], v[192:195]
    v_exp_f32 v205, v205
    v_mfma_f32_16x16x32_bf16 v[192:195], a[108:111], a[88:91], v[192:195]
    v_exp_f32 v206, v206
    v_mfma_f32_16x16x32_bf16 v[196:199], a[112:115], a[52:55], v[232:235]
    v_exp_f32 v207, v207
    v_mfma_f32_16x16x32_bf16 v[196:199], a[116:119], a[64:67], v[196:199]
    v_cvt_pk_bf16_f32 v214, v204, v205
    v_cvt_pk_bf16_f32 v215, v206, v207
    v_mfma_f32_16x16x32_bf16 v[196:199], a[120:123], a[76:79], v[196:199]
    v_mfma_f32_16x16x32_bf16 v[196:199], a[124:127], a[88:91], v[196:199]
    v_mfma_f32_16x16x32_bf16 v[64:67], a[144:147], v[208:211], v[64:67]
    v_exp_f32 v192, v192
    v_mfma_f32_16x16x32_bf16 v[68:71], a[148:151], v[208:211], v[68:71]
    v_exp_f32 v193, v193
    v_mfma_f32_16x16x32_bf16 v[72:75], a[152:155], v[208:211], v[72:75]
    v_exp_f32 v194, v194
    v_mfma_f32_16x16x32_bf16 v[76:79], a[156:159], v[208:211], v[76:79]
    v_exp_f32 v195, v195
    v_mfma_f32_16x16x32_bf16 v[80:83], a[160:163], v[208:211], v[80:83]
    v_mfma_f32_16x16x32_bf16 v[84:87], a[164:167], v[208:211], v[84:87]
    buffer_load_dwordx4 v255, s[8:11], s74 offen offset:3072 nt lds
    v_mfma_f32_16x16x32_bf16 v[88:91], a[168:171], v[208:211], v[88:91]
    v_mfma_f32_16x16x32_bf16 v[92:95], a[172:175], v[208:211], v[92:95]
    s_waitcnt vmcnt(12)
    v_mfma_f32_16x16x32_bf16 a[224:227], a[240:243], v[208:211], a[224:227]
    s_barrier
    v_mfma_f32_16x16x32_bf16 v[200:203], a[96:99], a[56:59], v[236:239]
    ds_read_b128 a[96:99], v240 offset:8192
    v_cvt_pk_bf16_f32 v208, v192, v193
    v_mfma_f32_16x16x32_bf16 v[200:203], a[100:103], a[68:71], v[200:203]
    v_cvt_pk_bf16_f32 v209, v194, v195
    v_mfma_f32_16x16x32_bf16 v[200:203], a[104:107], a[80:83], v[200:203]
    ds_read_b128 a[100:103], v241 offset:8192
    v_mfma_f32_16x16x32_bf16 v[200:203], a[108:111], a[92:95], v[200:203]
    v_exp_f32 v196, v196
    v_mfma_f32_16x16x32_bf16 v[204:207], a[112:115], a[56:59], v[236:239]
    ds_read_b128 a[104:107], v242 offset:8192
    v_mfma_f32_16x16x32_bf16 v[204:207], a[116:119], a[68:71], v[204:207]
    v_exp_f32 v197, v197
    v_mfma_f32_16x16x32_bf16 v[204:207], a[120:123], a[80:83], v[204:207]
    ds_read_b128 a[108:111], v243 offset:8192
    v_mfma_f32_16x16x32_bf16 v[204:207], a[124:127], a[92:95], v[204:207]
    v_exp_f32 v198, v198
    v_mfma_f32_16x16x32_bf16 v[96:99], a[144:147], v[212:215], v[96:99]
    ds_read_b128 a[112:115], v240 offset:12288
    v_mfma_f32_16x16x32_bf16 v[100:103], a[148:151], v[212:215], v[100:103]
    s_add_u32 m0, s68, 106496
    v_exp_f32 v199, v199
    v_mfma_f32_16x16x32_bf16 v[104:107], a[152:155], v[212:215], v[104:107]
    s_xor_b32 s74, s38, 106496
    ds_read_b128 a[116:119], v241 offset:12288
    v_cvt_pk_bf16_f32 v210, v196, v197
    v_mfma_f32_16x16x32_bf16 v[108:111], a[156:159], v[212:215], v[108:111]
    v_cvt_pk_bf16_f32 v211, v198, v199
    v_mfma_f32_16x16x32_bf16 v[112:115], a[160:163], v[212:215], v[112:115]
    ds_read_b128 a[120:123], v242 offset:12288
    v_mfma_f32_16x16x32_bf16 v[116:119], a[164:167], v[212:215], v[116:119]
    buffer_load_dwordx4 v252, s[12:15], s74 offen offset:0 nt lds
    v_mfma_f32_16x16x32_bf16 v[120:123], a[168:171], v[212:215], v[120:123]
    ds_read_b128 a[124:127], v243 offset:12288
    v_mfma_f32_16x16x32_bf16 v[124:127], a[172:175], v[212:215], v[124:127]
    v_exp_f32 v200, v200
    v_mfma_f32_16x16x32_bf16 a[228:231], a[240:243], v[212:215], a[228:231]
    s_waitcnt lgkmcnt(7)
    v_exp_f32 v201, v201
    v_mfma_f32_16x16x32_bf16 v[192:195], a[96:99], a[0:3], v[216:219]
    s_waitcnt lgkmcnt(6)
    v_exp_f32 v202, v202
    v_mfma_f32_16x16x32_bf16 v[192:195], a[100:103], a[12:15], v[192:195]
    s_waitcnt lgkmcnt(5)
    v_exp_f32 v203, v203
    v_mfma_f32_16x16x32_bf16 v[192:195], a[104:107], a[24:27], v[192:195]
    s_waitcnt lgkmcnt(4)
    v_cvt_pk_bf16_f32 v212, v200, v201
    v_cvt_pk_bf16_f32 v213, v202, v203
    v_mfma_f32_16x16x32_bf16 v[192:195], a[108:111], a[36:39], v[192:195]
    s_waitcnt lgkmcnt(3)
    v_exp_f32 v204, v204
    v_mfma_f32_16x16x32_bf16 v[196:199], a[112:115], a[0:3], v[216:219]
    s_waitcnt lgkmcnt(2)
    v_exp_f32 v205, v205
    v_mfma_f32_16x16x32_bf16 v[196:199], a[116:119], a[12:15], v[196:199]
    s_waitcnt lgkmcnt(1)
    v_exp_f32 v206, v206
    v_mfma_f32_16x16x32_bf16 v[196:199], a[120:123], a[24:27], v[196:199]
    s_waitcnt lgkmcnt(0)
    v_exp_f32 v207, v207
    v_mfma_f32_16x16x32_bf16 v[196:199], a[124:127], a[36:39], v[196:199]
    v_cvt_pk_bf16_f32 v214, v204, v205
    v_cvt_pk_bf16_f32 v215, v206, v207
    v_mfma_f32_16x16x32_bf16 v[128:131], a[144:147], v[208:211], v[128:131]
    v_exp_f32 v192, v192
    v_mfma_f32_16x16x32_bf16 v[132:135], a[148:151], v[208:211], v[132:135]
    v_exp_f32 v193, v193
    v_mfma_f32_16x16x32_bf16 v[136:139], a[152:155], v[208:211], v[136:139]
    v_exp_f32 v194, v194
    v_mfma_f32_16x16x32_bf16 v[140:143], a[156:159], v[208:211], v[140:143]
    v_exp_f32 v195, v195
    v_mfma_f32_16x16x32_bf16 v[144:147], a[160:163], v[208:211], v[144:147]
    buffer_load_dwordx4 v253, s[12:15], s74 offen offset:1024 nt lds
    v_mfma_f32_16x16x32_bf16 v[148:151], a[164:167], v[208:211], v[148:151]
    v_mfma_f32_16x16x32_bf16 v[152:155], a[168:171], v[208:211], v[152:155]
    v_mfma_f32_16x16x32_bf16 v[156:159], a[172:175], v[208:211], v[156:159]
    v_mfma_f32_16x16x32_bf16 a[232:235], a[240:243], v[208:211], a[232:235]
    v_mfma_f32_16x16x32_bf16 v[200:203], a[96:99], a[4:7], v[220:223]
    v_cvt_pk_bf16_f32 v208, v192, v193
    v_cvt_pk_bf16_f32 v209, v194, v195
    v_mfma_f32_16x16x32_bf16 v[200:203], a[100:103], a[16:19], v[200:203]
    v_exp_f32 v196, v196
    v_mfma_f32_16x16x32_bf16 v[200:203], a[104:107], a[28:31], v[200:203]
    v_exp_f32 v197, v197
    v_mfma_f32_16x16x32_bf16 v[200:203], a[108:111], a[40:43], v[200:203]
    v_exp_f32 v198, v198
    v_mfma_f32_16x16x32_bf16 v[204:207], a[112:115], a[4:7], v[220:223]
    v_exp_f32 v199, v199
    v_mfma_f32_16x16x32_bf16 v[204:207], a[116:119], a[16:19], v[204:207]
    v_cvt_pk_bf16_f32 v210, v196, v197
    v_cvt_pk_bf16_f32 v211, v198, v199
    v_mfma_f32_16x16x32_bf16 v[204:207], a[120:123], a[28:31], v[204:207]
    v_mfma_f32_16x16x32_bf16 v[204:207], a[124:127], a[40:43], v[204:207]
    v_mfma_f32_16x16x32_bf16 v[160:163], a[144:147], v[212:215], v[160:163]
    ds_read_b64_tr_b16 a[144:145], v244 offset:8192
    ds_read_b64_tr_b16 a[146:147], v244 offset:12288
    v_mfma_f32_16x16x32_bf16 v[164:167], a[148:151], v[212:215], v[164:167]
    v_exp_f32 v200, v200
    v_mfma_f32_16x16x32_bf16 v[168:171], a[152:155], v[212:215], v[168:171]
    ds_read_b64_tr_b16 a[148:149], v245 offset:8192
    ds_read_b64_tr_b16 a[150:151], v245 offset:12288
    v_mfma_f32_16x16x32_bf16 v[172:175], a[156:159], v[212:215], v[172:175]
    v_exp_f32 v201, v201
    v_mfma_f32_16x16x32_bf16 v[176:179], a[160:163], v[212:215], v[176:179]
    ds_read_b64_tr_b16 a[152:153], v246 offset:8192
    ds_read_b64_tr_b16 a[154:155], v246 offset:12288
    v_mfma_f32_16x16x32_bf16 v[180:183], a[164:167], v[212:215], v[180:183]
    buffer_load_dwordx4 v254, s[12:15], s74 offen offset:2048 nt lds
    v_mfma_f32_16x16x32_bf16 v[184:187], a[168:171], v[212:215], v[184:187]
    ds_read_b64_tr_b16 a[156:157], v247 offset:8192
    ds_read_b64_tr_b16 a[158:159], v247 offset:12288
    v_mfma_f32_16x16x32_bf16 v[188:191], a[172:175], v[212:215], v[188:191]
    v_exp_f32 v202, v202
    v_mfma_f32_16x16x32_bf16 a[236:239], a[240:243], v[212:215], a[236:239]
    ds_read_b64_tr_b16 a[160:161], v248 offset:8192
    ds_read_b64_tr_b16 a[162:163], v248 offset:12288
    v_mfma_f32_16x16x32_bf16 v[192:195], a[96:99], a[8:11], v[224:227]
    v_exp_f32 v203, v203
    v_mfma_f32_16x16x32_bf16 v[192:195], a[100:103], a[20:23], v[192:195]
    ds_read_b64_tr_b16 a[164:165], v249 offset:8192
    ds_read_b64_tr_b16 a[166:167], v249 offset:12288
    v_mfma_f32_16x16x32_bf16 v[192:195], a[104:107], a[32:35], v[192:195]
    v_cvt_pk_bf16_f32 v212, v200, v201
    v_cvt_pk_bf16_f32 v213, v202, v203
    v_mfma_f32_16x16x32_bf16 v[192:195], a[108:111], a[44:47], v[192:195]
    ds_read_b64_tr_b16 a[168:169], v250 offset:8192
    ds_read_b64_tr_b16 a[170:171], v250 offset:12288
    v_mfma_f32_16x16x32_bf16 v[196:199], a[112:115], a[8:11], v[224:227]
    v_exp_f32 v204, v204
    v_mfma_f32_16x16x32_bf16 v[196:199], a[116:119], a[20:23], v[196:199]
    ds_read_b64_tr_b16 a[172:173], v251 offset:8192
    ds_read_b64_tr_b16 a[174:175], v251 offset:12288
    v_mfma_f32_16x16x32_bf16 v[196:199], a[120:123], a[32:35], v[196:199]
    v_exp_f32 v205, v205
    v_mfma_f32_16x16x32_bf16 v[196:199], a[124:127], a[44:47], v[196:199]
    s_waitcnt lgkmcnt(14)
    v_exp_f32 v206, v206
    v_mfma_f32_16x16x32_bf16 v[0:3], a[144:147], v[208:211], v[0:3]
    s_waitcnt lgkmcnt(12)
    v_exp_f32 v207, v207
    v_mfma_f32_16x16x32_bf16 v[4:7], a[148:151], v[208:211], v[4:7]
    s_waitcnt lgkmcnt(10)
    v_cvt_pk_bf16_f32 v214, v204, v205
    v_cvt_pk_bf16_f32 v215, v206, v207
    v_mfma_f32_16x16x32_bf16 v[8:11], a[152:155], v[208:211], v[8:11]
    s_waitcnt lgkmcnt(8)
    v_exp_f32 v192, v192
    v_mfma_f32_16x16x32_bf16 v[12:15], a[156:159], v[208:211], v[12:15]
    s_waitcnt lgkmcnt(6)
    buffer_load_dwordx4 v255, s[12:15], s74 offen offset:3072 nt lds
    v_mfma_f32_16x16x32_bf16 v[16:19], a[160:163], v[208:211], v[16:19]
    s_waitcnt lgkmcnt(4)
    v_exp_f32 v193, v193
    v_mfma_f32_16x16x32_bf16 v[20:23], a[164:167], v[208:211], v[20:23]
    s_waitcnt lgkmcnt(2)
    v_exp_f32 v194, v194
    v_mfma_f32_16x16x32_bf16 v[24:27], a[168:171], v[208:211], v[24:27]
    s_waitcnt lgkmcnt(0)
    v_exp_f32 v195, v195
    v_mfma_f32_16x16x32_bf16 v[28:31], a[172:175], v[208:211], v[28:31]
    v_mfma_f32_16x16x32_bf16 a[216:219], a[240:243], v[208:211], a[216:219]
    v_mfma_f32_16x16x32_bf16 v[200:203], a[96:99], a[48:51], v[228:231]
    v_cvt_pk_bf16_f32 v208, v192, v193
    v_cvt_pk_bf16_f32 v209, v194, v195
    v_mfma_f32_16x16x32_bf16 v[200:203], a[100:103], a[60:63], v[200:203]
    v_exp_f32 v196, v196
    v_mfma_f32_16x16x32_bf16 v[200:203], a[104:107], a[72:75], v[200:203]
    v_exp_f32 v197, v197
    v_mfma_f32_16x16x32_bf16 v[200:203], a[108:111], a[84:87], v[200:203]
    v_exp_f32 v198, v198
    v_mfma_f32_16x16x32_bf16 v[204:207], a[112:115], a[48:51], v[228:231]
    v_exp_f32 v199, v199
    v_mfma_f32_16x16x32_bf16 v[204:207], a[116:119], a[60:63], v[204:207]
    v_cvt_pk_bf16_f32 v210, v196, v197
    v_cvt_pk_bf16_f32 v211, v198, v199
    v_mfma_f32_16x16x32_bf16 v[204:207], a[120:123], a[72:75], v[204:207]
    v_mfma_f32_16x16x32_bf16 v[204:207], a[124:127], a[84:87], v[204:207]
    s_add_u32 m0, s68, 32768
    v_mfma_f32_16x16x32_bf16 v[32:35], a[144:147], v[212:215], v[32:35]
    s_xor_b32 s74, s38, 114688
    v_exp_f32 v200, v200
    v_mfma_f32_16x16x32_bf16 v[36:39], a[148:151], v[212:215], v[36:39]
L_hopa_8:
    s_cbranch_execz L_backa
    v_exp_f32 v201, v201
    v_mfma_f32_16x16x32_bf16 v[40:43], a[152:155], v[212:215], v[40:43]
    v_exp_f32 v202, v202
    v_mfma_f32_16x16x32_bf16 v[44:47], a[156:159], v[212:215], v[44:47]
    buffer_load_dwordx4 v252, s[8:11], s74 offen offset:0 nt lds
    v_mfma_f32_16x16x32_bf16 v[48:51], a[160:163], v[212:215], v[48:51]
    v_exp_f32 v203, v203
    v_mfma_f32_16x16x32_bf16 v[52:55], a[164:167], v[212:215], v[52:55]
    v_mfma_f32_16x16x32_bf16 v[56:59], a[168:171], v[212:215], v[56:59]
    v_mfma_f32_16x16x32_bf16 v[60:63], a[172:175], v[212:215], v[60:63]
    v_mfma_f32_16x16x32_bf16 a[220:223], a[240:243], v[212:215], a[220:223]
    v_mfma_f32_16x16x32_bf16 v[192:195], a[96:99], a[52:55], v[232:235]
    v_cvt_pk_bf16_f32 v212, v200, v201
    v_cvt_pk_bf16_f32 v213, v202, v203
    v_mfma_f32_16x16x32_bf16 v[192:195], a[100:103], a[64:67], v[192:195]
    v_exp_f32 v204, v204
    v_mfma_f32_16x16x32_bf16 v[192:195], a[104:107], a[76:79], v[192:195]
    v_exp_f32 v205, v205
    v_mfma_f32_16x16x32_bf16 v[192:195], a[108:111], a[88:91], v[192:195]
    v_exp_f32 v206, v206
    v_mfma_f32_16x16x32_bf16 v[196:199], a[112:115], a[52:55], v[232:235]
    v_exp_f32 v207, v207
    v_mfma_f32_16x16x32_bf16 v[196:199], a[116:119], a[64:67], v[196:199]
    v_cvt_pk_bf16_f32 v214, v204, v205
    v_cvt_pk_bf16_f32 v215, v206, v207
    v_mfma_f32_16x16x32_bf16 v[196:199], a[120:123], a[76:79], v[196:199]
    v_mfma_f32_16x16x32_bf16 v[196:199], a[124:127], a[88:91], v[196:199]
    v_mfma_f32_16x16x32_bf16 v[64:67], a[144:147], v[208:211], v[64:67]
    v_exp_f32 v192, v192
    v_mfma_f32_16x16x32_bf16 v[68:71], a[148:151], v[208:211], v[68:71]
    v_exp_f32 v193, v193
    v_mfma_f32_16x16x32_bf16 v[72:75], a[152:155], v[208:211], v[72:75]
    buffer_load_dwordx4 v253, s[8:11], s74 offen offset:1024 nt lds
    v_mfma_f32_16x16x32_bf16 v[76:79], a[156:159], v[208:211], v[76:79]
    v_exp_f32 v194, v194
    v_mfma_f32_16x16x32_bf16 v[80:83], a[160:163], v[208:211], v[80:83]
    v_exp_f32 v195, v195
    v_mfma_f32_16x16x32_bf16 v[84:87], a[164:167], v[208:211], v[84:87]
    v_mfma_f32_16x16x32_bf16 v[88:91], a[168:171], v[208:211], v[88:91]
    v_mfma_f32_16x16x32_bf16 v[92:95], a[172:175], v[208:211], v[92:95]
    s_waitcnt vmcnt(14)
    v_mfma_f32_16x16x32_bf16 a[224:227], a[240:243], v[208:211], a[224:227]
    s_barrier
    v_mfma_f32_16x16x32_bf16 v[200:203], a[96:99], a[56:59], v[236:239]
    ds_read_b128 a[96:99], v240 offset:16384
    v_cvt_pk_bf16_f32 v208, v192, v193
    v_mfma_f32_16x16x32_bf16 v[200:203], a[100:103], a[68:71], v[200:203]
    v_cvt_pk_bf16_f32 v209, v194, v195
    v_mfma_f32_16x16x32_bf16 v[200:203], a[104:107], a[80:83], v[200:203]
    ds_read_b128 a[100:103], v241 offset:16384
    v_mfma_f32_16x16x32_bf16 v[200:203], a[108:111], a[92:95], v[200:203]
    v_exp_f32 v196, v196
    v_mfma_f32_16x16x32_bf16 v[204:207], a[112:115], a[56:59], v[236:239]
    ds_read_b128 a[104:107], v242 offset:16384
    v_mfma_f32_16x16x32_bf16 v[204:207], a[116:119], a[68:71], v[204:207]
    v_exp_f32 v197, v197
    v_mfma_f32_16x16x32_bf16 v[204:207], a[120:123], a[80:83], v[204:207]
    ds_read_b128 a[108:111], v243 offset:16384
    v_mfma_f32_16x16x32_bf16 v[204:207], a[124:127], a[92:95], v[204:207]
    v_exp_f32 v198, v198
    v_mfma_f32_16x16x32_bf16 v[96:99], a[144:147], v[212:215], v[96:99]
    ds_read_b128 a[112:115], v240 offset:20480
    v_mfma_f32_16x16x32_bf16 v[100:103], a[148:151], v[212:215], v[100:103]
    v_exp_f32 v199, v199
    v_mfma_f32_16x16x32_bf16 v[104:107], a[152:155], v[212:215], v[104:107]
    ds_read_b128 a[116:119], v241 offset:20480
    v_cvt_pk_bf16_f32 v210, v196, v197
    v_mfma_f32_16x16x32_bf16 v[108:111], a[156:159], v[212:215], v[108:111]
    buffer_load_dwordx4 v254, s[8:11], s74 offen offset:2048 nt lds
    v_mfma_f32_16x16x32_bf16 v[112:115], a[160:163], v[212:215], v[112:115]
    ds_read_b128 a[120:123], v242 offset:20480
    v_cvt_pk_bf16_f32 v211, v198, v199
    v_mfma_f32_16x16x32_bf16 v[116:119], a[164:167], v[212:215], v[116:119]
    v_exp_f32 v200, v200
    v_mfma_f32_16x16x32_bf16 v[120:123], a[168:171], v[212:215], v[120:123]
    ds_read_b128 a[124:127], v243 offset:20480
    v_mfma_f32_16x16x32_bf16 v[124:127], a[172:175], v[212:215], v[124:127]
    v_exp_f32 v201, v201
    v_mfma_f32_16x16x32_bf16 a[228:231], a[240:243], v[212:215], a[228:231]
    s_waitcnt lgkmcnt(7)
    v_exp_f32 v202, v202
    v_mfma_f32_16x16x32_bf16 v[192:195], a[96:99], a[0:3], v[216:219]
    s_waitcnt lgkmcnt(6)
    v_exp_f32 v203, v203
    v_mfma_f32_16x16x32_bf16 v[192:195], a[100:103], a[12:15], v[192:195]
    s_waitcnt lgkmcnt(5)
    v_cvt_pk_bf16_f32 v212, v200, v201
    v_cvt_pk_bf16_f32 v213, v202, v203
    v_mfma_f32_16x16x32_bf16 v[192:195], a[104:107], a[24:27], v[192:195]
    s_waitcnt lgkmcnt(4)
    v_exp_f32 v204, v204
    v_mfma_f32_16x16x32_bf16 v[192:195], a[108:111], a[36:39], v[192:195]
    s_waitcnt lgkmcnt(3)
    v_exp_f32 v205, v205
    v_mfma_f32_16x16x32_bf16 v[196:199], a[112:115], a[0:3], v[216:219]
    s_waitcnt lgkmcnt(2)
    v_exp_f32 v206, v206
    v_mfma_f32_16x16x32_bf16 v[196:199], a[116:119], a[12:15], v[196:199]
    s_waitcnt lgkmcnt(1)
    v_exp_f32 v207, v207
    v_mfma_f32_16x16x32_bf16 v[196:199], a[120:123], a[24:27], v[196:199]
    s_waitcnt lgkmcnt(0)
    v_cvt_pk_bf16_f32 v214, v204, v205
    v_cvt_pk_bf16_f32 v215, v206, v207
    v_mfma_f32_16x16x32_bf16 v[196:199], a[124:127], a[36:39], v[196:199]
    v_mfma_f32_16x16x32_bf16 v[128:131], a[144:147], v[208:211], v[128:131]
    v_exp_f32 v192, v192
    v_mfma_f32_16x16x32_bf16 v[132:135], a[148:151], v[208:211], v[132:135]
    buffer_load_dwordx4 v255, s[8:11], s74 offen offset:3072 nt lds
    v_mfma_f32_16x16x32_bf16 v[136:139], a[152:155], v[208:211], v[136:139]
    v_exp_f32 v193, v193
    v_mfma_f32_16x16x32_bf16 v[140:143], a[156:159], v[208:211], v[140:143]
    v_exp_f32 v194, v194
    v_mfma_f32_16x16x32_bf16 v[144:147], a[160:163], v[208:211], v[144:147]
    v_exp_f32 v195, v195
    v_mfma_f32_16x16x32_bf16 v[148:151], a[164:167], v[208:211], v[148:151]
    v_mfma_f32_16x16x32_bf16 v[152:155], a[168:171], v[208:211], v[152:155]
    v_mfma_f32_16x16x32_bf16 v[156:159], a[172:175], v[208:211], v[156:159]
    v_mfma_f32_16x16x32_bf16 a[232:235], a[240:243], v[208:211], a[232:235]
    v_mfma_f32_16x16x32_bf16 v[200:203], a[96:99], a[4:7], v[220:223]
    v_cvt_pk_bf16_f32 v208, v192, v193
    v_cvt_pk_bf16_f32 v209, v194, v195
    v_mfma_f32_16x16x32_bf16 v[200:203], a[100:103], a[16:19], v[200:203]
    v_exp_f32 v196, v196
    v_mfma_f32_16x16x32_bf16 v[200:203], a[104:107], a[28:31], v[200:203]
    v_exp_f32 v197, v197
    v_mfma_f32_16x16x32_bf16 v[200:203], a[108:111], a[40:43], v[200:203]
    v_exp_f32 v198, v198
    v_mfma_f32_16x16x32_bf16 v[204:207], a[112:115], a[4:7], v[220:223]
    v_exp_f32 v199, v199
    v_mfma_f32_16x16x32_bf16 v[204:207], a[116:119], a[16:19], v[204:207]
    s_add_u32 m0, s68, 114688
    v_cvt_pk_bf16_f32 v210, v196, v197
    v_cvt_pk_bf16_f32 v211, v198, v199
    v_mfma_f32_16x16x32_bf16 v[204:207], a[120:123], a[28:31], v[204:207]
    s_waitcnt vmcnt(12)
    v_mfma_f32_16x16x32_bf16 v[204:207], a[124:127], a[40:43], v[204:207]
    s_barrier
    v_mfma_f32_16x16x32_bf16 v[160:163], a[144:147], v[212:215], v[160:163]
    s_xor_b32 s74, s38, 114688
    ds_read_b64_tr_b16 a[144:145], v244 offset:16384
    ds_read_b64_tr_b16 a[146:147], v244 offset:20480
    v_mfma_f32_16x16x32_bf16 v[164:167], a[148:151], v[212:215], v[164:167]
    buffer_load_dwordx4 v252, s[12:15], s74 offen offset:0 nt lds
    v_mfma_f32_16x16x32_bf16 v[168:171], a[152:155], v[212:215], v[168:171]
    ds_read_b64_tr_b16 a[148:149], v245 offset:16384
    ds_read_b64_tr_b16 a[150:151], v245 offset:20480
    v_mfma_f32_16x16x32_bf16 v[172:175], a[156:159], v[212:215], v[172:175]
    v_exp_f32 v200, v200
    v_mfma_f32_16x16x32_bf16 v[176:179], a[160:163], v[212:215], v[176:179]
    ds_read_b64_tr_b16 a[152:153], v246 offset:16384
    ds_read_b64_tr_b16 a[154:155], v246 offset:20480
    v_mfma_f32_16x16x32_bf16 v[180:183], a[164:167], v[212:215], v[180:183]
    v_exp_f32 v201, v201
    v_mfma_f32_16x16x32_bf16 v[184:187], a[168:171], v[212:215], v[184:187]
    ds_read_b64_tr_b16 a[156:157], v247 offset:16384
    ds_read_b64_tr_b16 a[158:159], v247 offset:20480
    v_mfma_f32_16x16x32_bf16 v[188:191], a[172:175], v[212:215], v[188:191]
    v_exp_f32 v202, v202
    v_mfma_f32_16x16x32_bf16 a[236:239], a[240:243], v[212:215], a[236:239]
    ds_read_b64_tr_b16 a[160:161], v248 offset:16384
    ds_read_b64_tr_b16 a[162:163], v248 offset:20480
    v_mfma_f32_16x16x32_bf16 v[192:195], a[96:99], a[8:11], v[224:227]
    v_exp_f32 v203, v203
    v_mfma_f32_16x16x32_bf16 v[192:195], a[100:103], a[20:23], v[192:195]
    ds_read_b64_tr_b16 a[164:165], v249 offset:16384
    ds_read_b64_tr_b16 a[166:167], v249 offset:20480
    v_mfma_f32_16x16x32_bf16 v[192:195], a[104:107], a[32:35], v[192:195]
    v_cvt_pk_bf16_f32 v212, v200, v201
    v_cvt_pk_bf16_f32 v213, v202, v203
    v_mfma_f32_16x16x32_bf16 v[192:195], a[108:111], a[44:47], v[192:195]
    ds_read_b64_tr_b16 a[168:169], v250 offset:16384
    ds_read_b64_tr_b16 a[170:171], v250 offset:20480
    v_mfma_f32_16x16x32_bf16 v[196:199], a[112:115], a[8:11], v[224:227]
    v_exp_f32 v204, v204
    v_mfma_f32_16x16x32_bf16 v[196:199], a[116:119], a[20:23], v[196:199]
    ds_read_b64_tr_b16 a[172:173], v251 offset:16384
    ds_read_b64_tr_b16 a[174:175], v251 offset:20480
    v_mfma_f32_16x16x32_bf16 v[196:199], a[120:123], a[32:35], v[196:199]
    v_exp_f32 v205, v205
    v_mfma_f32_16x16x32_bf16 v[196:199], a[124:127], a[44:47], v[196:199]
    s_waitcnt lgkmcnt(14)
    v_exp_f32 v206, v206
    v_mfma_f32_16x16x32_bf16 v[0:3], a[144:147], v[208:211], v[0:3]
    s_waitcnt lgkmcnt(12)
    buffer_load_dwordx4 v253, s[12:15], s74 offen offset:1024 nt lds
    v_mfma_f32_16x16x32_bf16 v[4:7], a[148:151], v[208:211], v[4:7]
    s_waitcnt lgkmcnt(10)
    v_exp_f32 v207, v207
    v_mfma_f32_16x16x32_bf16 v[8:11], a[152:155], v[208:211], v[8:11]
    s_waitcnt lgkmcnt(8)
    v_cvt_pk_bf16_f32 v214, v204, v205
    v_cvt_pk_bf16_f32 v215, v206, v207
    v_mfma_f32_16x16x32_bf16 v[12:15], a[156:159], v[208:211], v[12:15]
    s_waitcnt lgkmcnt(6)
    v_exp_f32 v192, v192
    v_mfma_f32_16x16x32_bf16 v[16:19], a[160:163], v[208:211], v[16:19]
    s_waitcnt lgkmcnt(4)
    v_exp_f32 v193, v193
    v_mfma_f32_16x16x32_bf16 v[20:23], a[164:167], v[208:211], v[20:23]
    s_waitcnt lgkmcnt(2)
    v_exp_f32 v194, v194
    v_mfma_f32_16x16x32_bf16 v[24:27], a[168:171], v[208:211], v[24:27]
    s_waitcnt lgkmcnt(0)
    v_exp_f32 v195, v195
    v_mfma_f32_16x16x32_bf16 v[28:31], a[172:175], v[208:211], v[28:31]
    v_mfma_f32_16x16x32_bf16 a[216:219], a[240:243], v[208:211], a[216:219]
    v_mfma_f32_16x16x32_bf16 v[200:203], a[96:99], a[48:51], v[228:231]
    v_cvt_pk_bf16_f32 v208, v192, v193
    v_cvt_pk_bf16_f32 v209, v194, v195
    v_mfma_f32_16x16x32_bf16 v[200:203], a[100:103], a[60:63], v[200:203]
    v_exp_f32 v196, v196
    v_mfma_f32_16x16x32_bf16 v[200:203], a[104:107], a[72:75], v[200:203]
    v_exp_f32 v197, v197
    v_mfma_f32_16x16x32_bf16 v[200:203], a[108:111], a[84:87], v[200:203]
    v_exp_f32 v198, v198
    v_mfma_f32_16x16x32_bf16 v[204:207], a[112:115], a[48:51], v[228:231]
    v_exp_f32 v199, v199
    v_mfma_f32_16x16x32_bf16 v[204:207], a[116:119], a[60:63], v[204:207]
    v_cvt_pk_bf16_f32 v210, v196, v197
    v_cvt_pk_bf16_f32 v211, v198, v199
    v_mfma_f32_16x16x32_bf16 v[204:207], a[120:123], a[72:75], v[204:207]
    v_mfma_f32_16x16x32_bf16 v[204:207], a[124:127], a[84:87], v[204:207]
    v_mfma_f32_16x16x32_bf16 v[32:35], a[144:147], v[212:215], v[32:35]
    buffer_load_dwordx4 v254, s[12:15], s74 offen offset:2048 nt lds
    v_mfma_f32_16x16x32_bf16 v[36:39], a[148:151], v[212:215], v[36:39]
    v_exp_f32 v200, v200
    v_mfma_f32_16x16x32_bf16 v[40:43], a[152:155], v[212:215], v[40:43]
    v_exp_f32 v201, v201
    v_mfma_f32_16x16x32_bf16 v[44:47], a[156:159], v[212:215], v[44:47]
    v_exp_f32 v202, v202
    v_mfma_f32_16x16x32_bf16 v[48:51], a[160:163], v[212:215], v[48:51]
    v_exp_f32 v203, v203
    v_mfma_f32_16x16x32_bf16 v[52:55], a[164:167], v[212:215], v[52:55]
    v_mfma_f32_16x16x32_bf16 v[56:59], a[168:171], v[212:215], v[56:59]
    v_mfma_f32_16x16x32_bf16 v[60:63], a[172:175], v[212:215], v[60:63]
    v_mfma_f32_16x16x32_bf16 a[220:223], a[240:243], v[212:215], a[220:223]
    v_mfma_f32_16x16x32_bf16 v[192:195], a[96:99], a[52:55], v[232:235]
    v_cvt_pk_bf16_f32 v212, v200, v201
    v_cvt_pk_bf16_f32 v213, v202, v203
    v_mfma_f32_16x16x32_bf16 v[192:195], a[100:103], a[64:67], v[192:195]
    v_exp_f32 v204, v204
    v_mfma_f32_16x16x32_bf16 v[192:195], a[104:107], a[76:79], v[192:195]
    v_exp_f32 v205, v205
    v_mfma_f32_16x16x32_bf16 v[192:195], a[108:111], a[88:91], v[192:195]
    v_exp_f32 v206, v206
    v_mfma_f32_16x16x32_bf16 v[196:199], a[112:115], a[52:55], v[232:235]
    v_exp_f32 v207, v207
    v_mfma_f32_16x16x32_bf16 v[196:199], a[116:119], a[64:67], v[196:199]
    v_cvt_pk_bf16_f32 v214, v204, v205
    v_cvt_pk_bf16_f32 v215, v206, v207
    v_mfma_f32_16x16x32_bf16 v[196:199], a[120:123], a[76:79], v[196:199]
    v_mfma_f32_16x16x32_bf16 v[196:199], a[124:127], a[88:91], v[196:199]
    buffer_load_dwordx4 v255, s[12:15], s74 offen offset:3072 nt lds
    v_mfma_f32_16x16x32_bf16 v[64:67], a[144:147], v[208:211], v[64:67]
    v_exp_f32 v192, v192
    v_mfma_f32_16x16x32_bf16 v[68:71], a[148:151], v[208:211], v[68:71]
    v_exp_f32 v193, v193
    v_mfma_f32_16x16x32_bf16 v[72:75], a[152:155], v[208:211], v[72:75]
    v_exp_f32 v194, v194
    v_mfma_f32_16x16x32_bf16 v[76:79], a[156:159], v[208:211], v[76:79]
    v_exp_f32 v195, v195
    v_mfma_f32_16x16x32_bf16 v[80:83], a[160:163], v[208:211], v[80:83]
    v_mfma_f32_16x16x32_bf16 v[84:87], a[164:167], v[208:211], v[84:87]
    v_mfma_f32_16x16x32_bf16 v[88:91], a[168:171], v[208:211], v[88:91]
    v_mfma_f32_16x16x32_bf16 v[92:95], a[172:175], v[208:211], v[92:95]
    s_waitcnt vmcnt(12)
    v_mfma_f32_16x16x32_bf16 a[224:227], a[240:243], v[208:211], a[224:227]
    s_barrier
    v_mfma_f32_16x16x32_bf16 v[200:203], a[96:99], a[56:59], v[236:239]
    ds_read_b128 a[96:99], v240 offset:24576
    v_cvt_pk_bf16_f32 v208, v192, v193
    v_mfma_f32_16x16x32_bf16 v[200:203], a[100:103], a[68:71], v[200:203]
    v_cvt_pk_bf16_f32 v209, v194, v195
    v_mfma_f32_16x16x32_bf16 v[200:203], a[104:107], a[80:83], v[200:203]
    ds_read_b128 a[100:103], v241 offset:24576
    v_mfma_f32_16x16x32_bf16 v[200:203], a[108:111], a[92:95], v[200:203]
    s_add_u32 m0, s68, 0
    v_exp_f32 v196, v196
    v_mfma_f32_16x16x32_bf16 v[204:207], a[112:115], a[56:59], v[236:239]
    s_xor_b32 s74, s38, 122880
    ds_read_b128 a[104:107], v242 offset:24576
    v_mfma_f32_16x16x32_bf16 v[204:207], a[116:119], a[68:71], v[204:207]
    v_exp_f32 v197, v197
    v_mfma_f32_16x16x32_bf16 v[204:207], a[120:123], a[80:83], v[204:207]
    ds_read_b128 a[108:111], v243 offset:24576
    v_mfma_f32_16x16x32_bf16 v[204:207], a[124:127], a[92:95], v[204:207]
    buffer_load_dwordx4 v252, s[8:11], s74 offen offset:0 nt lds
    v_mfma_f32_16x16x32_bf16 v[96:99], a[144:147], v[212:215], v[96:99]
    ds_read_b128 a[112:115], v240 offset:28672
    v_mfma_f32_16x16x32_bf16 v[100:103], a[148:151], v[212:215], v[100:103]
    v_exp_f32 v198, v198
    v_mfma_f32_16x16x32_bf16 v[104:107], a[152:155], v[212:215], v[104:107]
    ds_read_b128 a[116:119], v241 offset:28672
    v_mfma_f32_16x16x32_bf16 v[108:111], a[156:159], v[212:215], v[108:111]
    v_exp_f32 v199, v199
    v_mfma_f32_16x16x32_bf16 v[112:115], a[160:163], v[212:215], v[112:115]
    ds_read_b128 a[120:123], v242 offset:28672
    v_cvt_pk_bf16_f32 v210, v196, v197
    v_mfma_f32_16x16x32_bf16 v[116:119], a[164:167], v[212:215], v[116:119]
    v_cvt_pk_bf16_f32 v211, v198, v199
    v_mfma_f32_16x16x32_bf16 v[120:123], a[168:171], v[212:215], v[120:123]
    ds_read_b128 a[124:127], v243 offset:28672
    v_mfma_f32_16x16x32_bf16 v[124:127], a[172:175], v[212:215], v[124:127]
    v_exp_f32 v200, v200
    v_mfma_f32_16x16x32_bf16 a[228:231], a[240:243], v[212:215], a[228:231]
    s_waitcnt lgkmcnt(7)
    v_exp_f32 v201, v201
    v_mfma_f32_16x16x32_bf16 v[192:195], a[96:99], a[0:3], v[216:219]
    s_waitcnt lgkmcnt(6)
    v_exp_f32 v202, v202
    v_mfma_f32_16x16x32_bf16 v[192:195], a[100:103], a[12:15], v[192:195]
    s_waitcnt lgkmcnt(5)
    v_exp_f32 v203, v203
    v_mfma_f32_16x16x32_bf16 v[192:195], a[104:107], a[24:27], v[192:195]
    s_waitcnt lgkmcnt(4)
    v_cvt_pk_bf16_f32 v212, v200, v201
    v_cvt_pk_bf16_f32 v213, v202, v203
    v_mfma_f32_16x16x32_bf16 v[192:195], a[108:111], a[36:39], v[192:195]
    s_waitcnt lgkmcnt(3)
    v_exp_f32 v204, v204
    v_mfma_f32_16x16x32_bf16 v[196:199], a[112:115], a[0:3], v[216:219]
    s_waitcnt lgkmcnt(2)
    v_exp_f32 v205, v205
    v_mfma_f32_16x16x32_bf16 v[196:199], a[116:119], a[12:15], v[196:199]
    s_waitcnt lgkmcnt(1)
    v_exp_f32 v206, v206
    v_mfma_f32_16x16x32_bf16 v[196:199], a[120:123], a[24:27], v[196:199]
    s_waitcnt lgkmcnt(0)
    buffer_load_dwordx4 v253, s[8:11], s74 offen offset:1024 nt lds
    v_mfma_f32_16x16x32_bf16 v[196:199], a[124:127], a[36:39], v[196:199]
    v_exp_f32 v207, v207
    v_mfma_f32_16x16x32_bf16 v[128:131], a[144:147], v[208:211], v[128:131]
    v_cvt_pk_bf16_f32 v214, v204, v205
    v_cvt_pk_bf16_f32 v215, v206, v207
    v_mfma_f32_16x16x32_bf16 v[132:135], a[148:151], v[208:211], v[132:135]
    v_exp_f32 v192, v192
    v_mfma_f32_16x16x32_bf16 v[136:139], a[152:155], v[208:211], v[136:139]
    v_exp_f32 v193, v193
    v_mfma_f32_16x16x32_bf16 v[140:143], a[156:159], v[208:211], v[140:143]
    v_exp_f32 v194, v194
    v_mfma_f32_16x16x32_bf16 v[144:147], a[160:163], v[208:211], v[144:147]
    v_exp_f32 v195, v195
    v_mfma_f32_16x16x32_bf16 v[148:151], a[164:167], v[208:211], v[148:151]
    v_mfma_f32_16x16x32_bf16 v[152:155], a[168:171], v[208:211], v[152:155]
    v_mfma_f32_16x16x32_bf16 v[156:159], a[172:175], v[208:211], v[156:159]
    v_mfma_f32_16x16x32_bf16 a[232:235], a[240:243], v[208:211], a[232:235]
    v_mfma_f32_16x16x32_bf16 v[200:203], a[96:99], a[4:7], v[220:223]
    v_cvt_pk_bf16_f32 v208, v192, v193
    v_cvt_pk_bf16_f32 v209, v194, v195
    v_mfma_f32_16x16x32_bf16 v[200:203], a[100:103], a[16:19], v[200:203]
    v_exp_f32 v196, v196
    v_mfma_f32_16x16x32_bf16 v[200:203], a[104:107], a[28:31], v[200:203]
    v_exp_f32 v197, v197
    v_mfma_f32_16x16x32_bf16 v[200:203], a[108:111], a[40:43], v[200:203]
    v_exp_f32 v198, v198
    v_mfma_f32_16x16x32_bf16 v[204:207], a[112:115], a[4:7], v[220:223]
    v_exp_f32 v199, v199
    v_mfma_f32_16x16x32_bf16 v[204:207], a[116:119], a[16:19], v[204:207]
    v_cvt_pk_bf16_f32 v210, v196, v197
    v_cvt_pk_bf16_f32 v211, v198, v199
    v_mfma_f32_16x16x32_bf16 v[204:207], a[120:123], a[28:31], v[204:207]
    s_waitcnt vmcnt(10)
    buffer_load_dwordx4 v254, s[8:11], s74 offen offset:2048 nt lds
    v_mfma_f32_16x16x32_bf16 v[204:207], a[124:127], a[40:43], v[204:207]
    s_barrier
    v_mfma_f32_16x16x32_bf16 v[160:163], a[144:147], v[212:215], v[160:163]
    ds_read_b64_tr_b16 a[144:145], v244 offset:24576
    ds_read_b64_tr_b16 a[146:147], v244 offset:28672
    v_mfma_f32_16x16x32_bf16 v[164:167], a[148:151], v[212:215], v[164:167]
    v_exp_f32 v200, v200
    v_mfma_f32_16x16x32_bf16 v[168:171], a[152:155], v[212:215], v[168:171]
    ds_read_b64_tr_b16 a[148:149], v245 offset:24576
    ds_read_b64_tr_b16 a[150:151], v245 offset:28672
    v_mfma_f32_16x16x32_bf16 v[172:175], a[156:159], v[212:215], v[172:175]
    v_exp_f32 v201, v201
    v_mfma_f32_16x16x32_bf16 v[176:179], a[160:163], v[212:215], v[176:179]
    ds_read_b64_tr_b16 a[152:153], v246 offset:24576
    ds_read_b64_tr_b16 a[154:155], v246 offset:28672
    v_mfma_f32_16x16x32_bf16 v[180:183], a[164:167], v[212:215], v[180:183]
    v_exp_f32 v202, v202
    v_mfma_f32_16x16x32_bf16 v[184:187], a[168:171], v[212:215], v[184:187]
    ds_read_b64_tr_b16 a[156:157], v247 offset:24576
    ds_read_b64_tr_b16 a[158:159], v247 offset:28672
    v_mfma_f32_16x16x32_bf16 v[188:191], a[172:175], v[212:215], v[188:191]
    v_exp_f32 v203, v203
    v_mfma_f32_16x16x32_bf16 a[236:239], a[240:243], v[212:215], a[236:239]
    ds_read_b64_tr_b16 a[160:161], v248 offset:24576
    ds_read_b64_tr_b16 a[162:163], v248 offset:28672
    v_mfma_f32_16x16x32_bf16 v[192:195], a[96:99], a[8:11], v[224:227]
    v_cvt_pk_bf16_f32 v212, v200, v201
    v_cvt_pk_bf16_f32 v213, v202, v203
    v_mfma_f32_16x16x32_bf16 v[192:195], a[100:103], a[20:23], v[192:195]
    ds_read_b64_tr_b16 a[164:165], v249 offset:24576
    ds_read_b64_tr_b16 a[166:167], v249 offset:28672
    v_mfma_f32_16x16x32_bf16 v[192:195], a[104:107], a[32:35], v[192:195]
    v_exp_f32 v204, v204
    v_mfma_f32_16x16x32_bf16 v[192:195], a[108:111], a[44:47], v[192:195]
    ds_read_b64_tr_b16 a[168:169], v250 offset:24576
    ds_read_b64_tr_b16 a[170:171], v250 offset:28672
    v_mfma_f32_16x16x32_bf16 v[196:199], a[112:115], a[8:11], v[224:227]
    v_exp_f32 v205, v205
    v_mfma_f32_16x16x32_bf16 v[196:199], a[116:119], a[20:23], v[196:199]
    ds_read_b64_tr_b16 a[172:173], v251 offset:24576
    ds_read_b64_tr_b16 a[174:175], v251 offset:28672
    v_mfma_f32_16x16x32_bf16 v[196:199], a[120:123], a[32:35], v[196:199]
    buffer_load_dwordx4 v255, s[8:11], s74 offen offset:3072 nt lds
    v_mfma_f32_16x16x32_bf16 v[196:199], a[124:127], a[44:47], v[196:199]
    s_waitcnt lgkmcnt(14)
    v_exp_f32 v206, v206
    v_mfma_f32_16x16x32_bf16 v[0:3], a[144:147], v[208:211], v[0:3]
    s_waitcnt lgkmcnt(12)
    v_exp_f32 v207, v207
    v_mfma_f32_16x16x32_bf16 v[4:7], a[148:151], v[208:211], v[4:7]
    s_waitcnt lgkmcnt(10)
    v_cvt_pk_bf16_f32 v214, v204, v205
    v_cvt_pk_bf16_f32 v215, v206, v207
    v_mfma_f32_16x16x32_bf16 v[8:11], a[152:155], v[208:211], v[8:11]
    s_waitcnt lgkmcnt(8)
    v_exp_f32 v192, v192
    v_mfma_f32_16x16x32_bf16 v[12:15], a[156:159], v[208:211], v[12:15]
    s_waitcnt lgkmcnt(6)
    v_exp_f32 v193, v193
    v_mfma_f32_16x16x32_bf16 v[16:19], a[160:163], v[208:211], v[16:19]
    s_waitcnt lgkmcnt(4)
    v_exp_f32 v194, v194
    v_mfma_f32_16x16x32_bf16 v[20:23], a[164:167], v[208:211], v[20:23]
    s_waitcnt lgkmcnt(2)
    v_exp_f32 v195, v195
    v_mfma_f32_16x16x32_bf16 v[24:27], a[168:171], v[208:211], v[24:27]
    s_waitcnt lgkmcnt(0)
    v_mfma_f32_16x16x32_bf16 v[28:31], a[172:175], v[208:211], v[28:31]
    v_mfma_f32_16x16x32_bf16 a[216:219], a[240:243], v[208:211], a[216:219]
    v_mfma_f32_16x16x32_bf16 v[200:203], a[96:99], a[48:51], v[228:231]
    v_cvt_pk_bf16_f32 v208, v192, v193
    v_cvt_pk_bf16_f32 v209, v194, v195
    v_mfma_f32_16x16x32_bf16 v[200:203], a[100:103], a[60:63], v[200:203]
    s_add_u32 m0, s68, 81920
    v_exp_f32 v196, v196
    v_mfma_f32_16x16x32_bf16 v[200:203], a[104:107], a[72:75], v[200:203]
    s_xor_b32 s74, s38, 122880
    v_exp_f32 v197, v197
    v_mfma_f32_16x16x32_bf16 v[200:203], a[108:111], a[84:87], v[200:203]
    v_exp_f32 v198, v198
    v_mfma_f32_16x16x32_bf16 v[204:207], a[112:115], a[48:51], v[228:231]
    v_exp_f32 v199, v199
    v_mfma_f32_16x16x32_bf16 v[204:207], a[116:119], a[60:63], v[204:207]
    buffer_load_dwordx4 v252, s[12:15], s74 offen offset:0 nt lds
    v_mfma_f32_16x16x32_bf16 v[204:207], a[120:123], a[72:75], v[204:207]
    v_cvt_pk_bf16_f32 v210, v196, v197
    v_cvt_pk_bf16_f32 v211, v198, v199
    v_mfma_f32_16x16x32_bf16 v[204:207], a[124:127], a[84:87], v[204:207]
    v_mfma_f32_16x16x32_bf16 v[32:35], a[144:147], v[212:215], v[32:35]
    v_exp_f32 v200, v200
    v_mfma_f32_16x16x32_bf16 v[36:39], a[148:151], v[212:215], v[36:39]
    v_exp_f32 v201, v201
    v_mfma_f32_16x16x32_bf16 v[40:43], a[152:155], v[212:215], v[40:43]
    v_exp_f32 v202, v202
    v_mfma_f32_16x16x32_bf16 v[44:47], a[156:159], v[212:215], v[44:47]
    v_exp_f32 v203, v203
    v_mfma_f32_16x16x32_bf16 v[48:51], a[160:163], v[212:215], v[48:51]
    v_mfma_f32_16x16x32_bf16 v[52:55], a[164:167], v[212:215], v[52:55]
    v_mfma_f32_16x16x32_bf16 v[56:59], a[168:171], v[212:215], v[56:59]
    v_mfma_f32_16x16x32_bf16 v[60:63], a[172:175], v[212:215], v[60:63]
    v_mfma_f32_16x16x32_bf16 a[220:223], a[240:243], v[212:215], a[220:223]
    v_mfma_f32_16x16x32_bf16 v[192:195], a[96:99], a[52:55], v[232:235]
    v_cvt_pk_bf16_f32 v212, v200, v201
    v_cvt_pk_bf16_f32 v213, v202, v203
    v_mfma_f32_16x16x32_bf16 v[192:195], a[100:103], a[64:67], v[192:195]
    v_exp_f32 v204, v204
    v_mfma_f32_16x16x32_bf16 v[192:195], a[104:107], a[76:79], v[192:195]
    v_exp_f32 v205, v205
    v_mfma_f32_16x16x32_bf16 v[192:195], a[108:111], a[88:91], v[192:195]
    v_exp_f32 v206, v206
    v_mfma_f32_16x16x32_bf16 v[196:199], a[112:115], a[52:55], v[232:235]
    buffer_load_dwordx4 v253, s[12:15], s74 offen offset:1024 nt lds
    v_mfma_f32_16x16x32_bf16 v[196:199], a[116:119], a[64:67], v[196:199]
    v_exp_f32 v207, v207
    v_mfma_f32_16x16x32_bf16 v[196:199], a[120:123], a[76:79], v[196:199]
    v_cvt_pk_bf16_f32 v214, v204, v205
    v_cvt_pk_bf16_f32 v215, v206, v207
    v_mfma_f32_16x16x32_bf16 v[196:199], a[124:127], a[88:91], v[196:199]
    v_mfma_f32_16x16x32_bf16 v[64:67], a[144:147], v[208:211], v[64:67]
    v_exp_f32 v192, v192
    v_mfma_f32_16x16x32_bf16 v[68:71], a[148:151], v[208:211], v[68:71]
    v_exp_f32 v193, v193
    v_mfma_f32_16x16x32_bf16 v[72:75], a[152:155], v[208:211], v[72:75]
    v_exp_f32 v194, v194
    v_mfma_f32_16x16x32_bf16 v[76:79], a[156:159], v[208:211], v[76:79]
    v_exp_f32 v195, v195
    v_mfma_f32_16x16x32_bf16 v[80:83], a[160:163], v[208:211], v[80:83]
    v_mfma_f32_16x16x32_bf16 v[84:87], a[164:167], v[208:211], v[84:87]
    v_mfma_f32_16x16x32_bf16 v[88:91], a[168:171], v[208:211], v[88:91]
    v_mfma_f32_16x16x32_bf16 v[92:95], a[172:175], v[208:211], v[92:95]
    s_waitcnt vmcnt(10)
    v_mfma_f32_16x16x32_bf16 a[224:227], a[240:243], v[208:211], a[224:227]
    s_barrier
    v_mfma_f32_16x16x32_bf16 v[200:203], a[96:99], a[56:59], v[236:239]
    ds_read_b128 a[96:99], v240 offset:32768
    v_cvt_pk_bf16_f32 v208, v192, v193
    v_mfma_f32_16x16x32_bf16 v[200:203], a[100:103], a[68:71], v[200:203]
    v_cvt_pk_bf16_f32 v209, v194, v195
    v_mfma_f32_16x16x32_bf16 v[200:203], a[104:107], a[80:83], v[200:203]
    ds_read_b128 a[100:103], v241 offset:32768
    v_mfma_f32_16x16x32_bf16 v[200:203], a[108:111], a[92:95], v[200:203]
    v_exp_f32 v196, v196
    v_mfma_f32_16x16x32_bf16 v[204:207], a[112:115], a[56:59], v[236:239]
    ds_read_b128 a[104:107], v242 offset:32768
    v_mfma_f32_16x16x32_bf16 v[204:207], a[116:119], a[68:71], v[204:207]
    buffer_load_dwordx4 v254, s[12:15], s74 offen offset:2048 nt lds
    v_mfma_f32_16x16x32_bf16 v[204:207], a[120:123], a[80:83], v[204:207]
    ds_read_b128 a[108:111], v243 offset:32768
    v_mfma_f32_16x16x32_bf16 v[204:207], a[124:127], a[92:95], v[204:207]
    v_exp_f32 v197, v197
    v_mfma_f32_16x16x32_bf16 v[96:99], a[144:147], v[212:215], v[96:99]
    ds_read_b128 a[112:115], v240 offset:36864
    v_mfma_f32_16x16x32_bf16 v[100:103], a[148:151], v[212:215], v[100:103]
    v_exp_f32 v198, v198
    v_mfma_f32_16x16x32_bf16 v[104:107], a[152:155], v[212:215], v[104:107]
    ds_read_b128 a[116:119], v241 offset:36864
    v_mfma_f32_16x16x32_bf16 v[108:111], a[156:159], v[212:215], v[108:111]
    v_exp_f32 v199, v199
    v_mfma_f32_16x16x32_bf16 v[112:115], a[160:163], v[212:215], v[112:115]
    ds_read_b128 a[120:123], v242 offset:36864
    v_cvt_pk_bf16_f32 v210, v196, v197
    v_mfma_f32_16x16x32_bf16 v[116:119], a[164:167], v[212:215], v[116:119]
    v_cvt_pk_bf16_f32 v211, v198, v199
    v_mfma_f32_16x16x32_bf16 v[120:123], a[168:171], v[212:215], v[120:123]
    ds_read_b128 a[124:127], v243 offset:36864
    v_mfma_f32_16x16x32_bf16 v[124:127], a[172:175], v[212:215], v[124:127]
    v_exp_f32 v200, v200
    v_mfma_f32_16x16x32_bf16 a[228:231], a[240:243], v[212:215], a[228:231]
    s_waitcnt lgkmcnt(7)
    v_exp_f32 v201, v201
    v_mfma_f32_16x16x32_bf16 v[192:195], a[96:99], a[0:3], v[216:219]
    s_waitcnt lgkmcnt(6)
    v_exp_f32 v202, v202
    v_mfma_f32_16x16x32_bf16 v[192:195], a[100:103], a[12:15], v[192:195]
    s_waitcnt lgkmcnt(5)
    v_exp_f32 v203, v203
    v_mfma_f32_16x16x32_bf16 v[192:195], a[104:107], a[24:27], v[192:195]
    s_waitcnt lgkmcnt(4)
    v_cvt_pk_bf16_f32 v212, v200, v201
    v_cvt_pk_bf16_f32 v213, v202, v203
    v_mfma_f32_16x16x32_bf16 v[192:195], a[108:111], a[36:39], v[192:195]
    s_waitcnt lgkmcnt(3)
    buffer_load_dwordx4 v255, s[12:15], s74 offen offset:3072 nt lds
    v_mfma_f32_16x16x32_bf16 v[196:199], a[112:115], a[0:3], v[216:219]
    s_waitcnt lgkmcnt(2)
    v_accvgpr_read_b32 v252, a244
    v_accvgpr_read_b32 v253, a246
    v_mfma_f32_16x16x32_bf16 v[196:199], a[116:119], a[12:15], v[196:199]
    s_waitcnt lgkmcnt(1)
    v_exp_f32 v204, v204
    v_mfma_f32_16x16x32_bf16 v[196:199], a[120:123], a[24:27], v[196:199]
    s_waitcnt lgkmcnt(0)
    v_exp_f32 v205, v205
    v_mfma_f32_16x16x32_bf16 v[196:199], a[124:127], a[36:39], v[196:199]
    v_exp_f32 v206, v206
    v_mfma_f32_16x16x32_bf16 v[128:131], a[144:147], v[208:211], v[128:131]
    v_exp_f32 v207, v207
    v_mfma_f32_16x16x32_bf16 v[132:135], a[148:151], v[208:211], v[132:135]
    s_add_u32 m0, s70, 8192
    v_cvt_pk_bf16_f32 v214, v204, v205
    v_cvt_pk_bf16_f32 v215, v206, v207
    v_mfma_f32_16x16x32_bf16 v[136:139], a[152:155], v[208:211], v[136:139]
    s_xor_b32 s73, s72, 0
    v_exp_f32 v192, v192
    v_mfma_f32_16x16x32_bf16 v[140:143], a[156:159], v[208:211], v[140:143]
    v_exp_f32 v193, v193
    v_mfma_f32_16x16x32_bf16 v[144:147], a[160:163], v[208:211], v[144:147]
    v_exp_f32 v194, v194
    v_mfma_f32_16x16x32_bf16 v[148:151], a[164:167], v[208:211], v[148:151]
    buffer_load_dwordx4 v252, s[20:23], s73 offen offset:0 lds
    v_mfma_f32_16x16x32_bf16 v[152:155], a[168:171], v[208:211], v[152:155]
    s_add_u32 s73, s73, 7168
    v_exp_f32 v195, v195
    v_mfma_f32_16x16x32_bf16 v[156:159], a[172:175], v[208:211], v[156:159]
    v_mfma_f32_16x16x32_bf16 a[232:235], a[240:243], v[208:211], a[232:235]
    v_mfma_f32_16x16x32_bf16 v[200:203], a[96:99], a[4:7], v[220:223]
    v_cvt_pk_bf16_f32 v208, v192, v193
    v_cvt_pk_bf16_f32 v209, v194, v195
    v_mfma_f32_16x16x32_bf16 v[200:203], a[100:103], a[16:19], v[200:203]
    v_exp_f32 v196, v196
    v_mfma_f32_16x16x32_bf16 v[200:203], a[104:107], a[28:31], v[200:203]
    v_exp_f32 v197, v197
    v_mfma_f32_16x16x32_bf16 v[200:203], a[108:111], a[40:43], v[200:203]
    v_exp_f32 v198, v198
    v_mfma_f32_16x16x32_bf16 v[204:207], a[112:115], a[4:7], v[220:223]
    v_exp_f32 v199, v199
    v_mfma_f32_16x16x32_bf16 v[204:207], a[116:119], a[16:19], v[204:207]
    v_cvt_pk_bf16_f32 v210, v196, v197
    v_cvt_pk_bf16_f32 v211, v198, v199
    v_mfma_f32_16x16x32_bf16 v[204:207], a[120:123], a[28:31], v[204:207]
    s_waitcnt vmcnt(9)
    v_mfma_f32_16x16x32_bf16 v[204:207], a[124:127], a[40:43], v[204:207]
    s_barrier
    buffer_load_dwordx4 v252, s[20:23], s73 offen offset:1024 lds
    v_mfma_f32_16x16x32_bf16 v[160:163], a[144:147], v[212:215], v[160:163]
    s_add_u32 s73, s73, 7168
    ds_read_b64_tr_b16 a[144:145], v244 offset:32768
    ds_read_b64_tr_b16 a[146:147], v244 offset:36864
    v_mfma_f32_16x16x32_bf16 v[164:167], a[148:151], v[212:215], v[164:167]
L_hopa_9:
    s_cbranch_execz L_backa
    v_exp_f32 v200, v200
    v_mfma_f32_16x16x32_bf16 v[168:171], a[152:155], v[212:215], v[168:171]
    ds_read_b64_tr_b16 a[148:149], v245 offset:32768
    ds_read_b64_tr_b16 a[150:151], v245 offset:36864
    v_mfma_f32_16x16x32_bf16 v[172:175], a[156:159], v[212:215], v[172:175]
    v_exp_f32 v201, v201
    v_mfma_f32_16x16x32_bf16 v[176:179], a[160:163], v[212:215], v[176:179]
    ds_read_b64_tr_b16 a[152:153], v246 offset:32768
    ds_read_b64_tr_b16 a[154:155], v246 offset:36864
    v_mfma_f32_16x16x32_bf16 v[180:183], a[164:167], v[212:215], v[180:183]
    v_exp_f32 v202, v202
    v_mfma_f32_16x16x32_bf16 v[184:187], a[168:171], v[212:215], v[184:187]
    ds_read_b64_tr_b16 a[156:157], v247 offset:32768
    ds_read_b64_tr_b16 a[158:159], v247 offset:36864
    v_mfma_f32_16x16x32_bf16 v[188:191], a[172:175], v[212:215], v[188:191]
    v_exp_f32 v203, v203
    v_mfma_f32_16x16x32_bf16 a[236:239], a[240:243], v[212:215], a[236:239]
    ds_read_b64_tr_b16 a[160:161], v248 offset:32768
    ds_read_b64_tr_b16 a[162:163], v248 offset:36864
    v_mfma_f32_16x16x32_bf16 v[192:195], a[96:99], a[8:11], v[224:227]
    buffer_load_dwordx4 v252, s[20:23], s73 offen offset:2048 lds
    v_mfma_f32_16x16x32_bf16 v[192:195], a[100:103], a[20:23], v[192:195]
    s_add_u32 s73, s73, 7168
    ds_read_b64_tr_b16 a[164:165], v249 offset:32768
    ds_read_b64_tr_b16 a[166:167], v249 offset:36864
    v_mfma_f32_16x16x32_bf16 v[192:195], a[104:107], a[32:35], v[192:195]
    v_cvt_pk_bf16_f32 v212, v200, v201
    v_cvt_pk_bf16_f32 v213, v202, v203
    v_mfma_f32_16x16x32_bf16 v[192:195], a[108:111], a[44:47], v[192:195]
    ds_read_b64_tr_b16 a[168:169], v250 offset:32768
    ds_read_b64_tr_b16 a[170:171], v250 offset:36864
    v_mfma_f32_16x16x32_bf16 v[196:199], a[112:115], a[8:11], v[224:227]
    v_exp_f32 v204, v204
    v_mfma_f32_16x16x32_bf16 v[196:199], a[116:119], a[20:23], v[196:199]
    ds_read_b64_tr_b16 a[172:173], v251 offset:32768
    ds_read_b64_tr_b16 a[174:175], v251 offset:36864
    v_mfma_f32_16x16x32_bf16 v[196:199], a[120:123], a[32:35], v[196:199]
    v_exp_f32 v205, v205
    v_mfma_f32_16x16x32_bf16 v[196:199], a[124:127], a[44:47], v[196:199]
    s_waitcnt lgkmcnt(14)
    v_exp_f32 v206, v206
    v_mfma_f32_16x16x32_bf16 v[0:3], a[144:147], v[208:211], v[0:3]
    s_waitcnt lgkmcnt(12)
    v_exp_f32 v207, v207
    v_mfma_f32_16x16x32_bf16 v[4:7], a[148:151], v[208:211], v[4:7]
    s_waitcnt lgkmcnt(10)
    v_cvt_pk_bf16_f32 v214, v204, v205
    v_cvt_pk_bf16_f32 v215, v206, v207
    v_mfma_f32_16x16x32_bf16 v[8:11], a[152:155], v[208:211], v[8:11]
    s_waitcnt lgkmcnt(8)
    buffer_load_dwordx4 v252, s[20:23], s73 offen offset:3072 lds
    v_mfma_f32_16x16x32_bf16 v[12:15], a[156:159], v[208:211], v[12:15]
    s_waitcnt lgkmcnt(6)
    v_exp_f32 v192, v192
    v_mfma_f32_16x16x32_bf16 v[16:19], a[160:163], v[208:211], v[16:19]
    s_waitcnt lgkmcnt(4)
    v_exp_f32 v193, v193
    v_mfma_f32_16x16x32_bf16 v[20:23], a[164:167], v[208:211], v[20:23]
    s_waitcnt lgkmcnt(2)
    v_exp_f32 v194, v194
    v_mfma_f32_16x16x32_bf16 v[24:27], a[168:171], v[208:211], v[24:27]
    s_waitcnt lgkmcnt(0)
    v_exp_f32 v195, v195
    v_mfma_f32_16x16x32_bf16 v[28:31], a[172:175], v[208:211], v[28:31]
    v_mfma_f32_16x16x32_bf16 a[216:219], a[240:243], v[208:211], a[216:219]
    v_mfma_f32_16x16x32_bf16 v[200:203], a[96:99], a[48:51], v[228:231]
    s_add_u32 m0, s70, 49152
    v_cvt_pk_bf16_f32 v208, v192, v193
    v_cvt_pk_bf16_f32 v209, v194, v195
    v_mfma_f32_16x16x32_bf16 v[200:203], a[100:103], a[60:63], v[200:203]
    s_xor_b32 s73, s72, 262144
    v_exp_f32 v196, v196
    v_mfma_f32_16x16x32_bf16 v[200:203], a[104:107], a[72:75], v[200:203]
    v_exp_f32 v197, v197
    v_mfma_f32_16x16x32_bf16 v[200:203], a[108:111], a[84:87], v[200:203]
    v_exp_f32 v198, v198
    v_mfma_f32_16x16x32_bf16 v[204:207], a[112:115], a[48:51], v[228:231]
    buffer_load_dwordx4 v252, s[20:23], s73 offen offset:0 lds
    v_mfma_f32_16x16x32_bf16 v[204:207], a[116:119], a[60:63], v[204:207]
    s_add_u32 s73, s73, 7168
    v_exp_f32 v199, v199
    v_mfma_f32_16x16x32_bf16 v[204:207], a[120:123], a[72:75], v[204:207]
    v_cvt_pk_bf16_f32 v210, v196, v197
    v_cvt_pk_bf16_f32 v211, v198, v199
    v_mfma_f32_16x16x32_bf16 v[204:207], a[124:127], a[84:87], v[204:207]
    v_mfma_f32_16x16x32_bf16 v[32:35], a[144:147], v[212:215], v[32:35]
    v_exp_f32 v200, v200
    v_mfma_f32_16x16x32_bf16 v[36:39], a[148:151], v[212:215], v[36:39]
    v_exp_f32 v201, v201
    v_mfma_f32_16x16x32_bf16 v[40:43], a[152:155], v[212:215], v[40:43]
    v_exp_f32 v202, v202
    v_mfma_f32_16x16x32_bf16 v[44:47], a[156:159], v[212:215], v[44:47]
    v_exp_f32 v203, v203
    v_mfma_f32_16x16x32_bf16 v[48:51], a[160:163], v[212:215], v[48:51]
    v_mfma_f32_16x16x32_bf16 v[52:55], a[164:167], v[212:215], v[52:55]
    v_mfma_f32_16x16x32_bf16 v[56:59], a[168:171], v[212:215], v[56:59]
    buffer_load_dwordx4 v252, s[20:23], s73 offen offset:1024 lds
    v_mfma_f32_16x16x32_bf16 v[60:63], a[172:175], v[212:215], v[60:63]
    s_add_u32 s73, s73, 7168
    v_mfma_f32_16x16x32_bf16 a[220:223], a[240:243], v[212:215], a[220:223]
    v_mfma_f32_16x16x32_bf16 v[192:195], a[96:99], a[52:55], v[232:235]
    v_cvt_pk_bf16_f32 v212, v200, v201
    v_cvt_pk_bf16_f32 v213, v202, v203
    v_mfma_f32_16x16x32_bf16 v[192:195], a[100:103], a[64:67], v[192:195]
    v_exp_f32 v204, v204
    v_mfma_f32_16x16x32_bf16 v[192:195], a[104:107], a[76:79], v[192:195]
    v_exp_f32 v205, v205
    v_mfma_f32_16x16x32_bf16 v[192:195], a[108:111], a[88:91], v[192:195]
    v_exp_f32 v206, v206
    v_mfma_f32_16x16x32_bf16 v[196:199], a[112:115], a[52:55], v[232:235]
    v_exp_f32 v207, v207
    v_mfma_f32_16x16x32_bf16 v[196:199], a[116:119], a[64:67], v[196:199]
    v_cvt_pk_bf16_f32 v214, v204, v205
    v_cvt_pk_bf16_f32 v215, v206, v207
    v_mfma_f32_16x16x32_bf16 v[196:199], a[120:123], a[76:79], v[196:199]
    v_mfma_f32_16x16x32_bf16 v[196:199], a[124:127], a[88:91], v[196:199]
    buffer_load_dwordx4 v252, s[20:23], s73 offen offset:2048 lds
    v_mfma_f32_16x16x32_bf16 v[64:67], a[144:147], v[208:211], v[64:67]
    s_add_u32 s73, s73, 7168
    v_exp_f32 v192, v192
    v_mfma_f32_16x16x32_bf16 v[68:71], a[148:151], v[208:211], v[68:71]
    v_exp_f32 v193, v193
    v_mfma_f32_16x16x32_bf16 v[72:75], a[152:155], v[208:211], v[72:75]
    v_exp_f32 v194, v194
    v_mfma_f32_16x16x32_bf16 v[76:79], a[156:159], v[208:211], v[76:79]
    v_exp_f32 v195, v195
    v_mfma_f32_16x16x32_bf16 v[80:83], a[160:163], v[208:211], v[80:83]
    v_mfma_f32_16x16x32_bf16 v[84:87], a[164:167], v[208:211], v[84:87]
    v_mfma_f32_16x16x32_bf16 v[88:91], a[168:171], v[208:211], v[88:91]
    v_mfma_f32_16x16x32_bf16 v[92:95], a[172:175], v[208:211], v[92:95]
    s_waitcnt vmcnt(11)
    v_mfma_f32_16x16x32_bf16 a[224:227], a[240:243], v[208:211], a[224:227]
    s_barrier
    v_mfma_f32_16x16x32_bf16 v[200:203], a[96:99], a[56:59], v[236:239]
    ds_read_b128 a[96:99], v240 offset:0
    v_cvt_pk_bf16_f32 v208, v192, v193
    v_mfma_f32_16x16x32_bf16 v[200:203], a[100:103], a[68:71], v[200:203]
    buffer_load_dwordx4 v252, s[20:23], s73 offen offset:3072 lds
    v_mfma_f32_16x16x32_bf16 v[200:203], a[104:107], a[80:83], v[200:203]
    ds_read_b128 a[100:103], v241 offset:0
    v_cvt_pk_bf16_f32 v209, v194, v195
    v_mfma_f32_16x16x32_bf16 v[200:203], a[108:111], a[92:95], v[200:203]
    v_exp_f32 v196, v196
    v_mfma_f32_16x16x32_bf16 v[204:207], a[112:115], a[56:59], v[236:239]
    ds_read_b128 a[104:107], v242 offset:0
    v_mfma_f32_16x16x32_bf16 v[204:207], a[116:119], a[68:71], v[204:207]
    v_exp_f32 v197, v197
    v_mfma_f32_16x16x32_bf16 v[204:207], a[120:123], a[80:83], v[204:207]
    ds_read_b128 a[108:111], v243 offset:0
    v_mfma_f32_16x16x32_bf16 v[204:207], a[124:127], a[92:95], v[204:207]
    s_add_u32 m0, s70, 16384
    v_exp_f32 v198, v198
    v_mfma_f32_16x16x32_bf16 v[96:99], a[144:147], v[212:215], v[96:99]
    s_xor_b32 s73, s72, 128
    ds_read_b128 a[112:115], v240 offset:4096
    v_mfma_f32_16x16x32_bf16 v[100:103], a[148:151], v[212:215], v[100:103]
    v_exp_f32 v199, v199
    v_mfma_f32_16x16x32_bf16 v[104:107], a[152:155], v[212:215], v[104:107]
    ds_read_b128 a[116:119], v241 offset:4096
    v_cvt_pk_bf16_f32 v210, v196, v197
    v_mfma_f32_16x16x32_bf16 v[108:111], a[156:159], v[212:215], v[108:111]
    buffer_load_dwordx4 v252, s[20:23], s73 offen offset:0 lds
    v_mfma_f32_16x16x32_bf16 v[112:115], a[160:163], v[212:215], v[112:115]
    s_add_u32 s73, s73, 7168
    ds_read_b128 a[120:123], v242 offset:4096
    v_cvt_pk_bf16_f32 v211, v198, v199
    v_mfma_f32_16x16x32_bf16 v[116:119], a[164:167], v[212:215], v[116:119]
    v_exp_f32 v200, v200
    v_mfma_f32_16x16x32_bf16 v[120:123], a[168:171], v[212:215], v[120:123]
    ds_read_b128 a[124:127], v243 offset:4096
    v_mfma_f32_16x16x32_bf16 v[124:127], a[172:175], v[212:215], v[124:127]
    v_exp_f32 v201, v201
    v_mfma_f32_16x16x32_bf16 a[228:231], a[240:243], v[212:215], a[228:231]
    s_waitcnt lgkmcnt(7)
    v_exp_f32 v202, v202
    v_mfma_f32_16x16x32_bf16 v[192:195], a[96:99], a[0:3], v[216:219]
    s_waitcnt lgkmcnt(6)
    v_exp_f32 v203, v203
    v_mfma_f32_16x16x32_bf16 v[192:195], a[100:103], a[12:15], v[192:195]
    s_waitcnt lgkmcnt(5)
    v_cvt_pk_bf16_f32 v212, v200, v201
    v_cvt_pk_bf16_f32 v213, v202, v203
    v_mfma_f32_16x16x32_bf16 v[192:195], a[104:107], a[24:27], v[192:195]
    s_waitcnt lgkmcnt(4)
    v_exp_f32 v204, v204
    v_mfma_f32_16x16x32_bf16 v[192:195], a[108:111], a[36:39], v[192:195]
    s_waitcnt lgkmcnt(3)
    v_exp_f32 v205, v205
    v_mfma_f32_16x16x32_bf16 v[196:199], a[112:115], a[0:3], v[216:219]
    s_waitcnt lgkmcnt(2)
    buffer_load_dwordx4 v252, s[20:23], s73 offen offset:1024 lds
    v_mfma_f32_16x16x32_bf16 v[196:199], a[116:119], a[12:15], v[196:199]
    s_waitcnt lgkmcnt(1)
    s_add_u32 s73, s73, 7168
    v_exp_f32 v206, v206
    v_mfma_f32_16x16x32_bf16 v[196:199], a[120:123], a[24:27], v[196:199]
    s_waitcnt lgkmcnt(0)
    v_exp_f32 v207, v207
    v_mfma_f32_16x16x32_bf16 v[196:199], a[124:127], a[36:39], v[196:199]
    v_cvt_pk_bf16_f32 v214, v204, v205
    v_cvt_pk_bf16_f32 v215, v206, v207
    v_mfma_f32_16x16x32_bf16 v[128:131], a[144:147], v[208:211], v[128:131]
    v_exp_f32 v192, v192
    v_mfma_f32_16x16x32_bf16 v[132:135], a[148:151], v[208:211], v[132:135]
    v_exp_f32 v193, v193
    v_mfma_f32_16x16x32_bf16 v[136:139], a[152:155], v[208:211], v[136:139]
    v_exp_f32 v194, v194
    v_mfma_f32_16x16x32_bf16 v[140:143], a[156:159], v[208:211], v[140:143]
    v_exp_f32 v195, v195
    v_mfma_f32_16x16x32_bf16 v[144:147], a[160:163], v[208:211], v[144:147]
    v_accvgpr_read_b32 v240, a245
    v_xor_b32 v241, 32, v240
    v_mfma_f32_16x16x32_bf16 v[148:151], a[164:167], v[208:211], v[148:151]
    v_xor_b32 v242, 64, v240
    v_xor_b32 v243, 96, v240
    v_mfma_f32_16x16x32_bf16 v[152:155], a[168:171], v[208:211], v[152:155]
    buffer_load_dwordx4 v252, s[20:23], s73 offen offset:2048 lds
    v_mfma_f32_16x16x32_bf16 v[156:159], a[172:175], v[208:211], v[156:159]
    s_add_u32 s73, s73, 7168
    v_mfma_f32_16x16x32_bf16 a[232:235], a[240:243], v[208:211], a[232:235]
    v_mfma_f32_16x16x32_bf16 v[200:203], a[96:99], a[4:7], v[220:223]
    v_cvt_pk_bf16_f32 v208, v192, v193
    v_cvt_pk_bf16_f32 v209, v194, v195
    v_mfma_f32_16x16x32_bf16 v[200:203], a[100:103], a[16:19], v[200:203]
    v_exp_f32 v196, v196
    v_mfma_f32_16x16x32_bf16 v[200:203], a[104:107], a[28:31], v[200:203]
    v_exp_f32 v197, v197
    v_mfma_f32_16x16x32_bf16 v[200:203], a[108:111], a[40:43], v[200:203]
    v_exp_f32 v198, v198
    v_mfma_f32_16x16x32_bf16 v[204:207], a[112:115], a[4:7], v[220:223]
    v_exp_f32 v199, v199
    v_mfma_f32_16x16x32_bf16 v[204:207], a[116:119], a[16:19], v[204:207]
    v_cvt_pk_bf16_f32 v210, v196, v197
    v_cvt_pk_bf16_f32 v211, v198, v199
    v_mfma_f32_16x16x32_bf16 v[204:207], a[120:123], a[28:31], v[204:207]
    s_waitcnt vmcnt(11)
    v_mfma_f32_16x16x32_bf16 v[204:207], a[124:127], a[40:43], v[204:207]
    s_barrier
    v_mfma_f32_16x16x32_bf16 v[160:163], a[144:147], v[212:215], v[160:163]
    ds_read_b64_tr_b16 a[144:145], v244 offset:0
    ds_read_b64_tr_b16 a[146:147], v244 offset:4096
    v_mfma_f32_16x16x32_bf16 v[164:167], a[148:151], v[212:215], v[164:167]
    buffer_load_dwordx4 v252, s[20:23], s73 offen offset:3072 lds
    v_mfma_f32_16x16x32_bf16 v[168:171], a[152:155], v[212:215], v[168:171]
    ds_read_b64_tr_b16 a[148:149], v245 offset:0
    ds_read_b64_tr_b16 a[150:151], v245 offset:4096
    v_mfma_f32_16x16x32_bf16 v[172:175], a[156:159], v[212:215], v[172:175]
    v_exp_f32 v200, v200
    v_mfma_f32_16x16x32_bf16 v[176:179], a[160:163], v[212:215], v[176:179]
    ds_read_b64_tr_b16 a[152:153], v246 offset:0
    ds_read_b64_tr_b16 a[154:155], v246 offset:4096
    v_mfma_f32_16x16x32_bf16 v[180:183], a[164:167], v[212:215], v[180:183]
    v_exp_f32 v201, v201
    v_mfma_f32_16x16x32_bf16 v[184:187], a[168:171], v[212:215], v[184:187]
    ds_read_b64_tr_b16 a[156:157], v247 offset:0
    ds_read_b64_tr_b16 a[158:159], v247 offset:4096
    v_mfma_f32_16x16x32_bf16 v[188:191], a[172:175], v[212:215], v[188:191]
    s_add_u32 m0, s70, 57344
    v_exp_f32 v202, v202
    v_mfma_f32_16x16x32_bf16 a[236:239], a[240:243], v[212:215], a[236:239]
    s_xor_b32 s73, s72, 65536
    ds_read_b64_tr_b16 a[160:161], v248 offset:0
    ds_read_b64_tr_b16 a[162:163], v248 offset:4096
    v_mfma_f32_16x16x32_bf16 v[192:195], a[96:99], a[8:11], v[224:227]
    v_exp_f32 v203, v203
    v_mfma_f32_16x16x32_bf16 v[192:195], a[100:103], a[20:23], v[192:195]
    ds_read_b64_tr_b16 a[164:165], v249 offset:0
    ds_read_b64_tr_b16 a[166:167], v249 offset:4096
    v_mfma_f32_16x16x32_bf16 v[192:195], a[104:107], a[32:35], v[192:195]
    buffer_load_dwordx4 v252, s[20:23], s73 offen offset:0 lds
    v_mfma_f32_16x16x32_bf16 v[192:195], a[108:111], a[44:47], v[192:195]
    s_add_u32 s73, s73, 7168
    ds_read_b64_tr_b16 a[168:169], v250 offset:0
    ds_read_b64_tr_b16 a[170:171], v250 offset:4096
    v_mfma_f32_16x16x32_bf16 v[196:199], a[112:115], a[8:11], v[224:227]
    v_cvt_pk_bf16_f32 v212, v200, v201
    v_cvt_pk_bf16_f32 v213, v202, v203
    v_mfma_f32_16x16x32_bf16 v[196:199], a[116:119], a[20:23], v[196:199]
    ds_read_b64_tr_b16 a[172:173], v251 offset:0
    ds_read_b64_tr_b16 a[174:175], v251 offset:4096
    v_mfma_f32_16x16x32_bf16 v[196:199], a[120:123], a[32:35], v[196:199]
    v_exp_f32 v204, v204
    v_mfma_f32_16x16x32_bf16 v[196:199], a[124:127], a[44:47], v[196:199]
    s_waitcnt lgkmcnt(14)
    v_exp_f32 v205, v205
    v_mfma_f32_16x16x32_bf16 v[0:3], a[144:147], v[208:211], v[0:3]
    s_waitcnt lgkmcnt(12)
    v_exp_f32 v206, v206
    v_mfma_f32_16x16x32_bf16 v[4:7], a[148:151], v[208:211], v[4:7]
    s_waitcnt lgkmcnt(10)
    v_exp_f32 v207, v207
    v_mfma_f32_16x16x32_bf16 v[8:11], a[152:155], v[208:211], v[8:11]
    s_waitcnt lgkmcnt(8)
    v_cvt_pk_bf16_f32 v214, v204, v205
    v_cvt_pk_bf16_f32 v215, v206, v207
    v_mfma_f32_16x16x32_bf16 v[12:15], a[156:159], v[208:211], v[12:15]
    s_waitcnt lgkmcnt(6)
    buffer_load_dwordx4 v252, s[20:23], s73 offen offset:1024 lds
    v_mfma_f32_16x16x32_bf16 v[16:19], a[160:163], v[208:211], v[16:19]
    s_waitcnt lgkmcnt(4)
    s_add_u32 s73, s73, 7168
    s_mul_i32 s82, s62, 40960
    v_exp_f32 v192, v192
    v_mfma_f32_16x16x32_bf16 v[20:23], a[164:167], v[208:211], v[20:23]
    s_waitcnt lgkmcnt(2)
    s_mul_i32 s83, s63, 81920
    v_exp_f32 v193, v193
    v_mfma_f32_16x16x32_bf16 v[24:27], a[168:171], v[208:211], v[24:27]
    s_waitcnt lgkmcnt(0)
    s_sub_u32 s77, 81920, s83
    v_exp_f32 v194, v194
    v_mfma_f32_16x16x32_bf16 v[28:31], a[172:175], v[208:211], v[28:31]
    s_mov_b64 s[80:81], 0
    v_exp_f32 v195, v195
    v_mfma_f32_16x16x32_bf16 a[216:219], a[240:243], v[208:211], a[216:219]
    v_mfma_f32_16x16x32_bf16 v[200:203], a[96:99], a[48:51], v[228:231]
    v_cvt_pk_bf16_f32 v208, v192, v193
    v_cvt_pk_bf16_f32 v209, v194, v195
    v_mfma_f32_16x16x32_bf16 v[200:203], a[100:103], a[60:63], v[200:203]
    v_exp_f32 v196, v196
    v_mfma_f32_16x16x32_bf16 v[200:203], a[104:107], a[72:75], v[200:203]
    v_exp_f32 v197, v197
    v_mfma_f32_16x16x32_bf16 v[200:203], a[108:111], a[84:87], v[200:203]
    v_exp_f32 v198, v198
    v_mfma_f32_16x16x32_bf16 v[204:207], a[112:115], a[48:51], v[228:231]
    v_exp_f32 v199, v199
    v_mfma_f32_16x16x32_bf16 v[204:207], a[116:119], a[60:63], v[204:207]
    buffer_load_dwordx4 v252, s[20:23], s73 offen offset:2048 lds
    v_mfma_f32_16x16x32_bf16 v[204:207], a[120:123], a[72:75], v[204:207]
    s_add_u32 s73, s73, 7168
    v_cvt_pk_bf16_f32 v210, v196, v197
    v_cvt_pk_bf16_f32 v211, v198, v199
    v_mfma_f32_16x16x32_bf16 v[204:207], a[124:127], a[84:87], v[204:207]
    v_add_u32 v251, s82, v253
    v_add_u32 v250, s83, v251
    v_mfma_f32_16x16x32_bf16 v[32:35], a[144:147], v[212:215], v[32:35]
    v_exp_f32 v200, v200
    v_mfma_f32_16x16x32_bf16 v[36:39], a[148:151], v[212:215], v[36:39]
    v_exp_f32 v201, v201
    v_mfma_f32_16x16x32_bf16 v[40:43], a[152:155], v[212:215], v[40:43]
    v_exp_f32 v202, v202
    v_mfma_f32_16x16x32_bf16 v[44:47], a[156:159], v[212:215], v[44:47]
    v_exp_f32 v203, v203
    v_mfma_f32_16x16x32_bf16 v[48:51], a[160:163], v[212:215], v[48:51]
    v_add_u32 v251, s77, v251
    v_accvgpr_read_b32 v244, a216
    v_mfma_f32_16x16x32_bf16 v[52:55], a[164:167], v[212:215], v[52:55]
    v_cmp_nlt_f32_e64 vcc, v244, s79
    v_mfma_f32_16x16x32_bf16 v[56:59], a[168:171], v[212:215], v[56:59]
    v_rcp_f32 v244, v244
    s_or_b64 s[80:81], s[80:81], vcc
    v_mfma_f32_16x16x32_bf16 v[60:63], a[172:175], v[212:215], v[60:63]
    buffer_load_dwordx4 v252, s[20:23], s73 offen offset:3072 lds
    v_mfma_f32_16x16x32_bf16 a[220:223], a[240:243], v[212:215], a[220:223]
    v_mul_f32 v0, v0, v244
    v_mul_f32 v1, v1, v244
    v_mfma_f32_16x16x32_bf16 v[192:195], a[96:99], a[52:55], v[232:235]
    v_cvt_pk_bf16_f32 v212, v200, v201
    v_cvt_pk_bf16_f32 v213, v202, v203
    v_mfma_f32_16x16x32_bf16 v[192:195], a[100:103], a[64:67], v[192:195]
    v_exp_f32 v204, v204
    v_mfma_f32_16x16x32_bf16 v[192:195], a[104:107], a[76:79], v[192:195]
    v_exp_f32 v205, v205
    v_mfma_f32_16x16x32_bf16 v[192:195], a[108:111], a[88:91], v[192:195]
    v_exp_f32 v206, v206
    v_mfma_f32_16x16x32_bf16 v[196:199], a[112:115], a[52:55], v[232:235]
    s_add_u32 m0, s70, 24576
    v_exp_f32 v207, v207
    v_mfma_f32_16x16x32_bf16 v[196:199], a[116:119], a[64:67], v[196:199]
    s_xor_b32 s73, s72, 65664
    v_cvt_pk_bf16_f32 v214, v204, v205
    v_cvt_pk_bf16_f32 v215, v206, v207
    v_mfma_f32_16x16x32_bf16 v[196:199], a[120:123], a[76:79], v[196:199]
    v_mul_f32 v2, v2, v244
    v_mul_f32 v3, v3, v244
    v_mfma_f32_16x16x32_bf16 v[196:199], a[124:127], a[88:91], v[196:199]
    v_mul_f32 v4, v4, v244
    v_mul_f32 v5, v5, v244
    v_mfma_f32_16x16x32_bf16 v[64:67], a[144:147], v[208:211], v[64:67]
    buffer_load_dwordx4 v252, s[20:23], s73 offen offset:0 lds
    v_mfma_f32_16x16x32_bf16 v[68:71], a[148:151], v[208:211], v[68:71]
    s_add_u32 s73, s73, 7168
    v_exp_f32 v192, v192
    v_mfma_f32_16x16x32_bf16 v[72:75], a[152:155], v[208:211], v[72:75]
    v_exp_f32 v193, v193
    v_mfma_f32_16x16x32_bf16 v[76:79], a[156:159], v[208:211], v[76:79]
    v_exp_f32 v194, v194
    v_mfma_f32_16x16x32_bf16 v[80:83], a[160:163], v[208:211], v[80:83]
    v_exp_f32 v195, v195
    v_mfma_f32_16x16x32_bf16 v[84:87], a[164:167], v[208:211], v[84:87]
    v_mul_f32 v6, v6, v244
    v_mul_f32 v7, v7, v244
    v_mfma_f32_16x16x32_bf16 v[88:91], a[168:171], v[208:211], v[88:91]
    v_cvt_pk_bf16_f32 v0, v0, v1
    v_cvt_pk_bf16_f32 v1, v2, v3
    v_mfma_f32_16x16x32_bf16 v[92:95], a[172:175], v[208:211], v[92:95]
    s_waitcnt vmcnt(13)
    v_cvt_pk_bf16_f32 v2, v4, v5
    v_cvt_pk_bf16_f32 v3, v6, v7
    v_mfma_f32_16x16x32_bf16 a[224:227], a[240:243], v[208:211], a[224:227]
    s_barrier
    v_mul_f32 v8, v8, v244
    v_mul_f32 v9, v9, v244
    v_mfma_f32_16x16x32_bf16 v[200:203], a[96:99], a[56:59], v[236:239]
    v_cvt_pk_bf16_f32 v208, v192, v193
    v_cvt_pk_bf16_f32 v209, v194, v195
    v_mfma_f32_16x16x32_bf16 v[200:203], a[100:103], a[68:71], v[200:203]
    buffer_load_dwordx4 v252, s[20:23], s73 offen offset:1024 lds
    v_mfma_f32_16x16x32_bf16 v[200:203], a[104:107], a[80:83], v[200:203]
    s_add_u32 s73, s73, 7168
    v_exp_f32 v196, v196
    v_mfma_f32_16x16x32_bf16 v[200:203], a[108:111], a[92:95], v[200:203]
    v_exp_f32 v197, v197
    v_mfma_f32_16x16x32_bf16 v[204:207], a[112:115], a[56:59], v[236:239]
    v_exp_f32 v198, v198
    v_mfma_f32_16x16x32_bf16 v[204:207], a[116:119], a[68:71], v[204:207]
    v_exp_f32 v199, v199
    v_mfma_f32_16x16x32_bf16 v[204:207], a[120:123], a[80:83], v[204:207]
    v_cvt_pk_bf16_f32 v210, v196, v197
    v_cvt_pk_bf16_f32 v211, v198, v199
    v_mfma_f32_16x16x32_bf16 v[204:207], a[124:127], a[92:95], v[204:207]
    v_mul_f32 v10, v10, v244
    v_mul_f32 v11, v11, v244
    v_mfma_f32_16x16x32_bf16 v[96:99], a[144:147], v[212:215], v[96:99]
    v_exp_f32 v200, v200
    v_mfma_f32_16x16x32_bf16 v[100:103], a[148:151], v[212:215], v[100:103]
    v_exp_f32 v201, v201
    v_mfma_f32_16x16x32_bf16 v[104:107], a[152:155], v[212:215], v[104:107]
    v_exp_f32 v202, v202
    v_mfma_f32_16x16x32_bf16 v[108:111], a[156:159], v[212:215], v[108:111]
    v_exp_f32 v203, v203
    v_mfma_f32_16x16x32_bf16 v[112:115], a[160:163], v[212:215], v[112:115]
    buffer_load_dwordx4 v252, s[20:23], s73 offen offset:2048 lds
    v_mfma_f32_16x16x32_bf16 v[116:119], a[164:167], v[212:215], v[116:119]
    s_add_u32 s73, s73, 7168
    v_mul_f32 v12, v12, v244
    v_mul_f32 v13, v13, v244
    v_mfma_f32_16x16x32_bf16 v[120:123], a[168:171], v[212:215], v[120:123]
    v_mul_f32 v14, v14, v244
    v_mul_f32 v15, v15, v244
    v_mfma_f32_16x16x32_bf16 v[124:127], a[172:175], v[212:215], v[124:127]
    v_cvt_pk_bf16_f32 v8, v8, v9
    v_cvt_pk_bf16_f32 v9, v10, v11
    v_mfma_f32_16x16x32_bf16 a[228:231], a[240:243], v[212:215], a[228:231]
    v_cvt_pk_bf16_f32 v10, v12, v13
    v_cvt_pk_bf16_f32 v11, v14, v15
    v_mfma_f32_16x16x32_bf16 v[128:131], a[144:147], v[208:211], v[128:131]
    v_cvt_pk_bf16_f32 v212, v200, v201
    v_cvt_pk_bf16_f32 v213, v202, v203
    v_mfma_f32_16x16x32_bf16 v[132:135], a[148:151], v[208:211], v[132:135]
    v_exp_f32 v204, v204
    v_mfma_f32_16x16x32_bf16 v[136:139], a[152:155], v[208:211], v[136:139]
    v_exp_f32 v205, v205
    v_mfma_f32_16x16x32_bf16 v[140:143], a[156:159], v[208:211], v[140:143]
    v_exp_f32 v206, v206
    v_mfma_f32_16x16x32_bf16 v[144:147], a[160:163], v[208:211], v[144:147]
    v_exp_f32 v207, v207
    v_mfma_f32_16x16x32_bf16 v[148:151], a[164:167], v[208:211], v[148:151]
    buffer_load_dwordx4 v252, s[20:23], s73 offen offset:3072 lds
    v_mfma_f32_16x16x32_bf16 v[152:155], a[168:171], v[208:211], v[152:155]
    v_cvt_pk_bf16_f32 v214, v204, v205
    v_cvt_pk_bf16_f32 v215, v206, v207
    v_mfma_f32_16x16x32_bf16 v[156:159], a[172:175], v[208:211], v[156:159]
    v_accvgpr_read_b32 v245, a220
    v_cmp_nlt_f32_e64 vcc, v245, s79
    v_mfma_f32_16x16x32_bf16 a[232:235], a[240:243], v[208:211], a[232:235]
    v_rcp_f32 v245, v245
    s_or_b64 s[80:81], s[80:81], vcc
    v_mfma_f32_16x16x32_bf16 v[160:163], a[144:147], v[212:215], v[160:163]
    v_mul_f32 v32, v32, v245
    v_mul_f32 v33, v33, v245
    v_mfma_f32_16x16x32_bf16 v[164:167], a[148:151], v[212:215], v[164:167]
    ds_read_b64_tr_b16 a[192:193], v240 offset:8192
    v_mul_f32 v34, v34, v245
    v_mfma_f32_16x16x32_bf16 v[168:171], a[152:155], v[212:215], v[168:171]
    ds_read_b64_tr_b16 a[194:195], v240 offset:10240
    v_mul_f32 v35, v35, v245
    v_mfma_f32_16x16x32_bf16 v[172:175], a[156:159], v[212:215], v[172:175]
    ds_read_b64_tr_b16 a[196:197], v240 offset:12288
    v_mul_f32 v36, v36, v245
    v_mfma_f32_16x16x32_bf16 v[176:179], a[160:163], v[212:215], v[176:179]
    ds_read_b64_tr_b16 a[198:199], v240 offset:14336
    v_mul_f32 v37, v37, v245
    v_mfma_f32_16x16x32_bf16 v[180:183], a[164:167], v[212:215], v[180:183]
    ds_read_b64_tr_b16 a[200:201], v241 offset:8192
    v_mul_f32 v38, v38, v245
    v_mfma_f32_16x16x32_bf16 v[184:187], a[168:171], v[212:215], v[184:187]
    ds_read_b64_tr_b16 a[202:203], v241 offset:10240
    v_mul_f32 v39, v39, v245
    v_mfma_f32_16x16x32_bf16 v[188:191], a[172:175], v[212:215], v[188:191]
    ds_read_b64_tr_b16 a[204:205], v241 offset:12288
    v_cvt_pk_bf16_f32 v32, v32, v33
    v_mfma_f32_16x16x32_bf16 a[236:239], a[240:243], v[212:215], a[236:239]
    ds_read_b64_tr_b16 a[206:207], v241 offset:14336
    v_cvt_pk_bf16_f32 v33, v34, v35
    s_waitcnt lgkmcnt(6)
    v_mfma_f32_16x16x32_bf16 v[192:195], a[192:195], v[0:3], 0
    s_waitcnt lgkmcnt(4)
    ds_read_b64_tr_b16 a[208:209], v242 offset:8192
    v_cvt_pk_bf16_f32 v34, v36, v37
    v_cvt_pk_bf16_f32 v35, v38, v39
    v_mfma_f32_16x16x32_bf16 v[192:195], a[196:199], v[8:11], v[192:195]
    ds_read_b64_tr_b16 a[210:211], v242 offset:10240
    v_mul_f32 v40, v40, v245
    v_mul_f32 v41, v41, v245
    v_mul_f32 v42, v42, v245
    v_mul_f32 v43, v43, v245
    v_mul_f32 v44, v44, v245
    v_mul_f32 v45, v45, v245
    v_mul_f32 v46, v46, v245
    v_mul_f32 v47, v47, v245
    v_cvt_pk_bf16_f32 v40, v40, v41
    v_cvt_pk_bf16_f32 v41, v42, v43
    v_cvt_pk_bf16_f32 v42, v44, v45
    v_cvt_pk_bf16_f32 v43, v46, v47
    v_mfma_f32_16x16x32_bf16 v[196:199], a[192:195], v[32:35], 0
    ds_read_b64_tr_b16 a[212:213], v242 offset:12288
    v_accvgpr_read_b32 v246, a224
    v_cmp_nlt_f32_e64 vcc, v246, s79
    v_rcp_f32 v246, v246
    s_or_b64 s[80:81], s[80:81], vcc
    v_mul_f32 v64, v64, v246
    v_mul_f32 v65, v65, v246
    v_mul_f32 v66, v66, v246
    v_mul_f32 v67, v67, v246
    v_mul_f32 v68, v68, v246
    v_mul_f32 v69, v69, v246
    v_mul_f32 v70, v70, v246
    v_mul_f32 v71, v71, v246
    v_cvt_pk_bf16_f32 v64, v64, v65
    v_cvt_pk_bf16_f32 v65, v66, v67
    v_cvt_pk_bf16_f32 v66, v68, v69
    v_cvt_pk_bf16_f32 v67, v70, v71
    v_mfma_f32_16x16x32_bf16 v[196:199], a[196:199], v[40:43], v[196:199]
    ds_read_b64_tr_b16 a[214:215], v242 offset:14336
    v_mul_f32 v72, v72, v246
    v_mul_f32 v73, v73, v246
    v_mul_f32 v74, v74, v246
    v_mul_f32 v75, v75, v246
    v_mul_f32 v76, v76, v246
    v_mul_f32 v77, v77, v246
    v_mul_f32 v78, v78, v246
    v_mul_f32 v79, v79, v246
    v_cvt_pk_bf16_f32 v72, v72, v73
    v_cvt_pk_bf16_f32 v73, v74, v75
    v_cvt_pk_bf16_f32 v74, v76, v77
    v_cvt_pk_bf16_f32 v75, v78, v79
    v_mfma_f32_16x16x32_bf16 v[200:203], a[192:195], v[64:67], 0
    v_mul_f32 v16, v16, v244
    v_mul_f32 v17, v17, v244
    v_mfma_f32_16x16x32_bf16 v[200:203], a[196:199], v[72:75], v[200:203]
    s_waitcnt lgkmcnt(4)
    v_mul_f32 v18, v18, v244
    v_mul_f32 v19, v19, v244
    v_mfma_f32_16x16x32_bf16 v[204:207], a[200:203], v[0:3], 0
    ds_read_b64_tr_b16 a[192:193], v243 offset:8192
    ds_read_b64_tr_b16 a[194:195], v243 offset:10240
    v_mfma_f32_16x16x32_bf16 v[204:207], a[204:207], v[8:11], v[204:207]
    ds_write_b128 v250, v[0:3] offset:32768
    v_mfma_f32_16x16x32_bf16 v[208:211], a[200:203], v[32:35], 0
    s_xor_b32 s55, s76, 16777216
    ds_read_b64_tr_b16 a[196:197], v243 offset:12288
    v_mul_f32 v20, v20, v244
    v_mfma_f32_16x16x32_bf16 v[208:211], a[204:207], v[40:43], v[208:211]
    ds_read_b64_tr_b16 a[198:199], v243 offset:14336
    v_mul_f32 v21, v21, v244
    v_mfma_f32_16x16x32_bf16 v[212:215], a[200:203], v[64:67], 0
    v_mul_f32 v22, v22, v244
    v_mul_f32 v23, v23, v244
    v_mfma_f32_16x16x32_bf16 v[212:215], a[204:207], v[72:75], v[212:215]
    s_waitcnt lgkmcnt(5)
    v_cvt_pk_bf16_f32 v16, v16, v17
    v_cvt_pk_bf16_f32 v17, v18, v19
    v_mfma_f32_16x16x32_bf16 v[216:219], a[208:211], v[0:3], 0
    buffer_store_dwordx4 a[248:251], v253, s[24:27], s55 offen sc1
    v_mfma_f32_16x16x32_bf16 v[216:219], a[212:215], v[8:11], v[216:219]
    s_waitcnt vmcnt(9) lgkmcnt(0)
    v_cvt_pk_bf16_f32 v18, v20, v21
    v_cvt_pk_bf16_f32 v19, v22, v23
    v_mfma_f32_16x16x32_bf16 v[220:223], a[208:211], v[32:35], 0
    s_barrier
    ds_write_b128 v250, v[8:11] offset:35840
    v_mfma_f32_16x16x32_bf16 v[220:223], a[212:215], v[40:43], v[220:223]
    s_add_u32 m0, s70, 8192
    ds_read_b64_tr_b16 a[200:201], v240 offset:16384
    ds_read_b64_tr_b16 a[202:203], v240 offset:18432
    v_mfma_f32_16x16x32_bf16 v[224:227], a[208:211], v[64:67], 0
    s_xor_b32 s73, s72, 327680
    ds_read_b64_tr_b16 a[204:205], v240 offset:20480
    ds_read_b64_tr_b16 a[206:207], v240 offset:22528
    v_mfma_f32_16x16x32_bf16 v[224:227], a[212:215], v[72:75], v[224:227]
    buffer_load_dwordx4 v252, s[20:23], s73 offen offset:0 lds
    v_mfma_f32_16x16x32_bf16 v[228:231], a[192:195], v[0:3], 0
    s_add_u32 s73, s73, 7168
    ds_read_b64_tr_b16 a[208:209], v241 offset:16384
    v_mul_f32 v48, v48, v245
    v_mfma_f32_16x16x32_bf16 v[228:231], a[196:199], v[8:11], v[228:231]
    ds_read_b64_tr_b16 a[210:211], v241 offset:18432
    v_mul_f32 v49, v49, v245
    v_mfma_f32_16x16x32_bf16 v[232:235], a[192:195], v[32:35], 0
    ds_read_b64_tr_b16 a[212:213], v241 offset:20480
    v_mul_f32 v50, v50, v245
    v_mfma_f32_16x16x32_bf16 v[232:235], a[196:199], v[40:43], v[232:235]
    ds_read_b64_tr_b16 a[214:215], v241 offset:22528
    v_mul_f32 v51, v51, v245
    v_mfma_f32_16x16x32_bf16 v[236:239], a[192:195], v[64:67], 0
    ds_write_b128 v250, v[32:35] offset:33792
    v_mfma_f32_16x16x32_bf16 v[236:239], a[196:199], v[72:75], v[236:239]
    s_waitcnt lgkmcnt(5)
    buffer_load_dwordx4 v252, s[20:23], s73 offen offset:1024 lds
    v_mfma_f32_16x16x32_bf16 v[4:7], a[200:203], v[0:3], 0
    s_add_u32 s73, s73, 7168
    ds_read_b64_tr_b16 a[192:193], v242 offset:16384
    v_mul_f32 v52, v52, v245
    v_mfma_f32_16x16x32_bf16 v[4:7], a[204:207], v[8:11], v[4:7]
L_hopa_10:
    s_cbranch_execz L_backa
    ds_read_b64_tr_b16 a[194:195], v242 offset:18432
    v_mul_f32 v53, v53, v245
    v_mfma_f32_16x16x32_bf16 v[36:39], a[200:203], v[32:35], 0
    ds_read_b64_tr_b16 a[196:197], v242 offset:20480
    v_mul_f32 v54, v54, v245
    v_mfma_f32_16x16x32_bf16 v[36:39], a[204:207], v[40:43], v[36:39]
    ds_read_b64_tr_b16 a[198:199], v242 offset:22528
    v_mul_f32 v55, v55, v245
    v_mfma_f32_16x16x32_bf16 v[68:71], a[200:203], v[64:67], 0
    v_cvt_pk_bf16_f32 v48, v48, v49
    v_cvt_pk_bf16_f32 v49, v50, v51
    v_mfma_f32_16x16x32_bf16 v[68:71], a[204:207], v[72:75], v[68:71]
    s_waitcnt lgkmcnt(5)
    buffer_load_dwordx4 v252, s[20:23], s73 offen offset:2048 lds
    v_mfma_f32_16x16x32_bf16 v[12:15], a[208:211], v[0:3], 0
    s_add_u32 s73, s73, 7168
    ds_write_b128 v250, v[40:43] offset:36864
    v_mfma_f32_16x16x32_bf16 v[12:15], a[212:215], v[8:11], v[12:15]
    ds_read_b64_tr_b16 a[200:201], v243 offset:16384
    ds_read_b64_tr_b16 a[202:203], v243 offset:18432
    v_mfma_f32_16x16x32_bf16 v[44:47], a[208:211], v[32:35], 0
    ds_read_b64_tr_b16 a[204:205], v243 offset:20480
    v_cvt_pk_bf16_f32 v50, v52, v53
    v_mfma_f32_16x16x32_bf16 v[44:47], a[212:215], v[40:43], v[44:47]
    s_xor_b32 s55, s76, 17825792
    ds_read_b64_tr_b16 a[206:207], v243 offset:22528
    v_cvt_pk_bf16_f32 v51, v54, v55
    v_mfma_f32_16x16x32_bf16 v[76:79], a[208:211], v[64:67], 0
    v_mul_f32 v80, v80, v246
    v_mul_f32 v81, v81, v246
    v_mfma_f32_16x16x32_bf16 v[76:79], a[212:215], v[72:75], v[76:79]
    s_waitcnt lgkmcnt(5)
    buffer_load_dwordx4 v252, s[20:23], s73 offen offset:3072 lds
    v_mfma_f32_16x16x32_bf16 v[20:23], a[192:195], v[0:3], 0
    ds_write_b128 v250, v[64:67] offset:34816
    v_mfma_f32_16x16x32_bf16 v[20:23], a[196:199], v[8:11], v[20:23]
    s_waitcnt vmcnt(9) lgkmcnt(1)
    buffer_store_dwordx4 a[248:251], v253, s[24:27], s55 offen sc1
    v_mfma_f32_16x16x32_bf16 v[52:55], a[192:195], v[32:35], 0
    s_barrier
    ds_read_b64_tr_b16 a[208:209], v240 offset:57344
    ds_read_b64_tr_b16 a[210:211], v240 offset:59392
    v_mul_f32 v82, v82, v246
    v_mul_f32 v83, v83, v246
    v_mul_f32 v84, v84, v246
    v_mul_f32 v85, v85, v246
    v_mul_f32 v86, v86, v246
    v_mul_f32 v87, v87, v246
    v_cvt_pk_bf16_f32 v80, v80, v81
    v_cvt_pk_bf16_f32 v81, v82, v83
    v_cvt_pk_bf16_f32 v82, v84, v85
    v_cvt_pk_bf16_f32 v83, v86, v87
    v_mfma_f32_16x16x32_bf16 v[52:55], a[196:199], v[40:43], v[52:55]
    s_add_u32 m0, s70, 16384
    ds_read_b64_tr_b16 a[212:213], v240 offset:61440
    v_mul_f32 v24, v24, v244
    v_mfma_f32_16x16x32_bf16 v[84:87], a[192:195], v[64:67], 0
    s_xor_b32 s73, s72, 131072
    ds_read_b64_tr_b16 a[214:215], v240 offset:63488
    v_mul_f32 v25, v25, v244
    v_mul_f32 v26, v26, v244
    v_mul_f32 v27, v27, v244
    v_mul_f32 v28, v28, v244
    v_mul_f32 v29, v29, v244
    v_mul_f32 v30, v30, v244
    v_mul_f32 v31, v31, v244
    v_cvt_pk_bf16_f32 v24, v24, v25
    v_cvt_pk_bf16_f32 v25, v26, v27
    v_cvt_pk_bf16_f32 v26, v28, v29
    v_cvt_pk_bf16_f32 v27, v30, v31
    v_mfma_f32_16x16x32_bf16 v[84:87], a[196:199], v[72:75], v[84:87]
    buffer_load_dwordx4 v252, s[20:23], s73 offen offset:0 lds
    v_mfma_f32_16x16x32_bf16 v[28:31], a[200:203], v[0:3], 0
    s_add_u32 s73, s73, 7168
    ds_read_b64_tr_b16 a[192:193], v241 offset:57344
    ds_read_b64_tr_b16 a[194:195], v241 offset:59392
    v_mul_f32 v56, v56, v245
    v_mul_f32 v57, v57, v245
    v_mul_f32 v58, v58, v245
    v_mul_f32 v59, v59, v245
    v_mul_f32 v60, v60, v245
    v_mul_f32 v61, v61, v245
    v_mul_f32 v62, v62, v245
    v_mul_f32 v63, v63, v245
    v_cvt_pk_bf16_f32 v56, v56, v57
    v_cvt_pk_bf16_f32 v57, v58, v59
    v_cvt_pk_bf16_f32 v58, v60, v61
    v_cvt_pk_bf16_f32 v59, v62, v63
    v_mfma_f32_16x16x32_bf16 v[28:31], a[204:207], v[8:11], v[28:31]
    ds_write_b128 v250, v[72:75] offset:37888
    v_mfma_f32_16x16x32_bf16 v[60:63], a[200:203], v[32:35], 0
    ds_read_b64_tr_b16 a[196:197], v241 offset:61440
    v_mul_f32 v88, v88, v246
    v_mul_f32 v89, v89, v246
    v_mul_f32 v90, v90, v246
    v_mul_f32 v91, v91, v246
    v_mul_f32 v92, v92, v246
    v_mul_f32 v93, v93, v246
    v_mul_f32 v94, v94, v246
    v_mul_f32 v95, v95, v246
    v_cvt_pk_bf16_f32 v88, v88, v89
    v_cvt_pk_bf16_f32 v89, v90, v91
    v_cvt_pk_bf16_f32 v90, v92, v93
    v_cvt_pk_bf16_f32 v91, v94, v95
    v_mfma_f32_16x16x32_bf16 v[60:63], a[204:207], v[40:43], v[60:63]
    ds_read_b64_tr_b16 a[198:199], v241 offset:63488
    v_accvgpr_read_b32 v247, a228
    v_mfma_f32_16x16x32_bf16 v[92:95], a[200:203], v[64:67], 0
    ds_write_b128 v250, v[16:19] offset:0
    v_mfma_f32_16x16x32_bf16 v[92:95], a[204:207], v[72:75], v[92:95]
    s_waitcnt lgkmcnt(6)
    buffer_load_dwordx4 v252, s[20:23], s73 offen offset:1024 lds
    v_mfma_f32_16x16x32_bf16 v[192:195], a[208:211], v[16:19], v[192:195]
    s_add_u32 s73, s73, 7168
    ds_read_b64_tr_b16 a[200:201], v242 offset:57344
    v_cmp_nlt_f32_e64 vcc, v247, s79
    v_mfma_f32_16x16x32_bf16 v[192:195], a[212:215], v[24:27], v[192:195]
    ds_read_b64_tr_b16 a[202:203], v242 offset:59392
    v_mfma_f32_16x16x32_bf16 v[196:199], a[208:211], v[48:51], v[196:199]
    ds_read_b64_tr_b16 a[204:205], v242 offset:61440
    v_mfma_f32_16x16x32_bf16 v[196:199], a[212:215], v[56:59], v[196:199]
    ds_read_b64_tr_b16 a[206:207], v242 offset:63488
    v_mfma_f32_16x16x32_bf16 v[200:203], a[208:211], v[80:83], v[200:203]
    ds_write_b128 v250, v[48:51] offset:1024
    v_mfma_f32_16x16x32_bf16 v[200:203], a[212:215], v[88:91], v[200:203]
    s_waitcnt lgkmcnt(6)
    buffer_load_dwordx4 v252, s[20:23], s73 offen offset:2048 lds
    v_mfma_f32_16x16x32_bf16 v[204:207], a[192:195], v[16:19], v[204:207]
    s_add_u32 s73, s73, 7168
    ds_read_b64_tr_b16 a[208:209], v243 offset:57344
    v_mfma_f32_16x16x32_bf16 v[204:207], a[196:199], v[24:27], v[204:207]
    ds_read_b64_tr_b16 a[210:211], v243 offset:59392
    v_mfma_f32_16x16x32_bf16 v[208:211], a[192:195], v[48:51], v[208:211]
    ds_read_b64_tr_b16 a[212:213], v243 offset:61440
    v_mfma_f32_16x16x32_bf16 v[208:211], a[196:199], v[56:59], v[208:211]
    s_xor_b32 s55, s76, 18874368
    ds_read_b64_tr_b16 a[214:215], v243 offset:63488
    v_mfma_f32_16x16x32_bf16 v[212:215], a[192:195], v[80:83], v[212:215]
    v_rcp_f32 v247, v247
    s_or_b64 s[80:81], s[80:81], vcc
    v_mfma_f32_16x16x32_bf16 v[212:215], a[196:199], v[88:91], v[212:215]
    s_waitcnt lgkmcnt(5)
    buffer_load_dwordx4 v252, s[20:23], s73 offen offset:3072 lds
    v_mfma_f32_16x16x32_bf16 v[216:219], a[200:203], v[16:19], v[216:219]
    ds_write_b128 v250, v[80:83] offset:2048
    v_mfma_f32_16x16x32_bf16 v[216:219], a[204:207], v[24:27], v[216:219]
    s_waitcnt vmcnt(10) lgkmcnt(1)
    buffer_store_dwordx4 a[248:251], v253, s[24:27], s55 offen sc1
    v_mfma_f32_16x16x32_bf16 v[220:223], a[200:203], v[48:51], v[220:223]
    s_barrier
    ds_read_b64_tr_b16 a[192:193], v240 offset:24576
    ds_read_b64_tr_b16 a[194:195], v240 offset:26624
    v_mfma_f32_16x16x32_bf16 v[220:223], a[204:207], v[56:59], v[220:223]
    s_add_u32 m0, s70, 57344
    ds_read_b64_tr_b16 a[196:197], v240 offset:28672
    v_mul_f32 v96, v96, v247
    v_mfma_f32_16x16x32_bf16 v[224:227], a[200:203], v[80:83], v[224:227]
    s_xor_b32 s73, s72, 196608
    ds_read_b64_tr_b16 a[198:199], v240 offset:30720
    ds_read_b128 a[96:99], v251 offset:32768
    v_mfma_f32_16x16x32_bf16 v[224:227], a[204:207], v[88:91], v[224:227]
    buffer_load_dwordx4 v252, s[20:23], s73 offen offset:0 lds
    v_mfma_f32_16x16x32_bf16 v[228:231], a[208:211], v[16:19], v[228:231]
    s_add_u32 s73, s73, 7168
    ds_write_b128 v250, v[24:27] offset:3072
    v_mfma_f32_16x16x32_bf16 v[228:231], a[212:215], v[24:27], v[228:231]
    ds_read_b64_tr_b16 a[200:201], v241 offset:24576
    v_mul_f32 v97, v97, v247
    v_mfma_f32_16x16x32_bf16 v[232:235], a[208:211], v[48:51], v[232:235]
    ds_read_b64_tr_b16 a[202:203], v241 offset:26624
    ds_read_b128 a[108:111], v251 offset:35840
    v_mfma_f32_16x16x32_bf16 v[232:235], a[212:215], v[56:59], v[232:235]
    ds_read_b64_tr_b16 a[204:205], v241 offset:28672
    v_mul_f32 v98, v98, v247
    v_mfma_f32_16x16x32_bf16 v[236:239], a[208:211], v[80:83], v[236:239]
    ds_read_b64_tr_b16 a[206:207], v241 offset:30720
    v_mul_f32 v99, v99, v247
    v_mfma_f32_16x16x32_bf16 v[236:239], a[212:215], v[88:91], v[236:239]
    s_waitcnt lgkmcnt(7)
    buffer_load_dwordx4 v252, s[20:23], s73 offen offset:1024 lds
    v_mfma_f32_16x16x32_bf16 v[4:7], a[192:195], v[16:19], v[4:7]
    s_add_u32 s73, s73, 7168
    ds_write_b128 v250, v[56:59] offset:4096
    v_mfma_f32_16x16x32_bf16 v[4:7], a[196:199], v[24:27], v[4:7]
    ds_read_b64_tr_b16 a[208:209], v242 offset:24576
    ds_read_b128 a[100:103], v251 offset:33792
    v_mfma_f32_16x16x32_bf16 v[36:39], a[192:195], v[48:51], v[36:39]
    ds_read_b64_tr_b16 a[210:211], v242 offset:26624
    v_mul_f32 v100, v100, v247
    v_mfma_f32_16x16x32_bf16 v[36:39], a[196:199], v[56:59], v[36:39]
    ds_read_b64_tr_b16 a[212:213], v242 offset:28672
    v_mul_f32 v101, v101, v247
    v_mfma_f32_16x16x32_bf16 v[68:71], a[192:195], v[80:83], v[68:71]
    ds_read_b64_tr_b16 a[214:215], v242 offset:30720
    ds_read_b128 a[112:115], v251 offset:36864
    v_mfma_f32_16x16x32_bf16 v[68:71], a[196:199], v[88:91], v[68:71]
    s_waitcnt lgkmcnt(7)
    buffer_load_dwordx4 v252, s[20:23], s73 offen offset:2048 lds
    v_mfma_f32_16x16x32_bf16 v[12:15], a[200:203], v[16:19], v[12:15]
    s_add_u32 s73, s73, 7168
    ds_read_b64_tr_b16 a[192:193], v243 offset:24576
    ds_read_b64_tr_b16 a[194:195], v243 offset:26624
    v_mfma_f32_16x16x32_bf16 v[12:15], a[204:207], v[24:27], v[12:15]
    ds_write_b128 v250, v[88:91] offset:5120
    v_mfma_f32_16x16x32_bf16 v[44:47], a[200:203], v[48:51], v[44:47]
    s_xor_b32 s55, s76, 20971520
    ds_read_b64_tr_b16 a[196:197], v243 offset:28672
    ds_read_b128 a[104:107], v251 offset:34816
    v_mfma_f32_16x16x32_bf16 v[44:47], a[204:207], v[56:59], v[44:47]
    ds_read_b64_tr_b16 a[198:199], v243 offset:30720
    v_mul_f32 v102, v102, v247
    v_mfma_f32_16x16x32_bf16 v[76:79], a[200:203], v[80:83], v[76:79]
    v_mul_f32 v103, v103, v247
    v_cvt_pk_bf16_f32 v96, v96, v97
    v_mfma_f32_16x16x32_bf16 v[76:79], a[204:207], v[88:91], v[76:79]
    s_waitcnt lgkmcnt(7)
    buffer_load_dwordx4 v252, s[20:23], s73 offen offset:3072 lds
    v_mfma_f32_16x16x32_bf16 v[20:23], a[208:211], v[16:19], v[20:23]
    buffer_store_dwordx4 a[248:251], v253, s[24:27], s55 offen sc1
    v_mfma_f32_16x16x32_bf16 v[20:23], a[212:215], v[24:27], v[20:23]
    s_waitcnt lgkmcnt(0)
    ds_read_b128 a[116:119], v251 offset:37888
    v_cvt_pk_bf16_f32 v97, v98, v99
    v_mfma_f32_16x16x32_bf16 v[52:55], a[208:211], v[48:51], v[52:55]
    s_barrier
    ds_read_b64_tr_b16 a[200:201], v240 offset:49152
    ds_read_b64_tr_b16 a[202:203], v240 offset:51200
    v_mfma_f32_16x16x32_bf16 v[52:55], a[212:215], v[56:59], v[52:55]
    s_add_u32 m0, s70, 24576
    ds_read_b64_tr_b16 a[204:205], v240 offset:53248
    v_cvt_pk_bf16_f32 v98, v100, v101
    v_mfma_f32_16x16x32_bf16 v[84:87], a[208:211], v[80:83], v[84:87]
    s_xor_b32 s73, s72, 393216
    ds_read_b64_tr_b16 a[206:207], v240 offset:55296
    v_cvt_pk_bf16_f32 v99, v102, v103
    v_mfma_f32_16x16x32_bf16 v[84:87], a[212:215], v[88:91], v[84:87]
    buffer_load_dwordx4 v252, s[20:23], s73 offen offset:0 lds
    v_mfma_f32_16x16x32_bf16 v[28:31], a[192:195], v[16:19], v[28:31]
    s_add_u32 s73, s73, 7168
    ds_read_b64_tr_b16 a[208:209], v241 offset:49152
    ds_read_b128 a[120:123], v251 offset:0
    v_mfma_f32_16x16x32_bf16 v[28:31], a[196:199], v[24:27], v[28:31]
    ds_read_b64_tr_b16 a[210:211], v241 offset:51200
    v_mul_f32 v104, v104, v247
    v_mfma_f32_16x16x32_bf16 v[60:63], a[192:195], v[48:51], v[60:63]
    ds_read_b64_tr_b16 a[212:213], v241 offset:53248
    ds_read_b128 a[132:135], v251 offset:3072
    v_mfma_f32_16x16x32_bf16 v[60:63], a[196:199], v[56:59], v[60:63]
    ds_read_b64_tr_b16 a[214:215], v241 offset:55296
    v_mul_f32 v105, v105, v247
    v_mfma_f32_16x16x32_bf16 v[92:95], a[192:195], v[80:83], v[92:95]
    v_mul_f32 v106, v106, v247
    v_mul_f32 v107, v107, v247
    v_mfma_f32_16x16x32_bf16 v[92:95], a[196:199], v[88:91], v[92:95]
    s_waitcnt lgkmcnt(6)
    buffer_load_dwordx4 v252, s[20:23], s73 offen offset:1024 lds
    v_mfma_f32_16x16x32_bf16 v[192:195], a[200:203], a[96:99], v[192:195]
    s_add_u32 s73, s73, 7168
    ds_read_b64_tr_b16 a[192:193], v242 offset:49152
    ds_read_b128 a[124:127], v251 offset:1024
    v_mfma_f32_16x16x32_bf16 v[192:195], a[204:207], a[108:111], v[192:195]
    ds_read_b64_tr_b16 a[194:195], v242 offset:51200
    v_mul_f32 v108, v108, v247
    v_mfma_f32_16x16x32_bf16 v[196:199], a[200:203], a[100:103], v[196:199]
    ds_read_b64_tr_b16 a[196:197], v242 offset:53248
    v_mul_f32 v109, v109, v247
    v_mfma_f32_16x16x32_bf16 v[196:199], a[204:207], a[112:115], v[196:199]
    ds_read_b64_tr_b16 a[198:199], v242 offset:55296
    v_mul_f32 v110, v110, v247
    v_mfma_f32_16x16x32_bf16 v[200:203], a[200:203], a[104:107], v[200:203]
    ds_read_b128 a[136:139], v251 offset:4096
    v_mul_f32 v111, v111, v247
    v_mfma_f32_16x16x32_bf16 v[200:203], a[204:207], a[116:119], v[200:203]
    s_waitcnt lgkmcnt(6)
    buffer_load_dwordx4 v252, s[20:23], s73 offen offset:2048 lds
    v_mfma_f32_16x16x32_bf16 v[204:207], a[208:211], a[96:99], v[204:207]
    s_add_u32 s73, s73, 7168
    ds_read_b64_tr_b16 a[200:201], v243 offset:49152
    v_cvt_pk_bf16_f32 v104, v104, v105
    v_mfma_f32_16x16x32_bf16 v[204:207], a[212:215], a[108:111], v[204:207]
    ds_read_b64_tr_b16 a[202:203], v243 offset:51200
    v_cvt_pk_bf16_f32 v105, v106, v107
    v_mfma_f32_16x16x32_bf16 v[208:211], a[208:211], a[100:103], v[208:211]
    s_xor_b32 s55, s76, 22020096
    ds_read_b64_tr_b16 a[204:205], v243 offset:53248
    ds_read_b128 a[128:131], v251 offset:2048
    v_mfma_f32_16x16x32_bf16 v[208:211], a[212:215], a[112:115], v[208:211]
    ds_read_b64_tr_b16 a[206:207], v243 offset:55296
    v_cvt_pk_bf16_f32 v106, v108, v109
    v_mfma_f32_16x16x32_bf16 v[212:215], a[208:211], a[104:107], v[212:215]
    v_cvt_pk_bf16_f32 v107, v110, v111
    v_accvgpr_read_b32 v248, a232
    v_mfma_f32_16x16x32_bf16 v[212:215], a[212:215], a[116:119], v[212:215]
    s_waitcnt lgkmcnt(6)
    buffer_load_dwordx4 v252, s[20:23], s73 offen offset:3072 lds
    v_mfma_f32_16x16x32_bf16 v[216:219], a[192:195], a[96:99], v[216:219]
    buffer_store_dwordx4 a[248:251], v253, s[24:27], s55 offen sc1
    v_mfma_f32_16x16x32_bf16 v[216:219], a[196:199], a[108:111], v[216:219]
    s_waitcnt vmcnt(16) lgkmcnt(0)
    ds_read_b128 a[140:143], v251 offset:5120
    v_cmp_nlt_f32_e64 vcc, v248, s79
    v_mfma_f32_16x16x32_bf16 v[220:223], a[192:195], a[100:103], v[220:223]
    s_barrier
    ds_read_b64_tr_b16 a[208:209], v240 offset:8192
    ds_read_b64_tr_b16 a[210:211], v240 offset:10240
    v_mfma_f32_16x16x32_bf16 v[220:223], a[196:199], a[112:115], v[220:223]
    s_add_u32 m0, s70, 49152
    ds_read_b64_tr_b16 a[212:213], v240 offset:12288
    v_mfma_f32_16x16x32_bf16 v[224:227], a[192:195], a[104:107], v[224:227]
    s_xor_b32 s73, s72, 458752
    ds_read_b64_tr_b16 a[214:215], v240 offset:14336
    v_mfma_f32_16x16x32_bf16 v[224:227], a[196:199], a[116:119], v[224:227]
    buffer_load_dwordx4 v252, s[20:23], s73 offen offset:0 lds
    v_mfma_f32_16x16x32_bf16 v[228:231], a[200:203], a[96:99], v[228:231]
    s_add_u32 s73, s73, 7168
    ds_write_b128 v250, v[96:99] offset:32768
    v_mfma_f32_16x16x32_bf16 v[228:231], a[204:207], a[108:111], v[228:231]
    ds_read_b64_tr_b16 a[192:193], v241 offset:8192
    v_mfma_f32_16x16x32_bf16 v[232:235], a[200:203], a[100:103], v[232:235]
    ds_read_b64_tr_b16 a[194:195], v241 offset:10240
    v_mfma_f32_16x16x32_bf16 v[232:235], a[204:207], a[112:115], v[232:235]
    ds_read_b64_tr_b16 a[196:197], v241 offset:12288
    v_mfma_f32_16x16x32_bf16 v[236:239], a[200:203], a[104:107], v[236:239]
    ds_read_b64_tr_b16 a[198:199], v241 offset:14336
    v_mfma_f32_16x16x32_bf16 v[236:239], a[204:207], a[116:119], v[236:239]
    s_waitcnt lgkmcnt(5)
    buffer_load_dwordx4 v252, s[20:23], s73 offen offset:1024 lds
    v_mfma_f32_16x16x32_bf16 v[192:195], a[208:211], a[120:123], v[192:195]
    s_add_u32 s73, s73, 7168
    ds_write_b128 v250, v[104:107] offset:35840
    v_mfma_f32_16x16x32_bf16 v[192:195], a[212:215], a[132:135], v[192:195]
    ds_read_b64_tr_b16 a[200:201], v242 offset:8192
    ds_read_b64_tr_b16 a[202:203], v242 offset:10240
    v_mfma_f32_16x16x32_bf16 v[196:199], a[208:211], a[124:127], v[196:199]
    ds_read_b64_tr_b16 a[204:205], v242 offset:12288
    v_mfma_f32_16x16x32_bf16 v[196:199], a[212:215], a[136:139], v[196:199]
    ds_read_b64_tr_b16 a[206:207], v242 offset:14336
    v_rcp_f32 v248, v248
    s_or_b64 s[80:81], s[80:81], vcc
    v_mul_f32 v128, v128, v248
    v_mul_f32 v129, v129, v248
    v_mul_f32 v130, v130, v248
    v_mul_f32 v131, v131, v248
    v_mul_f32 v132, v132, v248
    v_mul_f32 v133, v133, v248
    v_mul_f32 v134, v134, v248
    v_mul_f32 v135, v135, v248
    v_cvt_pk_bf16_f32 v128, v128, v129
    v_cvt_pk_bf16_f32 v129, v130, v131
    v_cvt_pk_bf16_f32 v130, v132, v133
    v_cvt_pk_bf16_f32 v131, v134, v135
    v_mfma_f32_16x16x32_bf16 v[200:203], a[208:211], a[128:131], v[200:203]
    ds_write_b128 v250, v[128:131] offset:33792
    v_mfma_f32_16x16x32_bf16 v[200:203], a[212:215], a[140:143], v[200:203]
    s_waitcnt lgkmcnt(6)
    buffer_load_dwordx4 v252, s[20:23], s73 offen offset:2048 lds
    v_mfma_f32_16x16x32_bf16 v[204:207], a[192:195], a[120:123], v[204:207]
    s_add_u32 s73, s73, 7168
    ds_read_b64_tr_b16 a[208:209], v243 offset:8192
    v_mul_f32 v136, v136, v248
    v_mfma_f32_16x16x32_bf16 v[204:207], a[196:199], a[132:135], v[204:207]
    ds_read_b64_tr_b16 a[210:211], v243 offset:10240
    v_mul_f32 v137, v137, v248
    v_mfma_f32_16x16x32_bf16 v[208:211], a[192:195], a[124:127], v[208:211]
    s_xor_b32 s55, s76, 23068672
    ds_read_b64_tr_b16 a[212:213], v243 offset:12288
    v_mul_f32 v138, v138, v248
    v_mfma_f32_16x16x32_bf16 v[208:211], a[196:199], a[136:139], v[208:211]
    ds_read_b64_tr_b16 a[214:215], v243 offset:14336
    v_mul_f32 v139, v139, v248
    v_mul_f32 v140, v140, v248
    v_mul_f32 v141, v141, v248
    v_mul_f32 v142, v142, v248
    v_mul_f32 v143, v143, v248
    v_cvt_pk_bf16_f32 v136, v136, v137
    v_cvt_pk_bf16_f32 v137, v138, v139
    v_cvt_pk_bf16_f32 v138, v140, v141
    v_cvt_pk_bf16_f32 v139, v142, v143
    v_mfma_f32_16x16x32_bf16 v[212:215], a[192:195], a[128:131], v[212:215]
    ds_write_b128 v250, v[136:139] offset:36864
    v_mfma_f32_16x16x32_bf16 v[212:215], a[196:199], a[140:143], v[212:215]
    s_waitcnt lgkmcnt(6)
    buffer_load_dwordx4 v252, s[20:23], s73 offen offset:3072 lds
    v_mfma_f32_16x16x32_bf16 v[216:219], a[200:203], a[120:123], v[216:219]
    buffer_store_dwordx4 a[248:251], v253, s[24:27], s55 offen sc1
    v_mfma_f32_16x16x32_bf16 v[216:219], a[204:207], a[132:135], v[216:219]
    s_waitcnt vmcnt(16) lgkmcnt(1)
    v_accvgpr_read_b32 v249, a236
    v_cmp_nlt_f32_e64 vcc, v249, s79
    v_mfma_f32_16x16x32_bf16 v[220:223], a[200:203], a[124:127], v[220:223]
    s_barrier
    ds_read_b64_tr_b16 a[192:193], v240 offset:16384
    ds_read_b64_tr_b16 a[194:195], v240 offset:18432
    v_mfma_f32_16x16x32_bf16 v[220:223], a[204:207], a[136:139], v[220:223]
    s_add_u32 m0, s70, 8192
    ds_read_b64_tr_b16 a[196:197], v240 offset:20480
    ds_read_b64_tr_b16 a[198:199], v240 offset:22528
    v_rcp_f32 v249, v249
    s_or_b64 s[80:81], s[80:81], vcc
    v_mul_f32 v160, v160, v249
    v_mul_f32 v161, v161, v249
    v_mul_f32 v162, v162, v249
    v_mul_f32 v163, v163, v249
    v_mul_f32 v164, v164, v249
    v_mul_f32 v165, v165, v249
    v_mul_f32 v166, v166, v249
    v_mul_f32 v167, v167, v249
    v_cvt_pk_bf16_f32 v160, v160, v161
    v_cvt_pk_bf16_f32 v161, v162, v163
    v_cvt_pk_bf16_f32 v162, v164, v165
    v_cvt_pk_bf16_f32 v163, v166, v167
    v_mfma_f32_16x16x32_bf16 v[224:227], a[200:203], a[128:131], v[224:227]
    s_xor_b32 s73, s72, 262272
    ds_write_b128 v250, v[160:163] offset:34816
    v_mfma_f32_16x16x32_bf16 v[224:227], a[204:207], a[140:143], v[224:227]
    buffer_load_dwordx4 v252, s[20:23], s73 offen offset:0 lds
    v_mfma_f32_16x16x32_bf16 v[228:231], a[208:211], a[120:123], v[228:231]
    s_add_u32 s73, s73, 7168
    ds_read_b64_tr_b16 a[200:201], v241 offset:16384
    v_mul_f32 v168, v168, v249
    v_mfma_f32_16x16x32_bf16 v[228:231], a[212:215], a[132:135], v[228:231]
    ds_read_b64_tr_b16 a[202:203], v241 offset:18432
    v_mul_f32 v169, v169, v249
    v_mfma_f32_16x16x32_bf16 v[232:235], a[208:211], a[124:127], v[232:235]
    ds_read_b64_tr_b16 a[204:205], v241 offset:20480
    v_mul_f32 v170, v170, v249
    v_mfma_f32_16x16x32_bf16 v[232:235], a[212:215], a[136:139], v[232:235]
    ds_read_b64_tr_b16 a[206:207], v241 offset:22528
    v_mul_f32 v171, v171, v249
    v_mul_f32 v172, v172, v249
    v_mul_f32 v173, v173, v249
    v_mul_f32 v174, v174, v249
    v_mul_f32 v175, v175, v249
    v_cvt_pk_bf16_f32 v168, v168, v169
    v_cvt_pk_bf16_f32 v169, v170, v171
    v_cvt_pk_bf16_f32 v170, v172, v173
    v_cvt_pk_bf16_f32 v171, v174, v175
    v_mfma_f32_16x16x32_bf16 v[236:239], a[208:211], a[128:131], v[236:239]
    ds_write_b128 v250, v[168:171] offset:37888
    v_mfma_f32_16x16x32_bf16 v[236:239], a[212:215], a[140:143], v[236:239]
    s_waitcnt lgkmcnt(6)
    buffer_load_dwordx4 v252, s[20:23], s73 offen offset:1024 lds
    v_mul_f32 v112, v112, v247
    v_mul_f32 v113, v113, v247
    v_mul_f32 v114, v114, v247
    v_mul_f32 v115, v115, v247
    v_mul_f32 v116, v116, v247
    v_mul_f32 v117, v117, v247
    v_mul_f32 v118, v118, v247
    v_mul_f32 v119, v119, v247
    v_cvt_pk_bf16_f32 v112, v112, v113
    v_cvt_pk_bf16_f32 v113, v114, v115
    v_cvt_pk_bf16_f32 v114, v116, v117
    v_cvt_pk_bf16_f32 v115, v118, v119
    v_mfma_f32_16x16x32_bf16 v[192:195], a[192:195], v[96:99], v[192:195]
    s_add_u32 s73, s73, 7168
    ds_write_b128 v250, v[112:115] offset:0
    v_mfma_f32_16x16x32_bf16 v[192:195], a[196:199], v[104:107], v[192:195]
    ds_read_b64_tr_b16 a[208:209], v242 offset:16384
    v_mul_f32 v120, v120, v247
    v_mfma_f32_16x16x32_bf16 v[196:199], a[192:195], v[128:131], v[196:199]
    ds_read_b64_tr_b16 a[210:211], v242 offset:18432
    v_mul_f32 v121, v121, v247
    v_mfma_f32_16x16x32_bf16 v[196:199], a[196:199], v[136:139], v[196:199]
    ds_read_b64_tr_b16 a[212:213], v242 offset:20480
    v_mul_f32 v122, v122, v247
    v_mfma_f32_16x16x32_bf16 v[200:203], a[192:195], v[160:163], v[200:203]
    ds_read_b64_tr_b16 a[214:215], v242 offset:22528
    v_mul_f32 v123, v123, v247
    v_mfma_f32_16x16x32_bf16 v[200:203], a[196:199], v[168:171], v[200:203]
    s_waitcnt lgkmcnt(6)
    buffer_load_dwordx4 v252, s[20:23], s73 offen offset:2048 lds
    v_mul_f32 v124, v124, v247
    v_mul_f32 v125, v125, v247
    v_mul_f32 v126, v126, v247
    v_mul_f32 v127, v127, v247
    v_cvt_pk_bf16_f32 v120, v120, v121
    v_cvt_pk_bf16_f32 v121, v122, v123
    v_cvt_pk_bf16_f32 v122, v124, v125
    v_cvt_pk_bf16_f32 v123, v126, v127
    v_mfma_f32_16x16x32_bf16 v[204:207], a[200:203], v[96:99], v[204:207]
    s_add_u32 s73, s73, 7168
    ds_write_b128 v250, v[120:123] offset:3072
    v_mfma_f32_16x16x32_bf16 v[204:207], a[204:207], v[104:107], v[204:207]
    ds_read_b64_tr_b16 a[192:193], v243 offset:16384
    ds_read_b64_tr_b16 a[194:195], v243 offset:18432
    v_mfma_f32_16x16x32_bf16 v[208:211], a[200:203], v[128:131], v[208:211]
    ds_read_b64_tr_b16 a[196:197], v243 offset:20480
    v_mul_f32 v144, v144, v248
    v_mfma_f32_16x16x32_bf16 v[208:211], a[204:207], v[136:139], v[208:211]
    s_xor_b32 s55, s76, 25165824
    ds_read_b64_tr_b16 a[198:199], v243 offset:22528
    v_mul_f32 v145, v145, v248
    v_mfma_f32_16x16x32_bf16 v[212:215], a[200:203], v[160:163], v[212:215]
    v_mul_f32 v146, v146, v248
    v_mul_f32 v147, v147, v248
    v_mfma_f32_16x16x32_bf16 v[212:215], a[204:207], v[168:171], v[212:215]
    s_waitcnt lgkmcnt(5)
    buffer_load_dwordx4 v252, s[20:23], s73 offen offset:3072 lds
    v_mul_f32 v148, v148, v248
    v_mul_f32 v149, v149, v248
    v_mul_f32 v150, v150, v248
    v_mul_f32 v151, v151, v248
    v_cvt_pk_bf16_f32 v144, v144, v145
    v_cvt_pk_bf16_f32 v145, v146, v147
    v_cvt_pk_bf16_f32 v146, v148, v149
    v_cvt_pk_bf16_f32 v147, v150, v151
    v_mfma_f32_16x16x32_bf16 v[216:219], a[208:211], v[96:99], v[216:219]
    ds_write_b128 v250, v[144:147] offset:1024
    v_mfma_f32_16x16x32_bf16 v[216:219], a[212:215], v[104:107], v[216:219]
    s_waitcnt vmcnt(15) lgkmcnt(1)
    buffer_store_dwordx4 a[248:251], v253, s[24:27], s55 offen sc1
    v_mfma_f32_16x16x32_bf16 v[220:223], a[208:211], v[128:131], v[220:223]
    s_barrier
    ds_read_b64_tr_b16 a[200:201], v240 offset:57344
    ds_read_b64_tr_b16 a[202:203], v240 offset:59392
    v_mfma_f32_16x16x32_bf16 v[220:223], a[212:215], v[136:139], v[220:223]
    s_add_u32 m0, s70, 16384
    ds_read_b64_tr_b16 a[204:205], v240 offset:61440
    v_mul_f32 v152, v152, v248
    v_mfma_f32_16x16x32_bf16 v[224:227], a[208:211], v[160:163], v[224:227]
    s_xor_b32 s73, s72, 327808
    ds_read_b64_tr_b16 a[206:207], v240 offset:63488
    v_mul_f32 v153, v153, v248
    v_mfma_f32_16x16x32_bf16 v[224:227], a[212:215], v[168:171], v[224:227]
    buffer_load_dwordx4 v252, s[20:23], s73 offen offset:0 lds
    v_mfma_f32_16x16x32_bf16 v[228:231], a[192:195], v[96:99], v[228:231]
    s_add_u32 s73, s73, 7168
    ds_read_b64_tr_b16 a[208:209], v241 offset:57344
    v_mul_f32 v154, v154, v248
    v_mul_f32 v155, v155, v248
    v_mul_f32 v156, v156, v248
    v_mul_f32 v157, v157, v248
    v_mul_f32 v158, v158, v248
    v_mul_f32 v159, v159, v248
    v_cvt_pk_bf16_f32 v152, v152, v153
    v_cvt_pk_bf16_f32 v153, v154, v155
    v_cvt_pk_bf16_f32 v154, v156, v157
    v_cvt_pk_bf16_f32 v155, v158, v159
    v_mfma_f32_16x16x32_bf16 v[228:231], a[196:199], v[104:107], v[228:231]
    ds_write_b128 v250, v[152:155] offset:4096
    v_mfma_f32_16x16x32_bf16 v[232:235], a[192:195], v[128:131], v[232:235]
    ds_read_b64_tr_b16 a[210:211], v241 offset:59392
    v_mul_f32 v176, v176, v249
    v_mfma_f32_16x16x32_bf16 v[232:235], a[196:199], v[136:139], v[232:235]
    ds_read_b64_tr_b16 a[212:213], v241 offset:61440
    v_mul_f32 v177, v177, v249
    v_mfma_f32_16x16x32_bf16 v[236:239], a[192:195], v[160:163], v[236:239]
    ds_read_b64_tr_b16 a[214:215], v241 offset:63488
    v_mul_f32 v178, v178, v249
    v_mfma_f32_16x16x32_bf16 v[236:239], a[196:199], v[168:171], v[236:239]
    s_waitcnt lgkmcnt(5)
    buffer_load_dwordx4 v252, s[20:23], s73 offen offset:1024 lds
    v_mfma_f32_16x16x32_bf16 v[192:195], a[200:203], v[112:115], v[192:195]
    s_add_u32 s73, s73, 7168
    ds_read_b64_tr_b16 a[192:193], v242 offset:57344
    v_mul_f32 v179, v179, v249
    v_mul_f32 v180, v180, v249
    v_mul_f32 v181, v181, v249
    v_mul_f32 v182, v182, v249
    v_mul_f32 v183, v183, v249
    v_cvt_pk_bf16_f32 v176, v176, v177
    v_cvt_pk_bf16_f32 v177, v178, v179
    v_cvt_pk_bf16_f32 v178, v180, v181
    v_cvt_pk_bf16_f32 v179, v182, v183
    v_mfma_f32_16x16x32_bf16 v[192:195], a[204:207], v[120:123], v[192:195]
    ds_write_b128 v250, v[176:179] offset:2048
    v_mfma_f32_16x16x32_bf16 v[196:199], a[200:203], v[144:147], v[196:199]
    ds_read_b64_tr_b16 a[194:195], v242 offset:59392
    v_mul_f32 v184, v184, v249
    v_mfma_f32_16x16x32_bf16 v[196:199], a[204:207], v[152:155], v[196:199]
    ds_read_b64_tr_b16 a[196:197], v242 offset:61440
    v_mul_f32 v185, v185, v249
    v_mul_f32 v186, v186, v249
    v_mul_f32 v187, v187, v249
    v_mul_f32 v188, v188, v249
    v_mul_f32 v189, v189, v249
    v_mul_f32 v190, v190, v249
    v_mul_f32 v191, v191, v249
    v_cvt_pk_bf16_f32 v184, v184, v185
    v_cvt_pk_bf16_f32 v185, v186, v187
    v_cvt_pk_bf16_f32 v186, v188, v189
    v_cvt_pk_bf16_f32 v187, v190, v191
    v_mfma_f32_16x16x32_bf16 v[200:203], a[200:203], v[176:179], v[200:203]
    ds_read_b64_tr_b16 a[198:199], v242 offset:63488
    ds_read_b128 a[144:147], v251 offset:32768
    v_mfma_f32_16x16x32_bf16 v[200:203], a[204:207], v[184:187], v[200:203]
    s_waitcnt lgkmcnt(6)
    buffer_load_dwordx4 v252, s[20:23], s73 offen offset:2048 lds
    v_mfma_f32_16x16x32_bf16 v[204:207], a[208:211], v[112:115], v[204:207]
    s_add_u32 s73, s73, 7168
    ds_read_b64_tr_b16 a[200:201], v243 offset:57344
    ds_read_b64_tr_b16 a[202:203], v243 offset:59392
    v_mfma_f32_16x16x32_bf16 v[204:207], a[212:215], v[120:123], v[204:207]
L_hopa_11:
    s_cbranch_execz L_backa
    ds_write_b128 v250, v[184:187] offset:5120
    v_mfma_f32_16x16x32_bf16 v[208:211], a[208:211], v[144:147], v[208:211]
    s_xor_b32 s55, s76, 26214400
    ds_read_b64_tr_b16 a[204:205], v243 offset:61440
    ds_read_b128 a[156:159], v251 offset:35840
    v_mfma_f32_16x16x32_bf16 v[208:211], a[212:215], v[152:155], v[208:211]
    ds_read_b64_tr_b16 a[206:207], v243 offset:63488
    ds_read_b128 a[148:151], v251 offset:33792
    v_mfma_f32_16x16x32_bf16 v[212:215], a[208:211], v[176:179], v[212:215]
    ds_read_b128 a[160:163], v251 offset:36864
    ds_read_b128 a[152:155], v251 offset:34816
    v_mfma_f32_16x16x32_bf16 v[212:215], a[212:215], v[184:187], v[212:215]
    s_waitcnt lgkmcnt(10)
    buffer_load_dwordx4 v252, s[20:23], s73 offen offset:3072 lds
    v_mfma_f32_16x16x32_bf16 v[216:219], a[192:195], v[112:115], v[216:219]
    buffer_store_dwordx4 a[248:251], v253, s[24:27], s55 offen sc1
    v_mfma_f32_16x16x32_bf16 v[216:219], a[196:199], v[120:123], v[216:219]
    s_waitcnt vmcnt(16) lgkmcnt(3)
    ds_read_b128 a[164:167], v251 offset:37888
    v_mfma_f32_16x16x32_bf16 v[220:223], a[192:195], v[144:147], v[220:223]
    s_barrier
    ds_read_b64_tr_b16 a[208:209], v240 offset:24576
    ds_read_b64_tr_b16 a[210:211], v240 offset:26624
    v_mfma_f32_16x16x32_bf16 v[220:223], a[196:199], v[152:155], v[220:223]
    s_add_u32 m0, s70, 57344
    ds_read_b64_tr_b16 a[212:213], v240 offset:28672
    v_mfma_f32_16x16x32_bf16 v[224:227], a[192:195], v[176:179], v[224:227]
    s_xor_b32 s73, s72, 131200
    ds_read_b64_tr_b16 a[214:215], v240 offset:30720
    ds_read_b128 a[168:171], v251 offset:0
    v_mfma_f32_16x16x32_bf16 v[224:227], a[196:199], v[184:187], v[224:227]
    buffer_load_dwordx4 v252, s[20:23], s73 offen offset:0 lds
    v_mfma_f32_16x16x32_bf16 v[228:231], a[200:203], v[112:115], v[228:231]
    s_add_u32 s73, s73, 7168
    ds_read_b64_tr_b16 a[192:193], v241 offset:24576
    v_mfma_f32_16x16x32_bf16 v[228:231], a[204:207], v[120:123], v[228:231]
    ds_read_b64_tr_b16 a[194:195], v241 offset:26624
    v_mfma_f32_16x16x32_bf16 v[232:235], a[200:203], v[144:147], v[232:235]
    ds_read_b64_tr_b16 a[196:197], v241 offset:28672
    ds_read_b128 a[180:183], v251 offset:3072
    v_mfma_f32_16x16x32_bf16 v[232:235], a[204:207], v[152:155], v[232:235]
    ds_read_b64_tr_b16 a[198:199], v241 offset:30720
    v_mfma_f32_16x16x32_bf16 v[236:239], a[200:203], v[176:179], v[236:239]
    v_mfma_f32_16x16x32_bf16 v[236:239], a[204:207], v[184:187], v[236:239]
    s_waitcnt lgkmcnt(6)
    buffer_load_dwordx4 v252, s[20:23], s73 offen offset:1024 lds
    v_mfma_f32_16x16x32_bf16 v[192:195], a[208:211], a[144:147], v[192:195]
    s_add_u32 s73, s73, 7168
    ds_read_b64_tr_b16 a[200:201], v242 offset:24576
    ds_read_b128 a[172:175], v251 offset:1024
    v_mfma_f32_16x16x32_bf16 v[192:195], a[212:215], a[156:159], v[192:195]
    ds_read_b64_tr_b16 a[202:203], v242 offset:26624
    v_mfma_f32_16x16x32_bf16 v[196:199], a[208:211], a[148:151], v[196:199]
    ds_read_b64_tr_b16 a[204:205], v242 offset:28672
    v_mfma_f32_16x16x32_bf16 v[196:199], a[212:215], a[160:163], v[196:199]
    ds_read_b64_tr_b16 a[206:207], v242 offset:30720
    v_mfma_f32_16x16x32_bf16 v[200:203], a[208:211], a[152:155], v[200:203]
    ds_read_b128 a[184:187], v251 offset:4096
    v_mfma_f32_16x16x32_bf16 v[200:203], a[212:215], a[164:167], v[200:203]
    s_waitcnt lgkmcnt(6)
    buffer_load_dwordx4 v252, s[20:23], s73 offen offset:2048 lds
    v_mfma_f32_16x16x32_bf16 v[204:207], a[192:195], a[144:147], v[204:207]
    s_add_u32 s73, s73, 7168
    ds_read_b64_tr_b16 a[208:209], v243 offset:24576
    v_mfma_f32_16x16x32_bf16 v[204:207], a[196:199], a[156:159], v[204:207]
    ds_read_b64_tr_b16 a[210:211], v243 offset:26624
    v_mfma_f32_16x16x32_bf16 v[208:211], a[192:195], a[148:151], v[208:211]
    s_xor_b32 s55, s76, 27262976
    ds_read_b64_tr_b16 a[212:213], v243 offset:28672
    ds_read_b128 a[176:179], v251 offset:2048
    v_mfma_f32_16x16x32_bf16 v[208:211], a[196:199], a[160:163], v[208:211]
    ds_read_b64_tr_b16 a[214:215], v243 offset:30720
    v_mfma_f32_16x16x32_bf16 v[212:215], a[192:195], a[152:155], v[212:215]
    v_mfma_f32_16x16x32_bf16 v[212:215], a[196:199], a[164:167], v[212:215]
    s_waitcnt lgkmcnt(6)
    buffer_load_dwordx4 v252, s[20:23], s73 offen offset:3072 lds
    v_mfma_f32_16x16x32_bf16 v[216:219], a[200:203], a[144:147], v[216:219]
    buffer_store_dwordx4 a[248:251], v253, s[24:27], s55 offen sc1
    v_mfma_f32_16x16x32_bf16 v[216:219], a[204:207], a[156:159], v[216:219]
    s_waitcnt vmcnt(16) lgkmcnt(0)
    ds_read_b128 a[188:191], v251 offset:5120
    v_mfma_f32_16x16x32_bf16 v[220:223], a[200:203], a[148:151], v[220:223]
    s_barrier
    ds_read_b64_tr_b16 a[192:193], v240 offset:49152
    ds_read_b64_tr_b16 a[194:195], v240 offset:51200
    v_mfma_f32_16x16x32_bf16 v[220:223], a[204:207], a[160:163], v[220:223]
    s_add_u32 m0, s70, 24576
    ds_read_b64_tr_b16 a[196:197], v240 offset:53248
    v_mfma_f32_16x16x32_bf16 v[224:227], a[200:203], a[152:155], v[224:227]
    s_xor_b32 s73, s72, 196736
    ds_read_b64_tr_b16 a[198:199], v240 offset:55296
    v_mfma_f32_16x16x32_bf16 v[224:227], a[204:207], a[164:167], v[224:227]
    buffer_load_dwordx4 v252, s[20:23], s73 offen offset:0 lds
    v_mfma_f32_16x16x32_bf16 v[228:231], a[208:211], a[144:147], v[228:231]
    s_add_u32 s73, s73, 7168
    s_cmp_lg_u64 s[80:81], 0
    s_cselect_b32 s82, 1, 0
    ds_read_b64_tr_b16 a[200:201], v241 offset:49152
    v_mfma_f32_16x16x32_bf16 v[228:231], a[212:215], a[156:159], v[228:231]
    s_lshl_b32 s83, s3, 2
    ds_read_b64_tr_b16 a[202:203], v241 offset:51200
    v_mfma_f32_16x16x32_bf16 v[232:235], a[208:211], a[148:151], v[232:235]
    s_andn2_b32 s82, s82, s78
    ds_read_b64_tr_b16 a[204:205], v241 offset:53248
    v_mfma_f32_16x16x32_bf16 v[232:235], a[212:215], a[160:163], v[232:235]
    ds_read_b64_tr_b16 a[206:207], v241 offset:55296
    v_mfma_f32_16x16x32_bf16 v[236:239], a[208:211], a[152:155], v[236:239]
    v_mfma_f32_16x16x32_bf16 v[236:239], a[212:215], a[164:167], v[236:239]
    s_waitcnt lgkmcnt(4)
    buffer_load_dwordx4 v252, s[20:23], s73 offen offset:1024 lds
    v_mfma_f32_16x16x32_bf16 v[192:195], a[192:195], a[168:171], v[192:195]
    s_add_u32 s73, s73, 7168
    ds_read_b64_tr_b16 a[208:209], v242 offset:49152
    v_mov_b32 v164, s83
    v_mfma_f32_16x16x32_bf16 v[192:195], a[196:199], a[180:183], v[192:195]
    ds_read_b64_tr_b16 a[210:211], v242 offset:51200
    v_mov_b32 v165, s82
    v_mfma_f32_16x16x32_bf16 v[196:199], a[192:195], a[172:175], v[196:199]
    ds_read_b64_tr_b16 a[212:213], v242 offset:53248
    v_mfma_f32_16x16x32_bf16 v[196:199], a[196:199], a[184:187], v[196:199]
    ds_read_b64_tr_b16 a[214:215], v242 offset:55296
    v_mfma_f32_16x16x32_bf16 v[200:203], a[192:195], a[176:179], v[200:203]
    v_mfma_f32_16x16x32_bf16 v[200:203], a[196:199], a[188:191], v[200:203]
    s_waitcnt lgkmcnt(4)
    buffer_load_dwordx4 v252, s[20:23], s73 offen offset:2048 lds
    v_mfma_f32_16x16x32_bf16 v[204:207], a[200:203], a[168:171], v[204:207]
    s_add_u32 s73, s73, 7168
    ds_read_b64_tr_b16 a[192:193], v243 offset:49152
    v_mfma_f32_16x16x32_bf16 v[204:207], a[204:207], a[180:183], v[204:207]
    ds_read_b64_tr_b16 a[194:195], v243 offset:51200
    v_mfma_f32_16x16x32_bf16 v[208:211], a[200:203], a[172:175], v[208:211]
    ds_read_b64_tr_b16 a[196:197], v243 offset:53248
    v_mfma_f32_16x16x32_bf16 v[208:211], a[204:207], a[184:187], v[208:211]
    ds_read_b64_tr_b16 a[198:199], v243 offset:55296
    ds_write_b32 v164, v165 offset:38912
    v_mov_b32 v164, 0
    v_mfma_f32_16x16x32_bf16 v[212:215], a[200:203], a[176:179], v[212:215]
    v_mfma_f32_16x16x32_bf16 v[212:215], a[204:207], a[188:191], v[212:215]
    s_waitcnt lgkmcnt(5)
    buffer_load_dwordx4 v252, s[20:23], s73 offen offset:3072 lds
    v_mfma_f32_16x16x32_bf16 v[216:219], a[208:211], a[168:171], v[216:219]
    v_cvt_pk_bf16_f32 v192, v192, v193
    v_cvt_pk_bf16_f32 v193, v194, v195
    v_mfma_f32_16x16x32_bf16 v[216:219], a[212:215], a[180:183], v[216:219]
    s_waitcnt vmcnt(15) lgkmcnt(0)
    v_cvt_pk_bf16_f32 v194, v204, v205
    v_cvt_pk_bf16_f32 v195, v206, v207
    s_xor_b32 s77, s76, 0
    v_mfma_f32_16x16x32_bf16 v[220:223], a[208:211], a[172:175], v[220:223]
    s_barrier
    ds_read_b64_tr_b16 a[200:201], v240 offset:8192
    ds_read_b64_tr_b16 a[202:203], v240 offset:10240
    v_mfma_f32_16x16x32_bf16 v[220:223], a[212:215], a[184:187], v[220:223]
    s_add_u32 m0, s70, 49152
    ds_read_b64_tr_b16 a[204:205], v240 offset:12288
    ds_read_b128 v[164:167], v164 offset:38912
    v_mfma_f32_16x16x32_bf16 v[224:227], a[208:211], a[176:179], v[224:227]
    s_xor_b32 s73, s72, 393344
    ds_read_b64_tr_b16 a[206:207], v240 offset:14336
    v_mfma_f32_16x16x32_bf16 v[224:227], a[212:215], a[188:191], v[224:227]
    buffer_load_dwordx4 v252, s[20:23], s73 offen offset:0 lds
    v_mfma_f32_16x16x32_bf16 v[228:231], a[192:195], a[168:171], v[228:231]
    s_add_u32 s73, s73, 7168
    ds_read_b64_tr_b16 a[208:209], v241 offset:8192
    v_mfma_f32_16x16x32_bf16 v[228:231], a[196:199], a[180:183], v[228:231]
    ds_read_b64_tr_b16 a[210:211], v241 offset:10240
    v_mfma_f32_16x16x32_bf16 v[232:235], a[192:195], a[172:175], v[232:235]
    ds_read_b64_tr_b16 a[212:213], v241 offset:12288
    v_mfma_f32_16x16x32_bf16 v[232:235], a[196:199], a[184:187], v[232:235]
    ds_read_b64_tr_b16 a[214:215], v241 offset:14336
    v_mfma_f32_16x16x32_bf16 v[236:239], a[192:195], a[176:179], v[236:239]
    v_mfma_f32_16x16x32_bf16 v[236:239], a[196:199], a[188:191], v[236:239]
    s_waitcnt lgkmcnt(4)
    buffer_load_dwordx4 v252, s[20:23], s73 offen offset:1024 lds
    v_mfma_f32_16x16x32_bf16 v[4:7], a[200:203], a[96:99], v[4:7]
    s_add_u32 s73, s73, 7168
    ds_read_b64_tr_b16 a[192:193], v242 offset:8192
    v_mfma_f32_16x16x32_bf16 v[4:7], a[204:207], a[108:111], v[4:7]
    ds_read_b64_tr_b16 a[194:195], v242 offset:10240
    v_mfma_f32_16x16x32_bf16 v[36:39], a[200:203], a[100:103], v[36:39]
    ds_read_b64_tr_b16 a[196:197], v242 offset:12288
    v_mfma_f32_16x16x32_bf16 v[36:39], a[204:207], a[112:115], v[36:39]
    ds_read_b64_tr_b16 a[198:199], v242 offset:14336
    v_mfma_f32_16x16x32_bf16 v[68:71], a[200:203], a[104:107], v[68:71]
    buffer_store_dwordx4 v[192:195], v253, s[24:27], s77 offen sc1
    v_mfma_f32_16x16x32_bf16 v[68:71], a[204:207], a[116:119], v[68:71]
    s_waitcnt lgkmcnt(4)
    buffer_load_dwordx4 v252, s[20:23], s73 offen offset:2048 lds
    v_mfma_f32_16x16x32_bf16 v[12:15], a[208:211], a[96:99], v[12:15]
    s_add_u32 s73, s73, 7168
    ds_read_b64_tr_b16 a[200:201], v243 offset:8192
    v_cvt_pk_bf16_f32 v196, v196, v197
    v_mfma_f32_16x16x32_bf16 v[12:15], a[212:215], a[108:111], v[12:15]
    ds_read_b64_tr_b16 a[202:203], v243 offset:10240
    v_cvt_pk_bf16_f32 v197, v198, v199
    v_mfma_f32_16x16x32_bf16 v[44:47], a[208:211], a[100:103], v[44:47]
    ds_read_b64_tr_b16 a[204:205], v243 offset:12288
    v_cvt_pk_bf16_f32 v198, v208, v209
    v_mfma_f32_16x16x32_bf16 v[44:47], a[212:215], a[112:115], v[44:47]
    ds_read_b64_tr_b16 a[206:207], v243 offset:14336
    v_cvt_pk_bf16_f32 v199, v210, v211
    s_xor_b32 s77, s76, 1048576
    v_mfma_f32_16x16x32_bf16 v[76:79], a[208:211], a[104:107], v[76:79]
    v_mfma_f32_16x16x32_bf16 v[76:79], a[212:215], a[116:119], v[76:79]
    s_waitcnt lgkmcnt(4)
    buffer_load_dwordx4 v252, s[20:23], s73 offen offset:3072 lds
    v_mfma_f32_16x16x32_bf16 v[20:23], a[192:195], a[96:99], v[20:23]
    v_or3_b32 v164, v164, v165, v166
    v_or_b32 v164, v164, v167
    v_mfma_f32_16x16x32_bf16 v[20:23], a[196:199], a[108:111], v[20:23]
    s_waitcnt vmcnt(15) lgkmcnt(0)
    v_cmp_ne_u32 vcc, 0, v164
    v_mfma_f32_16x16x32_bf16 v[52:55], a[192:195], a[100:103], v[52:55]
    s_barrier
    ds_read_b64_tr_b16 a[208:209], v240 offset:16384
    ds_read_b64_tr_b16 a[210:211], v240 offset:18432
    v_mfma_f32_16x16x32_bf16 v[52:55], a[196:199], a[112:115], v[52:55]
    s_add_u32 m0, s70, 8192
    ds_read_b64_tr_b16 a[212:213], v240 offset:20480
    v_mfma_f32_16x16x32_bf16 v[84:87], a[192:195], a[104:107], v[84:87]
    s_xor_b32 s73, s72, 458880
    ds_read_b64_tr_b16 a[214:215], v240 offset:22528
    v_mfma_f32_16x16x32_bf16 v[84:87], a[196:199], a[116:119], v[84:87]
    buffer_load_dwordx4 v252, s[20:23], s73 offen offset:0 lds
    v_mfma_f32_16x16x32_bf16 v[28:31], a[200:203], a[96:99], v[28:31]
    s_add_u32 s73, s73, 7168
    ds_read_b64_tr_b16 a[192:193], v241 offset:16384
    v_mfma_f32_16x16x32_bf16 v[28:31], a[204:207], a[108:111], v[28:31]
    ds_read_b64_tr_b16 a[194:195], v241 offset:18432
    v_mfma_f32_16x16x32_bf16 v[60:63], a[200:203], a[100:103], v[60:63]
    ds_read_b64_tr_b16 a[196:197], v241 offset:20480
    v_mfma_f32_16x16x32_bf16 v[60:63], a[204:207], a[112:115], v[60:63]
    ds_read_b64_tr_b16 a[198:199], v241 offset:22528
    v_mfma_f32_16x16x32_bf16 v[92:95], a[200:203], a[104:107], v[92:95]
    buffer_store_dwordx4 v[196:199], v253, s[24:27], s77 offen sc1
    v_mfma_f32_16x16x32_bf16 v[92:95], a[204:207], a[116:119], v[92:95]
    s_waitcnt lgkmcnt(4)
    buffer_load_dwordx4 v252, s[20:23], s73 offen offset:1024 lds
    v_mfma_f32_16x16x32_bf16 v[4:7], a[208:211], a[120:123], v[4:7]
    s_add_u32 s73, s73, 7168
    ds_read_b64_tr_b16 a[200:201], v242 offset:16384
    v_cvt_pk_bf16_f32 v200, v200, v201
    v_mfma_f32_16x16x32_bf16 v[4:7], a[212:215], a[132:135], v[4:7]
    ds_read_b64_tr_b16 a[202:203], v242 offset:18432
    v_cvt_pk_bf16_f32 v201, v202, v203
    v_mfma_f32_16x16x32_bf16 v[36:39], a[208:211], a[124:127], v[36:39]
    ds_read_b64_tr_b16 a[204:205], v242 offset:20480
    v_cvt_pk_bf16_f32 v202, v212, v213
    v_mfma_f32_16x16x32_bf16 v[36:39], a[212:215], a[136:139], v[36:39]
    ds_read_b64_tr_b16 a[206:207], v242 offset:22528
    v_cvt_pk_bf16_f32 v203, v214, v215
    s_xor_b32 s77, s76, 2097152
    v_mfma_f32_16x16x32_bf16 v[68:71], a[208:211], a[128:131], v[68:71]
    v_mfma_f32_16x16x32_bf16 v[68:71], a[212:215], a[140:143], v[68:71]
    s_waitcnt lgkmcnt(4)
    buffer_load_dwordx4 v252, s[20:23], s73 offen offset:2048 lds
    v_mfma_f32_16x16x32_bf16 v[12:15], a[192:195], a[120:123], v[12:15]
    s_add_u32 s73, s73, 7168
    ds_read_b64_tr_b16 a[208:209], v243 offset:16384
    v_mfma_f32_16x16x32_bf16 v[12:15], a[196:199], a[132:135], v[12:15]
    ds_read_b64_tr_b16 a[210:211], v243 offset:18432
    v_mfma_f32_16x16x32_bf16 v[44:47], a[192:195], a[124:127], v[44:47]
    s_cbranch_vccnz L_fallback
    ds_read_b64_tr_b16 a[212:213], v243 offset:20480
    v_mfma_f32_16x16x32_bf16 v[44:47], a[196:199], a[136:139], v[44:47]
    ds_read_b64_tr_b16 a[214:215], v243 offset:22528
    v_mfma_f32_16x16x32_bf16 v[76:79], a[192:195], a[128:131], v[76:79]
    v_mfma_f32_16x16x32_bf16 v[76:79], a[196:199], a[140:143], v[76:79]
    s_waitcnt lgkmcnt(4)
    buffer_load_dwordx4 v252, s[20:23], s73 offen offset:3072 lds
    v_mfma_f32_16x16x32_bf16 v[20:23], a[200:203], a[120:123], v[20:23]
    v_mfma_f32_16x16x32_bf16 v[20:23], a[204:207], a[132:135], v[20:23]
    s_waitcnt vmcnt(15) lgkmcnt(0)
    v_mfma_f32_16x16x32_bf16 v[52:55], a[200:203], a[124:127], v[52:55]
    s_barrier
    ds_read_b64_tr_b16 a[192:193], v240 offset:57344
    ds_read_b64_tr_b16 a[194:195], v240 offset:59392
    v_mfma_f32_16x16x32_bf16 v[52:55], a[204:207], a[136:139], v[52:55]
    s_add_u32 m0, s70, 16384
    ds_read_b64_tr_b16 a[196:197], v240 offset:61440
    v_mfma_f32_16x16x32_bf16 v[84:87], a[200:203], a[128:131], v[84:87]
    s_xor_b32 s73, s72, 256
    ds_read_b64_tr_b16 a[198:199], v240 offset:63488
    buffer_store_dwordx4 v[200:203], v253, s[24:27], s77 offen sc1
    v_mfma_f32_16x16x32_bf16 v[84:87], a[204:207], a[140:143], v[84:87]
    s_lshl_b32 s82, s63, 6
    buffer_load_dwordx4 v252, s[20:23], s73 offen offset:0 lds
    v_mfma_f32_16x16x32_bf16 v[28:31], a[208:211], a[120:123], v[28:31]
    s_add_u32 s73, s73, 7168
    ds_read_b64_tr_b16 a[200:201], v241 offset:57344
    v_cvt_pk_bf16_f32 v216, v216, v217
    v_mfma_f32_16x16x32_bf16 v[28:31], a[212:215], a[132:135], v[28:31]
    s_mul_i32 s83, s63, 163840
    ds_read_b64_tr_b16 a[202:203], v241 offset:59392
    v_cvt_pk_bf16_f32 v217, v218, v219
    v_mfma_f32_16x16x32_bf16 v[60:63], a[208:211], a[124:127], v[60:63]
    s_sub_u32 s83, 81920, s83
    ds_read_b64_tr_b16 a[204:205], v241 offset:61440
    v_cvt_pk_bf16_f32 v218, v228, v229
    v_mfma_f32_16x16x32_bf16 v[60:63], a[212:215], a[136:139], v[60:63]
    ds_read_b64_tr_b16 a[206:207], v241 offset:63488
    v_cvt_pk_bf16_f32 v219, v230, v231
    s_xor_b32 s77, s76, 4194304
    v_mfma_f32_16x16x32_bf16 v[92:95], a[208:211], a[128:131], v[92:95]
    v_mfma_f32_16x16x32_bf16 v[92:95], a[212:215], a[140:143], v[92:95]
    s_waitcnt lgkmcnt(4)
    buffer_load_dwordx4 v252, s[20:23], s73 offen offset:1024 lds
    v_mfma_f32_16x16x32_bf16 v[4:7], a[192:195], v[96:99], v[4:7]
    s_add_u32 s73, s73, 7168
    ds_read_b64_tr_b16 a[208:209], v242 offset:57344
    v_xor_b32 v244, s82, v240
    v_mfma_f32_16x16x32_bf16 v[4:7], a[196:199], v[104:107], v[4:7]
    ds_read_b64_tr_b16 a[210:211], v242 offset:59392
    v_xor_b32 v245, 32, v244
    v_mfma_f32_16x16x32_bf16 v[36:39], a[192:195], v[128:131], v[36:39]
    ds_read_b64_tr_b16 a[212:213], v242 offset:61440
    v_add_u32 v246, s83, v244
    v_mfma_f32_16x16x32_bf16 v[36:39], a[196:199], v[136:139], v[36:39]
    ds_read_b64_tr_b16 a[214:215], v242 offset:63488
    v_add_u32 v247, s83, v245
    v_mfma_f32_16x16x32_bf16 v[68:71], a[192:195], v[160:163], v[68:71]
    v_and_b32 v164, 16, v253
    v_and_b32 v165, 96, v253
    v_mfma_f32_16x16x32_bf16 v[68:71], a[196:199], v[168:171], v[68:71]
    s_waitcnt lgkmcnt(4)
    buffer_load_dwordx4 v252, s[20:23], s73 offen offset:2048 lds
    v_mfma_f32_16x16x32_bf16 v[12:15], a[200:203], v[96:99], v[12:15]
    s_add_u32 s73, s73, 7168
    ds_read_b64_tr_b16 a[192:193], v243 offset:57344
    v_lshlrev_b32 v165, 8, v165
    v_mfma_f32_16x16x32_bf16 v[12:15], a[204:207], v[104:107], v[12:15]
    ds_read_b64_tr_b16 a[194:195], v243 offset:59392
    v_lshl_or_b32 v165, v164, 8, v165
    v_mfma_f32_16x16x32_bf16 v[44:47], a[200:203], v[128:131], v[44:47]
    ds_read_b64_tr_b16 a[196:197], v243 offset:61440
    v_xor_b32 v248, s35, v165
    v_mfma_f32_16x16x32_bf16 v[44:47], a[204:207], v[136:139], v[44:47]
    ds_read_b64_tr_b16 a[198:199], v243 offset:63488
    v_accvgpr_read_b32 v250, a247
    v_mfma_f32_16x16x32_bf16 v[76:79], a[200:203], v[160:163], v[76:79]
    buffer_store_dwordx4 v[216:219], v253, s[24:27], s77 offen sc1
    v_mfma_f32_16x16x32_bf16 v[76:79], a[204:207], v[168:171], v[76:79]
    s_waitcnt lgkmcnt(4)
    buffer_load_dwordx4 v252, s[20:23], s73 offen offset:3072 lds
    v_mfma_f32_16x16x32_bf16 v[20:23], a[208:211], v[96:99], v[20:23]
    v_cvt_pk_bf16_f32 v220, v220, v221
    v_cvt_pk_bf16_f32 v221, v222, v223
    v_mfma_f32_16x16x32_bf16 v[20:23], a[212:215], v[104:107], v[20:23]
    s_waitcnt vmcnt(16) lgkmcnt(0)
    v_cvt_pk_bf16_f32 v222, v232, v233
    v_cvt_pk_bf16_f32 v223, v234, v235
    s_xor_b32 s77, s76, 5242880
    v_mfma_f32_16x16x32_bf16 v[52:55], a[208:211], v[128:131], v[52:55]
    s_barrier
    ds_read_b64_tr_b16 a[200:201], v240 offset:24576
    ds_read_b64_tr_b16 a[202:203], v240 offset:26624
    v_mfma_f32_16x16x32_bf16 v[52:55], a[212:215], v[136:139], v[52:55]
    s_add_u32 m0, s70, 57344
    ds_read_b64_tr_b16 a[204:205], v240 offset:28672
    v_mov_b32 v165, 0x3f80
    v_mfma_f32_16x16x32_bf16 v[84:87], a[208:211], v[160:163], v[84:87]
    s_xor_b32 s73, s72, 65792
    ds_read_b64_tr_b16 a[206:207], v240 offset:30720
    v_lshlrev_b32 v164, v164, v165
    v_mfma_f32_16x16x32_bf16 v[84:87], a[212:215], v[168:171], v[84:87]
    buffer_load_dwordx4 v252, s[20:23], s73 offen offset:0 lds
    v_mfma_f32_16x16x32_bf16 v[28:31], a[192:195], v[96:99], v[28:31]
    s_add_u32 s73, s73, 7168
    ds_read_b64_tr_b16 a[208:209], v241 offset:24576
    v_bfe_u32 v165, v253, 5, 3
    v_mfma_f32_16x16x32_bf16 v[28:31], a[196:199], v[104:107], v[28:31]
    ds_read_b64_tr_b16 a[210:211], v241 offset:26624
    v_lshrrev_b32 v166, 8, v253
    v_mfma_f32_16x16x32_bf16 v[60:63], a[192:195], v[128:131], v[60:63]
    ds_read_b64_tr_b16 a[212:213], v241 offset:28672
    v_lshlrev_b32 v166, 1, v166
    v_mfma_f32_16x16x32_bf16 v[60:63], a[196:199], v[136:139], v[60:63]
    ds_read_b64_tr_b16 a[214:215], v241 offset:30720
    v_cmp_eq_u32 vcc, v165, v166
    v_mfma_f32_16x16x32_bf16 v[92:95], a[192:195], v[160:163], v[92:95]
    v_or_b32 v166, 1, v166
    v_accvgpr_write_b32 a84, 0
    v_mfma_f32_16x16x32_bf16 v[92:95], a[196:199], v[168:171], v[92:95]
    s_waitcnt lgkmcnt(4)
    buffer_load_dwordx4 v252, s[20:23], s73 offen offset:1024 lds
    v_mfma_f32_16x16x32_bf16 v[4:7], a[200:203], v[112:115], v[4:7]
    s_add_u32 s73, s73, 7168
    ds_read_b64_tr_b16 a[192:193], v242 offset:24576
    v_cndmask_b32 v167, 0, v164, vcc
    v_mfma_f32_16x16x32_bf16 v[4:7], a[204:207], v[120:123], v[4:7]
    ds_read_b64_tr_b16 a[194:195], v242 offset:26624
    v_cmp_eq_u32 vcc, v165, v166
    v_mfma_f32_16x16x32_bf16 v[36:39], a[200:203], v[144:147], v[36:39]
    ds_read_b64_tr_b16 a[196:197], v242 offset:28672
    v_accvgpr_write_b32 a86, v167
    v_mfma_f32_16x16x32_bf16 v[36:39], a[204:207], v[152:155], v[36:39]
    ds_read_b64_tr_b16 a[198:199], v242 offset:30720
    v_accvgpr_write_b32 a88, v167
    v_mfma_f32_16x16x32_bf16 v[68:71], a[200:203], v[176:179], v[68:71]
    buffer_store_dwordx4 v[220:223], v253, s[24:27], s77 offen sc1
    v_mfma_f32_16x16x32_bf16 v[68:71], a[204:207], v[184:187], v[68:71]
    s_waitcnt lgkmcnt(4)
    buffer_load_dwordx4 v252, s[20:23], s73 offen offset:2048 lds
    v_mfma_f32_16x16x32_bf16 v[12:15], a[208:211], v[112:115], v[12:15]
    s_add_u32 s73, s73, 7168
    ds_read_b64_tr_b16 a[200:201], v243 offset:24576
    v_cvt_pk_bf16_f32 v224, v224, v225
    v_mfma_f32_16x16x32_bf16 v[12:15], a[212:215], v[120:123], v[12:15]
    ds_read_b64_tr_b16 a[202:203], v243 offset:26624
    v_cvt_pk_bf16_f32 v225, v226, v227
    v_mfma_f32_16x16x32_bf16 v[44:47], a[208:211], v[144:147], v[44:47]
    ds_read_b64_tr_b16 a[204:205], v243 offset:28672
    v_cvt_pk_bf16_f32 v226, v236, v237
    v_mfma_f32_16x16x32_bf16 v[44:47], a[212:215], v[152:155], v[44:47]
    ds_read_b64_tr_b16 a[206:207], v243 offset:30720
    v_cvt_pk_bf16_f32 v227, v238, v239
    s_xor_b32 s77, s76, 6291456
    v_mfma_f32_16x16x32_bf16 v[76:79], a[208:211], v[176:179], v[76:79]
    v_cndmask_b32 v164, 0, v164, vcc
    v_accvgpr_write_b32 a85, 0
    v_mfma_f32_16x16x32_bf16 v[76:79], a[212:215], v[184:187], v[76:79]
    s_waitcnt lgkmcnt(4)
    buffer_load_dwordx4 v252, s[20:23], s73 offen offset:3072 lds
    v_mfma_f32_16x16x32_bf16 v[20:23], a[192:195], v[112:115], v[20:23]
    v_accvgpr_write_b32 a87, v164
    v_accvgpr_write_b32 a89, v164
    v_mfma_f32_16x16x32_bf16 v[20:23], a[196:199], v[120:123], v[20:23]
    s_waitcnt vmcnt(16) lgkmcnt(0)
    v_accvgpr_write_b32 a90, 0
    v_accvgpr_write_b32 a91, 0
    v_mfma_f32_16x16x32_bf16 v[52:55], a[192:195], v[144:147], v[52:55]
    s_barrier
    ds_read_b64_tr_b16 a[208:209], v240 offset:49152
    ds_read_b64_tr_b16 a[210:211], v240 offset:51200
    v_mfma_f32_16x16x32_bf16 v[52:55], a[196:199], v[152:155], v[52:55]
    s_add_u32 m0, s70, 24576
    ds_read_b64_tr_b16 a[212:213], v240 offset:53248
    v_bfe_u32 v164, v253, 8, 1
    v_mfma_f32_16x16x32_bf16 v[84:87], a[192:195], v[176:179], v[84:87]
    s_xor_b32 s73, s72, 131328
    ds_read_b64_tr_b16 a[214:215], v240 offset:55296
    v_lshrrev_b32 v165, 9, v253
    v_mfma_f32_16x16x32_bf16 v[84:87], a[196:199], v[184:187], v[84:87]
    buffer_load_dwordx4 v252, s[20:23], s73 offen offset:0 lds
    v_mfma_f32_16x16x32_bf16 v[28:31], a[200:203], v[112:115], v[28:31]
    s_add_u32 s73, s73, 7168
    ds_read_b64_tr_b16 a[192:193], v241 offset:49152
    v_lshl_or_b32 v164, v164, 1, v165
    v_mfma_f32_16x16x32_bf16 v[28:31], a[204:207], v[120:123], v[28:31]
    ds_read_b64_tr_b16 a[194:195], v241 offset:51200
    v_lshlrev_b32 v164, 4, v164
    v_mfma_f32_16x16x32_bf16 v[60:63], a[200:203], v[144:147], v[60:63]
    ds_read_b64_tr_b16 a[196:197], v241 offset:53248
    v_and_b32 v165, 0xf0, v253
    v_mfma_f32_16x16x32_bf16 v[60:63], a[204:207], v[152:155], v[60:63]
    ds_read_b64_tr_b16 a[198:199], v241 offset:55296
    v_lshl_or_b32 v164, v165, 7, v164
    v_mfma_f32_16x16x32_bf16 v[92:95], a[200:203], v[176:179], v[92:95]
    buffer_store_dwordx4 v[224:227], v253, s[24:27], s77 offen sc1
    v_mfma_f32_16x16x32_bf16 v[92:95], a[204:207], v[184:187], v[92:95]
    s_waitcnt lgkmcnt(4)
    buffer_load_dwordx4 v252, s[20:23], s73 offen offset:1024 lds
    v_mfma_f32_16x16x32_bf16 v[4:7], a[208:211], a[144:147], v[4:7]
    s_add_u32 s73, s73, 7168
    ds_read_b64_tr_b16 a[200:201], v242 offset:49152
    v_add_u32 v249, s52, v164
    v_mfma_f32_16x16x32_bf16 v[4:7], a[212:215], a[156:159], v[4:7]
    ds_read_b64_tr_b16 a[202:203], v242 offset:51200
    v_readfirstlane_b32 s36, v250
    v_mfma_f32_16x16x32_bf16 v[36:39], a[208:211], a[148:151], v[36:39]
    ds_read_b64_tr_b16 a[204:205], v242 offset:53248
    v_mfma_f32_16x16x32_bf16 v[36:39], a[212:215], a[160:163], v[36:39]
    ds_read_b64_tr_b16 a[206:207], v242 offset:55296
    v_mfma_f32_16x16x32_bf16 v[68:71], a[208:211], a[152:155], v[68:71]
    v_mfma_f32_16x16x32_bf16 v[68:71], a[212:215], a[164:167], v[68:71]
    s_waitcnt lgkmcnt(4)
    buffer_load_dwordx4 v252, s[20:23], s73 offen offset:2048 lds
    v_mfma_f32_16x16x32_bf16 v[12:15], a[192:195], a[144:147], v[12:15]
    s_add_u32 s73, s73, 7168
    ds_read_b64_tr_b16 a[208:209], v243 offset:49152
    v_mfma_f32_16x16x32_bf16 v[12:15], a[196:199], a[156:159], v[12:15]
    ds_read_b64_tr_b16 a[210:211], v243 offset:51200
    v_mfma_f32_16x16x32_bf16 v[44:47], a[192:195], a[148:151], v[44:47]
    ds_read_b64_tr_b16 a[212:213], v243 offset:53248
    v_mfma_f32_16x16x32_bf16 v[44:47], a[196:199], a[160:163], v[44:47]
    ds_read_b64_tr_b16 a[214:215], v243 offset:55296
    v_mfma_f32_16x16x32_bf16 v[76:79], a[192:195], a[152:155], v[76:79]
    v_mfma_f32_16x16x32_bf16 v[76:79], a[196:199], a[164:167], v[76:79]
    s_waitcnt lgkmcnt(4)
    buffer_load_dwordx4 v252, s[20:23], s73 offen offset:3072 lds
    v_mfma_f32_16x16x32_bf16 v[20:23], a[200:203], a[144:147], v[20:23]
    v_mfma_f32_16x16x32_bf16 v[20:23], a[204:207], a[156:159], v[20:23]
    s_waitcnt vmcnt(16) lgkmcnt(0)
    v_mfma_f32_16x16x32_bf16 v[52:55], a[200:203], a[148:151], v[52:55]
    s_barrier
    ds_read_b64_tr_b16 a[192:193], v240 offset:8192
    ds_read_b64_tr_b16 a[194:195], v240 offset:10240
    v_mfma_f32_16x16x32_bf16 v[52:55], a[204:207], a[160:163], v[52:55]
    s_add_u32 m0, s70, 49152
    ds_read_b64_tr_b16 a[196:197], v240 offset:12288
    v_mfma_f32_16x16x32_bf16 v[84:87], a[200:203], a[152:155], v[84:87]
    s_xor_b32 s73, s72, 196864
    ds_read_b64_tr_b16 a[198:199], v240 offset:14336
    v_mfma_f32_16x16x32_bf16 v[84:87], a[204:207], a[164:167], v[84:87]
    buffer_load_dwordx4 v252, s[20:23], s73 offen offset:0 lds
    v_mfma_f32_16x16x32_bf16 v[28:31], a[208:211], a[144:147], v[28:31]
    s_add_u32 s73, s73, 7168
    ds_read_b64_tr_b16 a[200:201], v241 offset:8192
    v_mfma_f32_16x16x32_bf16 v[28:31], a[212:215], a[156:159], v[28:31]
    ds_read_b64_tr_b16 a[202:203], v241 offset:10240
    v_mfma_f32_16x16x32_bf16 v[60:63], a[208:211], a[148:151], v[60:63]
    ds_read_b64_tr_b16 a[204:205], v241 offset:12288
    v_mfma_f32_16x16x32_bf16 v[60:63], a[212:215], a[160:163], v[60:63]
    ds_read_b64_tr_b16 a[206:207], v241 offset:14336
    v_mfma_f32_16x16x32_bf16 v[92:95], a[208:211], a[152:155], v[92:95]
    v_mfma_f32_16x16x32_bf16 v[92:95], a[212:215], a[164:167], v[92:95]
    s_waitcnt lgkmcnt(4)
    buffer_load_dwordx4 v252, s[20:23], s73 offen offset:1024 lds
    v_mfma_f32_16x16x32_bf16 v[4:7], a[192:195], a[168:171], v[4:7]
    s_add_u32 s73, s73, 7168
    ds_read_b64_tr_b16 a[208:209], v242 offset:8192
    v_mfma_f32_16x16x32_bf16 v[4:7], a[196:199], a[180:183], v[4:7]
    ds_read_b64_tr_b16 a[210:211], v242 offset:10240
    v_mfma_f32_16x16x32_bf16 v[36:39], a[192:195], a[172:175], v[36:39]
    ds_read_b64_tr_b16 a[212:213], v242 offset:12288
    v_mfma_f32_16x16x32_bf16 v[36:39], a[196:199], a[184:187], v[36:39]
    ds_read_b64_tr_b16 a[214:215], v242 offset:14336
    v_mfma_f32_16x16x32_bf16 v[68:71], a[192:195], a[176:179], v[68:71]
    v_mfma_f32_16x16x32_bf16 v[68:71], a[196:199], a[188:191], v[68:71]
    s_waitcnt lgkmcnt(4)
    buffer_load_dwordx4 v252, s[20:23], s73 offen offset:2048 lds
    v_mfma_f32_16x16x32_bf16 v[12:15], a[200:203], a[168:171], v[12:15]
    s_add_u32 s73, s73, 7168
    ds_read_b64_tr_b16 a[192:193], v243 offset:8192
    v_mfma_f32_16x16x32_bf16 v[12:15], a[204:207], a[180:183], v[12:15]
    ds_read_b64_tr_b16 a[194:195], v243 offset:10240
    v_mfma_f32_16x16x32_bf16 v[44:47], a[200:203], a[172:175], v[44:47]
    ds_read_b64_tr_b16 a[196:197], v243 offset:12288
    v_mfma_f32_16x16x32_bf16 v[44:47], a[204:207], a[184:187], v[44:47]
    ds_read_b64_tr_b16 a[198:199], v243 offset:14336
    v_mfma_f32_16x16x32_bf16 v[76:79], a[200:203], a[176:179], v[76:79]
    v_mfma_f32_16x16x32_bf16 v[76:79], a[204:207], a[188:191], v[76:79]
    s_waitcnt lgkmcnt(4)
    buffer_load_dwordx4 v252, s[20:23], s73 offen offset:3072 lds
    v_mfma_f32_16x16x32_bf16 v[20:23], a[208:211], a[168:171], v[20:23]
L_hopa_12:
    s_cbranch_execz L_backa
    v_cvt_pk_bf16_f32 v12, v12, v13
    v_cvt_pk_bf16_f32 v13, v14, v15
    v_mfma_f32_16x16x32_bf16 v[20:23], a[212:215], a[180:183], v[20:23]
    s_waitcnt vmcnt(14) lgkmcnt(0)
    v_cvt_pk_bf16_f32 v14, v4, v5
    v_cvt_pk_bf16_f32 v15, v6, v7
    s_xor_b32 s77, s76, 8388608
    v_mfma_f32_16x16x32_bf16 v[52:55], a[208:211], a[172:175], v[52:55]
    s_barrier
    ds_read_b64_tr_b16 a[200:201], v240 offset:16384
    ds_read_b64_tr_b16 a[202:203], v240 offset:18432
    v_mfma_f32_16x16x32_bf16 v[52:55], a[212:215], a[184:187], v[52:55]
    s_add_u32 m0, s70, 8192
    ds_read_b64_tr_b16 a[204:205], v240 offset:20480
    v_add_u32_e64 v254, s36, 1
    v_mfma_f32_16x16x32_bf16 v[84:87], a[208:211], a[176:179], v[84:87]
    s_xor_b32 s73, s72, 262400
    ds_read_b64_tr_b16 a[206:207], v240 offset:22528
    v_mfma_f32_16x16x32_bf16 v[84:87], a[212:215], a[188:191], v[84:87]
    buffer_load_dwordx4 v252, s[20:23], s73 offen offset:0 lds
    v_mfma_f32_16x16x32_bf16 v[28:31], a[192:195], a[168:171], v[28:31]
    s_add_u32 s73, s73, 7168
    ds_read_b64_tr_b16 a[208:209], v241 offset:16384
    v_mfma_f32_16x16x32_bf16 v[28:31], a[196:199], a[180:183], v[28:31]
    ds_read_b64_tr_b16 a[210:211], v241 offset:18432
    v_mfma_f32_16x16x32_bf16 v[60:63], a[192:195], a[172:175], v[60:63]
    ds_read_b64_tr_b16 a[212:213], v241 offset:20480
    v_mfma_f32_16x16x32_bf16 v[60:63], a[196:199], a[184:187], v[60:63]
    ds_read_b64_tr_b16 a[214:215], v241 offset:22528
    v_mfma_f32_16x16x32_bf16 v[92:95], a[192:195], a[176:179], v[92:95]
    v_mfma_f32_16x16x32_bf16 v[92:95], a[196:199], a[188:191], v[92:95]
    s_waitcnt lgkmcnt(4)
    buffer_load_dwordx4 v252, s[20:23], s73 offen offset:1024 lds
    v_mfma_f32_16x16x32_bf16 v[100:103], a[200:203], v[0:3], 0
    s_add_u32 s73, s73, 7168
    ds_read_b64_tr_b16 a[192:193], v242 offset:16384
    v_mfma_f32_16x16x32_bf16 v[100:103], a[204:207], v[8:11], v[100:103]
    ds_read_b64_tr_b16 a[194:195], v242 offset:18432
    v_mfma_f32_16x16x32_bf16 v[132:135], a[200:203], v[32:35], 0
    ds_read_b64_tr_b16 a[196:197], v242 offset:20480
    v_mfma_f32_16x16x32_bf16 v[132:135], a[204:207], v[40:43], v[132:135]
    ds_read_b64_tr_b16 a[198:199], v242 offset:22528
    v_mfma_f32_16x16x32_bf16 v[164:167], a[200:203], v[64:67], 0
    buffer_store_dwordx4 v[12:15], v253, s[24:27], s77 offen sc1
    v_mfma_f32_16x16x32_bf16 v[164:167], a[204:207], v[72:75], v[164:167]
    s_waitcnt lgkmcnt(4)
    buffer_load_dwordx4 v252, s[20:23], s73 offen offset:2048 lds
    v_mfma_f32_16x16x32_bf16 v[108:111], a[208:211], v[0:3], 0
    s_add_u32 s73, s73, 7168
    ds_read_b64_tr_b16 a[200:201], v243 offset:16384
    v_cvt_pk_bf16_f32 v44, v44, v45
    v_mfma_f32_16x16x32_bf16 v[108:111], a[212:215], v[8:11], v[108:111]
    ds_read_b64_tr_b16 a[202:203], v243 offset:18432
    v_cvt_pk_bf16_f32 v45, v46, v47
    v_mfma_f32_16x16x32_bf16 v[140:143], a[208:211], v[32:35], 0
    ds_read_b64_tr_b16 a[204:205], v243 offset:20480
    v_cvt_pk_bf16_f32 v46, v36, v37
    v_mfma_f32_16x16x32_bf16 v[140:143], a[212:215], v[40:43], v[140:143]
    ds_read_b64_tr_b16 a[206:207], v243 offset:22528
    v_cvt_pk_bf16_f32 v47, v38, v39
    s_xor_b32 s77, s76, 9437184
    v_mfma_f32_16x16x32_bf16 v[172:175], a[208:211], v[64:67], 0
    v_mfma_f32_16x16x32_bf16 v[172:175], a[212:215], v[72:75], v[172:175]
    s_waitcnt lgkmcnt(4)
    buffer_load_dwordx4 v252, s[20:23], s73 offen offset:3072 lds
    v_mfma_f32_16x16x32_bf16 v[116:119], a[192:195], v[0:3], 0
    v_mfma_f32_16x16x32_bf16 v[116:119], a[196:199], v[8:11], v[116:119]
    s_waitcnt vmcnt(14) lgkmcnt(0)
    v_mfma_f32_16x16x32_bf16 v[148:151], a[192:195], v[32:35], 0
    s_barrier
    ds_read_b64_tr_b16 a[208:209], v240 offset:57344
    ds_read_b64_tr_b16 a[210:211], v240 offset:59392
    v_mfma_f32_16x16x32_bf16 v[148:151], a[196:199], v[40:43], v[148:151]
    s_add_u32 m0, s70, 16384
    ds_read_b64_tr_b16 a[212:213], v240 offset:61440
    v_mfma_f32_16x16x32_bf16 v[180:183], a[192:195], v[64:67], 0
    s_xor_b32 s73, s72, 327936
    ds_read_b64_tr_b16 a[214:215], v240 offset:63488
    v_mfma_f32_16x16x32_bf16 v[180:183], a[196:199], v[72:75], v[180:183]
    buffer_load_dwordx4 v252, s[20:23], s73 offen offset:0 lds
    v_mfma_f32_16x16x32_bf16 v[124:127], a[200:203], v[0:3], 0
    s_add_u32 s73, s73, 7168
    ds_read_b64_tr_b16 a[192:193], v241 offset:57344
    v_mfma_f32_16x16x32_bf16 v[124:127], a[204:207], v[8:11], v[124:127]
    ds_read_b64_tr_b16 a[194:195], v241 offset:59392
    v_mfma_f32_16x16x32_bf16 v[156:159], a[200:203], v[32:35], 0
    ds_read_b64_tr_b16 a[196:197], v241 offset:61440
    v_mfma_f32_16x16x32_bf16 v[156:159], a[204:207], v[40:43], v[156:159]
    ds_read_b64_tr_b16 a[198:199], v241 offset:63488
    v_mfma_f32_16x16x32_bf16 v[188:191], a[200:203], v[64:67], 0
    buffer_store_dwordx4 v[44:47], v253, s[24:27], s77 offen sc1
    v_mfma_f32_16x16x32_bf16 v[188:191], a[204:207], v[72:75], v[188:191]
    s_waitcnt lgkmcnt(4)
    buffer_load_dwordx4 v252, s[20:23], s73 offen offset:1024 lds
    v_mfma_f32_16x16x32_bf16 v[100:103], a[208:211], v[16:19], v[100:103]
    s_add_u32 s73, s73, 7168
    ds_read_b64_tr_b16 a[200:201], v242 offset:57344
    v_cvt_pk_bf16_f32 v76, v76, v77
    v_mfma_f32_16x16x32_bf16 v[100:103], a[212:215], v[24:27], v[100:103]
    ds_read_b64_tr_b16 a[202:203], v242 offset:59392
    v_cvt_pk_bf16_f32 v77, v78, v79
    v_mfma_f32_16x16x32_bf16 v[132:135], a[208:211], v[48:51], v[132:135]
    ds_read_b64_tr_b16 a[204:205], v242 offset:61440
    v_cvt_pk_bf16_f32 v78, v68, v69
    v_mfma_f32_16x16x32_bf16 v[132:135], a[212:215], v[56:59], v[132:135]
    ds_read_b64_tr_b16 a[206:207], v242 offset:63488
    v_cvt_pk_bf16_f32 v79, v70, v71
    s_xor_b32 s77, s76, 10485760
    v_mfma_f32_16x16x32_bf16 v[164:167], a[208:211], v[80:83], v[164:167]
    v_mfma_f32_16x16x32_bf16 v[164:167], a[212:215], v[88:91], v[164:167]
    s_waitcnt lgkmcnt(4)
    buffer_load_dwordx4 v252, s[20:23], s73 offen offset:2048 lds
    v_mfma_f32_16x16x32_bf16 v[108:111], a[192:195], v[16:19], v[108:111]
    s_add_u32 s73, s73, 7168
    ds_read_b64_tr_b16 a[208:209], v243 offset:57344
    v_mfma_f32_16x16x32_bf16 v[108:111], a[196:199], v[24:27], v[108:111]
    ds_read_b64_tr_b16 a[210:211], v243 offset:59392
    v_mfma_f32_16x16x32_bf16 v[140:143], a[192:195], v[48:51], v[140:143]
    ds_read_b64_tr_b16 a[212:213], v243 offset:61440
    v_mfma_f32_16x16x32_bf16 v[140:143], a[196:199], v[56:59], v[140:143]
    ds_read_b64_tr_b16 a[214:215], v243 offset:63488
    v_mfma_f32_16x16x32_bf16 v[172:175], a[192:195], v[80:83], v[172:175]
    v_mfma_f32_16x16x32_bf16 v[172:175], a[196:199], v[88:91], v[172:175]
    s_waitcnt lgkmcnt(4)
    buffer_load_dwordx4 v252, s[20:23], s73 offen offset:3072 lds
    v_mfma_f32_16x16x32_bf16 v[116:119], a[200:203], v[16:19], v[116:119]
    v_mfma_f32_16x16x32_bf16 v[116:119], a[204:207], v[24:27], v[116:119]
    s_waitcnt vmcnt(14) lgkmcnt(0)
    v_mfma_f32_16x16x32_bf16 v[148:151], a[200:203], v[48:51], v[148:151]
    s_barrier
    ds_read_b64_tr_b16 a[192:193], v240 offset:24576
    ds_read_b64_tr_b16 a[194:195], v240 offset:26624
    v_mfma_f32_16x16x32_bf16 v[148:151], a[204:207], v[56:59], v[148:151]
    s_add_u32 m0, s70, 57344
    ds_read_b64_tr_b16 a[196:197], v240 offset:28672
    v_mfma_f32_16x16x32_bf16 v[180:183], a[200:203], v[80:83], v[180:183]
    s_xor_b32 s73, s72, 393472
    ds_read_b64_tr_b16 a[198:199], v240 offset:30720
    buffer_store_dwordx4 v[76:79], v253, s[24:27], s77 offen sc1
    v_mfma_f32_16x16x32_bf16 v[180:183], a[204:207], v[88:91], v[180:183]
    buffer_load_dwordx4 v252, s[20:23], s73 offen offset:0 lds
    v_mfma_f32_16x16x32_bf16 v[124:127], a[208:211], v[16:19], v[124:127]
    s_add_u32 s73, s73, 7168
    ds_read_b64_tr_b16 a[200:201], v241 offset:24576
    v_cvt_pk_bf16_f32 v28, v28, v29
    v_mfma_f32_16x16x32_bf16 v[124:127], a[212:215], v[24:27], v[124:127]
    ds_read_b64_tr_b16 a[202:203], v241 offset:26624
    v_cvt_pk_bf16_f32 v29, v30, v31
    v_mfma_f32_16x16x32_bf16 v[156:159], a[208:211], v[48:51], v[156:159]
    ds_read_b64_tr_b16 a[204:205], v241 offset:28672
    v_cvt_pk_bf16_f32 v30, v20, v21
    v_mfma_f32_16x16x32_bf16 v[156:159], a[212:215], v[56:59], v[156:159]
    ds_read_b64_tr_b16 a[206:207], v241 offset:30720
    v_cvt_pk_bf16_f32 v31, v22, v23
    s_xor_b32 s77, s76, 12582912
    v_mfma_f32_16x16x32_bf16 v[188:191], a[208:211], v[80:83], v[188:191]
    v_mfma_f32_16x16x32_bf16 v[188:191], a[212:215], v[88:91], v[188:191]
    s_waitcnt lgkmcnt(4)
    buffer_load_dwordx4 v252, s[20:23], s73 offen offset:1024 lds
    v_mfma_f32_16x16x32_bf16 v[100:103], a[192:195], v[96:99], v[100:103]
    s_add_u32 s73, s73, 7168
    ds_read_b64_tr_b16 a[208:209], v242 offset:24576
    v_mfma_f32_16x16x32_bf16 v[100:103], a[196:199], v[104:107], v[100:103]
    ds_read_b64_tr_b16 a[210:211], v242 offset:26624
    v_mfma_f32_16x16x32_bf16 v[132:135], a[192:195], v[128:131], v[132:135]
    ds_read_b64_tr_b16 a[212:213], v242 offset:28672
    v_mfma_f32_16x16x32_bf16 v[132:135], a[196:199], v[136:139], v[132:135]
    ds_read_b64_tr_b16 a[214:215], v242 offset:30720
    v_mfma_f32_16x16x32_bf16 v[164:167], a[192:195], v[160:163], v[164:167]
    v_mfma_f32_16x16x32_bf16 v[164:167], a[196:199], v[168:171], v[164:167]
    s_waitcnt lgkmcnt(4)
    buffer_load_dwordx4 v252, s[20:23], s73 offen offset:2048 lds
    v_mfma_f32_16x16x32_bf16 v[108:111], a[200:203], v[96:99], v[108:111]
    s_add_u32 s73, s73, 7168
    ds_read_b64_tr_b16 a[192:193], v243 offset:24576
    v_mfma_f32_16x16x32_bf16 v[108:111], a[204:207], v[104:107], v[108:111]
    ds_read_b64_tr_b16 a[194:195], v243 offset:26624
    v_mfma_f32_16x16x32_bf16 v[140:143], a[200:203], v[128:131], v[140:143]
    ds_read_b64_tr_b16 a[196:197], v243 offset:28672
    v_mfma_f32_16x16x32_bf16 v[140:143], a[204:207], v[136:139], v[140:143]
    ds_read_b64_tr_b16 a[198:199], v243 offset:30720
    v_mfma_f32_16x16x32_bf16 v[172:175], a[200:203], v[160:163], v[172:175]
    buffer_store_dwordx4 v[28:31], v253, s[24:27], s77 offen sc1
    v_mfma_f32_16x16x32_bf16 v[172:175], a[204:207], v[168:171], v[172:175]
    s_waitcnt lgkmcnt(4)
    buffer_load_dwordx4 v252, s[20:23], s73 offen offset:3072 lds
    v_mfma_f32_16x16x32_bf16 v[116:119], a[208:211], v[96:99], v[116:119]
    v_cvt_pk_bf16_f32 v60, v60, v61
    v_cvt_pk_bf16_f32 v61, v62, v63
    v_mfma_f32_16x16x32_bf16 v[116:119], a[212:215], v[104:107], v[116:119]
    s_waitcnt vmcnt(16) lgkmcnt(0)
    v_cvt_pk_bf16_f32 v62, v52, v53
    v_cvt_pk_bf16_f32 v63, v54, v55
    s_xor_b32 s77, s76, 13631488
    v_mfma_f32_16x16x32_bf16 v[148:151], a[208:211], v[128:131], v[148:151]
    s_barrier
    ds_read_b64_tr_b16 a[200:201], v240 offset:49152
    ds_read_b64_tr_b16 a[202:203], v240 offset:51200
    v_mfma_f32_16x16x32_bf16 v[148:151], a[212:215], v[136:139], v[148:151]
    s_add_u32 m0, s70, 24576
    buffer_store_dword v254, off, s[24:27], s35 sc1
    v_mfma_f32_16x16x32_bf16 v[180:183], a[208:211], v[160:163], v[180:183]
    s_xor_b32 s73, s72, 459008
    ds_read_b64_tr_b16 a[204:205], v240 offset:53248
    ds_read_b64_tr_b16 a[206:207], v240 offset:55296
    v_mfma_f32_16x16x32_bf16 v[180:183], a[212:215], v[168:171], v[180:183]
    buffer_load_dwordx4 v252, s[20:23], s73 offen offset:0 lds
    v_mfma_f32_16x16x32_bf16 v[124:127], a[192:195], v[96:99], v[124:127]
    s_add_u32 s73, s73, 7168
    ds_read_b64_tr_b16 a[208:209], v241 offset:49152
    v_add_u32 v254, 1, v254
    v_mfma_f32_16x16x32_bf16 v[124:127], a[196:199], v[104:107], v[124:127]
    ds_read_b64_tr_b16 a[210:211], v241 offset:51200
    v_mfma_f32_16x16x32_bf16 v[156:159], a[192:195], v[128:131], v[156:159]
    ds_read_b64_tr_b16 a[212:213], v241 offset:53248
    v_mfma_f32_16x16x32_bf16 v[156:159], a[196:199], v[136:139], v[156:159]
    ds_read_b64_tr_b16 a[214:215], v241 offset:55296
    v_mfma_f32_16x16x32_bf16 v[188:191], a[192:195], v[160:163], v[188:191]
    v_mfma_f32_16x16x32_bf16 v[188:191], a[196:199], v[168:171], v[188:191]
    s_waitcnt lgkmcnt(4)
    buffer_load_dwordx4 v252, s[20:23], s73 offen offset:1024 lds
    v_mfma_f32_16x16x32_bf16 v[100:103], a[200:203], v[112:115], v[100:103]
    s_add_u32 s73, s73, 7168
    ds_read_b64_tr_b16 a[192:193], v242 offset:49152
    v_mfma_f32_16x16x32_bf16 v[100:103], a[204:207], v[120:123], v[100:103]
    ds_read_b64_tr_b16 a[194:195], v242 offset:51200
    v_mfma_f32_16x16x32_bf16 v[132:135], a[200:203], v[144:147], v[132:135]
    ds_read_b64_tr_b16 a[196:197], v242 offset:53248
    v_mfma_f32_16x16x32_bf16 v[132:135], a[204:207], v[152:155], v[132:135]
    ds_read_b64_tr_b16 a[198:199], v242 offset:55296
    v_mfma_f32_16x16x32_bf16 v[164:167], a[200:203], v[176:179], v[164:167]
    buffer_store_dwordx4 v[60:63], v253, s[24:27], s77 offen sc1
    v_mfma_f32_16x16x32_bf16 v[164:167], a[204:207], v[184:187], v[164:167]
    s_waitcnt lgkmcnt(4)
    buffer_load_dwordx4 v252, s[20:23], s73 offen offset:2048 lds
    v_mfma_f32_16x16x32_bf16 v[108:111], a[208:211], v[112:115], v[108:111]
    s_add_u32 s73, s73, 7168
    ds_read_b64_tr_b16 a[200:201], v243 offset:49152
    v_cvt_pk_bf16_f32 v92, v92, v93
    v_mfma_f32_16x16x32_bf16 v[108:111], a[212:215], v[120:123], v[108:111]
    ds_read_b64_tr_b16 a[202:203], v243 offset:51200
    v_cvt_pk_bf16_f32 v93, v94, v95
    v_mfma_f32_16x16x32_bf16 v[140:143], a[208:211], v[144:147], v[140:143]
    ds_read_b64_tr_b16 a[204:205], v243 offset:53248
    v_cvt_pk_bf16_f32 v94, v84, v85
    v_mfma_f32_16x16x32_bf16 v[140:143], a[212:215], v[152:155], v[140:143]
    ds_read_b64_tr_b16 a[206:207], v243 offset:55296
    v_cvt_pk_bf16_f32 v95, v86, v87
    s_xor_b32 s77, s76, 14680064
    v_mfma_f32_16x16x32_bf16 v[172:175], a[208:211], v[176:179], v[172:175]
    v_mfma_f32_16x16x32_bf16 v[172:175], a[212:215], v[184:187], v[172:175]
    s_waitcnt lgkmcnt(4)
    buffer_load_dwordx4 v252, s[20:23], s73 offen offset:3072 lds
    v_mfma_f32_16x16x32_bf16 v[116:119], a[192:195], v[112:115], v[116:119]
    v_mfma_f32_16x16x32_bf16 v[116:119], a[196:199], v[120:123], v[116:119]
    s_waitcnt vmcnt(17) lgkmcnt(0)
    v_mfma_f32_16x16x32_bf16 v[148:151], a[192:195], v[144:147], v[148:151]
    s_barrier
    ds_read_b64_tr_b16 a[208:209], v240 offset:8192
    ds_read_b64_tr_b16 a[210:211], v240 offset:10240
    v_mfma_f32_16x16x32_bf16 v[148:151], a[196:199], v[152:155], v[148:151]
    s_add_u32 m0, s70, 49152
    ds_read_b64_tr_b16 a[212:213], v240 offset:12288
    v_mfma_f32_16x16x32_bf16 v[180:183], a[192:195], v[176:179], v[180:183]
    s_xor_b32 s73, s49, 512
    ds_read_b64_tr_b16 a[214:215], v240 offset:14336
    v_mfma_f32_16x16x32_bf16 v[180:183], a[196:199], v[184:187], v[180:183]
    buffer_load_dwordx4 v252, s[20:23], s73 offen offset:0 lds
    v_mfma_f32_16x16x32_bf16 v[124:127], a[200:203], v[112:115], v[124:127]
    s_add_u32 s73, s73, 7168
    ds_read_b64_tr_b16 a[192:193], v241 offset:8192
    v_mfma_f32_16x16x32_bf16 v[124:127], a[204:207], v[120:123], v[124:127]
    ds_read_b64_tr_b16 a[194:195], v241 offset:10240
    v_mfma_f32_16x16x32_bf16 v[156:159], a[200:203], v[144:147], v[156:159]
    ds_read_b64_tr_b16 a[196:197], v241 offset:12288
    v_mfma_f32_16x16x32_bf16 v[156:159], a[204:207], v[152:155], v[156:159]
    ds_read_b64_tr_b16 a[198:199], v241 offset:14336
    v_mfma_f32_16x16x32_bf16 v[188:191], a[200:203], v[176:179], v[188:191]
    buffer_store_dwordx4 v[92:95], v253, s[24:27], s77 offen sc1
    v_mfma_f32_16x16x32_bf16 v[188:191], a[204:207], v[184:187], v[188:191]
    s_waitcnt lgkmcnt(4)
    buffer_load_dwordx4 v252, s[20:23], s73 offen offset:1024 lds
    v_mfma_f32_16x16x32_bf16 v[100:103], a[208:211], a[96:99], v[100:103]
    s_add_u32 s73, s73, 7168
    ds_read_b64_tr_b16 a[200:201], v242 offset:8192
    v_mfma_f32_16x16x32_bf16 v[100:103], a[212:215], a[108:111], v[100:103]
    ds_read_b64_tr_b16 a[202:203], v242 offset:10240
    v_mfma_f32_16x16x32_bf16 v[132:135], a[208:211], a[100:103], v[132:135]
    ds_read_b64_tr_b16 a[204:205], v242 offset:12288
    v_mfma_f32_16x16x32_bf16 v[132:135], a[212:215], a[112:115], v[132:135]
    ds_read_b64_tr_b16 a[206:207], v242 offset:14336
    v_mfma_f32_16x16x32_bf16 v[164:167], a[208:211], a[104:107], v[164:167]
    v_mfma_f32_16x16x32_bf16 v[164:167], a[212:215], a[116:119], v[164:167]
    s_waitcnt lgkmcnt(4)
    buffer_load_dwordx4 v252, s[20:23], s73 offen offset:2048 lds
    v_mfma_f32_16x16x32_bf16 v[108:111], a[192:195], a[96:99], v[108:111]
    s_add_u32 s73, s73, 7168
    ds_read_b64_tr_b16 a[208:209], v243 offset:8192
    v_mfma_f32_16x16x32_bf16 v[108:111], a[196:199], a[108:111], v[108:111]
    ds_read_b64_tr_b16 a[210:211], v243 offset:10240
    v_mfma_f32_16x16x32_bf16 v[140:143], a[192:195], a[100:103], v[140:143]
    ds_read_b64_tr_b16 a[212:213], v243 offset:12288
    v_mfma_f32_16x16x32_bf16 v[140:143], a[196:199], a[112:115], v[140:143]
    ds_read_b64_tr_b16 a[214:215], v243 offset:14336
    v_mfma_f32_16x16x32_bf16 v[172:175], a[192:195], a[104:107], v[172:175]
    v_mfma_f32_16x16x32_bf16 v[172:175], a[196:199], a[116:119], v[172:175]
    s_waitcnt lgkmcnt(4)
    buffer_load_dwordx4 v252, s[20:23], s73 offen offset:3072 lds
    v_mfma_f32_16x16x32_bf16 v[116:119], a[200:203], a[96:99], v[116:119]
    v_mfma_f32_16x16x32_bf16 v[116:119], a[204:207], a[108:111], v[116:119]
    s_waitcnt vmcnt(17) lgkmcnt(0)
    v_mfma_f32_16x16x32_bf16 v[148:151], a[200:203], a[100:103], v[148:151]
    s_barrier
    ds_read_b64_tr_b16 a[192:193], v240 offset:16384
    ds_read_b64_tr_b16 a[194:195], v240 offset:18432
    v_mfma_f32_16x16x32_bf16 v[148:151], a[204:207], a[112:115], v[148:151]
    s_add_u32 m0, s70, 8192
    ds_read_b64_tr_b16 a[196:197], v240 offset:20480
    v_mfma_f32_16x16x32_bf16 v[180:183], a[200:203], a[104:107], v[180:183]
    s_xor_b32 s73, s49, 66048
    ds_read_b64_tr_b16 a[198:199], v240 offset:22528
    v_mfma_f32_16x16x32_bf16 v[180:183], a[204:207], a[116:119], v[180:183]
    buffer_load_dwordx4 v252, s[20:23], s73 offen offset:0 lds
    v_mfma_f32_16x16x32_bf16 v[124:127], a[208:211], a[96:99], v[124:127]
    s_add_u32 s73, s73, 7168
    ds_read_b64_tr_b16 a[200:201], v241 offset:16384
    v_mfma_f32_16x16x32_bf16 v[124:127], a[212:215], a[108:111], v[124:127]
    ds_read_b64_tr_b16 a[202:203], v241 offset:18432
    v_mfma_f32_16x16x32_bf16 v[156:159], a[208:211], a[100:103], v[156:159]
    ds_read_b64_tr_b16 a[204:205], v241 offset:20480
    v_mfma_f32_16x16x32_bf16 v[156:159], a[212:215], a[112:115], v[156:159]
    ds_read_b64_tr_b16 a[206:207], v241 offset:22528
    v_mfma_f32_16x16x32_bf16 v[188:191], a[208:211], a[104:107], v[188:191]
    v_mfma_f32_16x16x32_bf16 v[188:191], a[212:215], a[116:119], v[188:191]
    s_waitcnt lgkmcnt(4)
    buffer_load_dwordx4 v252, s[20:23], s73 offen offset:1024 lds
    v_mfma_f32_16x16x32_bf16 v[100:103], a[192:195], a[120:123], v[100:103]
    s_add_u32 s73, s73, 7168
    buffer_load_dword v255, v248, s[24:27], 0 offen sc1
    v_mfma_f32_16x16x32_bf16 v[100:103], a[196:199], a[132:135], v[100:103]
    ds_read_b64_tr_b16 a[208:209], v242 offset:16384
    v_mfma_f32_16x16x32_bf16 v[132:135], a[192:195], a[124:127], v[132:135]
    ds_read_b64_tr_b16 a[210:211], v242 offset:18432
    v_mfma_f32_16x16x32_bf16 v[132:135], a[196:199], a[136:139], v[132:135]
    ds_read_b64_tr_b16 a[212:213], v242 offset:20480
    v_mfma_f32_16x16x32_bf16 v[164:167], a[192:195], a[128:131], v[164:167]
    ds_read_b64_tr_b16 a[214:215], v242 offset:22528
    v_mfma_f32_16x16x32_bf16 v[164:167], a[196:199], a[140:143], v[164:167]
    s_waitcnt lgkmcnt(4)
    buffer_load_dwordx4 v252, s[20:23], s73 offen offset:2048 lds
    v_mfma_f32_16x16x32_bf16 v[108:111], a[200:203], a[120:123], v[108:111]
    s_add_u32 s73, s73, 7168
    ds_read_b64_tr_b16 a[192:193], v243 offset:16384
    v_mfma_f32_16x16x32_bf16 v[108:111], a[204:207], a[132:135], v[108:111]
    ds_read_b64_tr_b16 a[194:195], v243 offset:18432
    v_mfma_f32_16x16x32_bf16 v[140:143], a[200:203], a[124:127], v[140:143]
    ds_read_b64_tr_b16 a[196:197], v243 offset:20480
    v_mfma_f32_16x16x32_bf16 v[140:143], a[204:207], a[136:139], v[140:143]
    ds_read_b64_tr_b16 a[198:199], v243 offset:22528
    v_mfma_f32_16x16x32_bf16 v[172:175], a[200:203], a[128:131], v[172:175]
    v_mfma_f32_16x16x32_bf16 v[172:175], a[204:207], a[140:143], v[172:175]
    s_waitcnt lgkmcnt(4)
    buffer_load_dwordx4 v252, s[20:23], s73 offen offset:3072 lds
    v_mfma_f32_16x16x32_bf16 v[116:119], a[208:211], a[120:123], v[116:119]
    v_mfma_f32_16x16x32_bf16 v[116:119], a[212:215], a[132:135], v[116:119]
    s_waitcnt vmcnt(16) lgkmcnt(0)
    v_mfma_f32_16x16x32_bf16 v[148:151], a[208:211], a[124:127], v[148:151]
    s_barrier
    ds_read_b64_tr_b16 a[200:201], v240 offset:57344
    ds_read_b64_tr_b16 a[202:203], v240 offset:59392
    v_mfma_f32_16x16x32_bf16 v[148:151], a[212:215], a[136:139], v[148:151]
    s_add_u32 m0, s70, 16384
    ds_read_b64_tr_b16 a[204:205], v240 offset:61440
    v_mfma_f32_16x16x32_bf16 v[180:183], a[208:211], a[128:131], v[180:183]
    s_xor_b32 s73, s49, 131584
    ds_read_b64_tr_b16 a[206:207], v240 offset:63488
    v_mfma_f32_16x16x32_bf16 v[180:183], a[212:215], a[140:143], v[180:183]
    buffer_load_dwordx4 v252, s[20:23], s73 offen offset:0 lds
    v_mfma_f32_16x16x32_bf16 v[124:127], a[192:195], a[120:123], v[124:127]
    s_add_u32 s73, s73, 7168
    ds_read_b64_tr_b16 a[208:209], v241 offset:57344
    v_mfma_f32_16x16x32_bf16 v[124:127], a[196:199], a[132:135], v[124:127]
    ds_read_b64_tr_b16 a[210:211], v241 offset:59392
    v_mfma_f32_16x16x32_bf16 v[156:159], a[192:195], a[124:127], v[156:159]
    ds_read_b64_tr_b16 a[212:213], v241 offset:61440
    v_mfma_f32_16x16x32_bf16 v[156:159], a[196:199], a[136:139], v[156:159]
    ds_read_b64_tr_b16 a[214:215], v241 offset:63488
    v_mfma_f32_16x16x32_bf16 v[188:191], a[192:195], a[128:131], v[188:191]
    v_mfma_f32_16x16x32_bf16 v[188:191], a[196:199], a[140:143], v[188:191]
    s_waitcnt lgkmcnt(4)
    buffer_load_dwordx4 v252, s[20:23], s73 offen offset:1024 lds
    v_mfma_f32_16x16x32_bf16 v[100:103], a[200:203], a[144:147], v[100:103]
    s_add_u32 s73, s73, 7168
    ds_read_b64_tr_b16 a[192:193], v242 offset:57344
    v_mfma_f32_16x16x32_bf16 v[100:103], a[204:207], a[156:159], v[100:103]
    ds_read_b64_tr_b16 a[194:195], v242 offset:59392
    v_mfma_f32_16x16x32_bf16 v[132:135], a[200:203], a[148:151], v[132:135]
    ds_read_b64_tr_b16 a[196:197], v242 offset:61440
    v_mfma_f32_16x16x32_bf16 v[132:135], a[204:207], a[160:163], v[132:135]
    ds_read_b64_tr_b16 a[198:199], v242 offset:63488
    v_mfma_f32_16x16x32_bf16 v[164:167], a[200:203], a[152:155], v[164:167]
    v_mfma_f32_16x16x32_bf16 v[164:167], a[204:207], a[164:167], v[164:167]
    s_waitcnt lgkmcnt(4)
    buffer_load_dwordx4 v252, s[20:23], s73 offen offset:2048 lds
    v_mfma_f32_16x16x32_bf16 v[108:111], a[208:211], a[144:147], v[108:111]
    s_add_u32 s73, s73, 7168
    ds_read_b64_tr_b16 a[200:201], v243 offset:57344
    v_mfma_f32_16x16x32_bf16 v[108:111], a[212:215], a[156:159], v[108:111]
    ds_read_b64_tr_b16 a[202:203], v243 offset:59392
    v_mfma_f32_16x16x32_bf16 v[140:143], a[208:211], a[148:151], v[140:143]
    ds_read_b64_tr_b16 a[204:205], v243 offset:61440
    v_mfma_f32_16x16x32_bf16 v[140:143], a[212:215], a[160:163], v[140:143]
    ds_read_b64_tr_b16 a[206:207], v243 offset:63488
    v_mfma_f32_16x16x32_bf16 v[172:175], a[208:211], a[152:155], v[172:175]
    v_mfma_f32_16x16x32_bf16 v[172:175], a[212:215], a[164:167], v[172:175]
    s_waitcnt lgkmcnt(4)
    buffer_load_dwordx4 v252, s[20:23], s73 offen offset:3072 lds
    v_mfma_f32_16x16x32_bf16 v[116:119], a[192:195], a[144:147], v[116:119]
    v_mfma_f32_16x16x32_bf16 v[116:119], a[196:199], a[156:159], v[116:119]
    s_waitcnt vmcnt(14) lgkmcnt(0)
    v_mfma_f32_16x16x32_bf16 v[148:151], a[192:195], a[148:151], v[148:151]
    s_barrier
    ds_read_b64_tr_b16 a[208:209], v240 offset:24576
    ds_read_b64_tr_b16 a[210:211], v240 offset:26624
    v_mfma_f32_16x16x32_bf16 v[148:151], a[196:199], a[160:163], v[148:151]
    s_add_u32 m0, s70, 57344
    ds_read_b64_tr_b16 a[212:213], v240 offset:28672
    v_mfma_f32_16x16x32_bf16 v[180:183], a[192:195], a[152:155], v[180:183]
    s_xor_b32 s73, s49, 197120
    ds_read_b64_tr_b16 a[214:215], v240 offset:30720
    v_mfma_f32_16x16x32_bf16 v[180:183], a[196:199], a[164:167], v[180:183]
    buffer_load_dwordx4 v252, s[20:23], s73 offen offset:0 lds
    v_mfma_f32_16x16x32_bf16 v[124:127], a[200:203], a[144:147], v[124:127]
    s_add_u32 s73, s73, 7168
    ds_read_b64_tr_b16 a[192:193], v241 offset:24576
    v_mfma_f32_16x16x32_bf16 v[124:127], a[204:207], a[156:159], v[124:127]
    ds_read_b64_tr_b16 a[194:195], v241 offset:26624
    v_mfma_f32_16x16x32_bf16 v[156:159], a[200:203], a[148:151], v[156:159]
    ds_read_b64_tr_b16 a[196:197], v241 offset:28672
    v_mfma_f32_16x16x32_bf16 v[156:159], a[204:207], a[160:163], v[156:159]
    ds_read_b64_tr_b16 a[198:199], v241 offset:30720
    v_mfma_f32_16x16x32_bf16 v[188:191], a[200:203], a[152:155], v[188:191]
    v_mfma_f32_16x16x32_bf16 v[188:191], a[204:207], a[164:167], v[188:191]
    s_waitcnt lgkmcnt(4)
    buffer_load_dwordx4 v252, s[20:23], s73 offen offset:1024 lds
    v_mfma_f32_16x16x32_bf16 v[100:103], a[208:211], a[168:171], v[100:103]
    s_add_u32 s73, s73, 7168
    ds_read_b64_tr_b16 a[200:201], v242 offset:24576
    v_mfma_f32_16x16x32_bf16 v[100:103], a[212:215], a[180:183], v[100:103]
    ds_read_b64_tr_b16 a[202:203], v242 offset:26624
    v_mfma_f32_16x16x32_bf16 v[132:135], a[208:211], a[172:175], v[132:135]
    ds_read_b64_tr_b16 a[204:205], v242 offset:28672
    v_mfma_f32_16x16x32_bf16 v[132:135], a[212:215], a[184:187], v[132:135]
    ds_read_b64_tr_b16 a[206:207], v242 offset:30720
    v_mfma_f32_16x16x32_bf16 v[164:167], a[208:211], a[176:179], v[164:167]
    v_mfma_f32_16x16x32_bf16 v[164:167], a[212:215], a[188:191], v[164:167]
    s_waitcnt lgkmcnt(4)
    buffer_load_dwordx4 v252, s[20:23], s73 offen offset:2048 lds
    v_mfma_f32_16x16x32_bf16 v[108:111], a[192:195], a[168:171], v[108:111]
    s_add_u32 s73, s73, 7168
    ds_read_b64_tr_b16 a[208:209], v243 offset:24576
    v_mfma_f32_16x16x32_bf16 v[108:111], a[196:199], a[180:183], v[108:111]
    ds_read_b64_tr_b16 a[210:211], v243 offset:26624
    v_mfma_f32_16x16x32_bf16 v[140:143], a[192:195], a[172:175], v[140:143]
    ds_read_b64_tr_b16 a[212:213], v243 offset:28672
    v_mfma_f32_16x16x32_bf16 v[140:143], a[196:199], a[184:187], v[140:143]
    s_waitcnt vmcnt(9)
    ds_read_b64_tr_b16 a[214:215], v243 offset:30720
    v_cmp_eq_u32_e64 s[36:37], v250, v255
    v_mfma_f32_16x16x32_bf16 v[172:175], a[192:195], a[176:179], v[172:175]
    s_xor_b32 s55, s50, 12288
    v_mfma_f32_16x16x32_bf16 v[172:175], a[196:199], a[188:191], v[172:175]
    s_waitcnt lgkmcnt(4)
    buffer_load_dwordx4 v252, s[20:23], s73 offen offset:3072 lds
    v_mfma_f32_16x16x32_bf16 v[116:119], a[200:203], a[168:171], v[116:119]
    s_and_b32 s36, s36, 0x88
    s_cbranch_scc1 L_spinB
L_spinB_back:
    v_cvt_pk_bf16_f32 v100, v100, v101
    v_cvt_pk_bf16_f32 v101, v102, v103
    v_mfma_f32_16x16x32_bf16 v[116:119], a[204:207], a[180:183], v[116:119]
    s_waitcnt lgkmcnt(0)
    v_add_u32 v250, 2, v250
    v_cvt_pk_bf16_f32 v102, v108, v109
    v_mfma_f32_16x16x32_bf16 v[148:151], a[200:203], a[172:175], v[148:151]
    s_barrier
    buffer_load_dwordx4 a[0:3], v253, s[24:27], s55 offen sc1
    v_mfma_f32_16x16x32_bf16 v[148:151], a[204:207], a[184:187], v[148:151]
    s_add_u32 m0, s70, 24576
    ds_read_b64_tr_b16 a[192:193], v244 offset:49152
    ds_read_b64_tr_b16 a[194:195], v244 offset:51200
    v_mfma_f32_16x16x32_bf16 v[180:183], a[200:203], a[176:179], v[180:183]
    s_xor_b32 s73, s49, 0
    ds_read_b64_tr_b16 a[196:197], v244 offset:53248
    ds_read_b64_tr_b16 a[198:199], v244 offset:55296
    v_mfma_f32_16x16x32_bf16 v[180:183], a[204:207], a[188:191], v[180:183]
    buffer_load_dwordx4 v252, s[20:23], s73 offen offset:0 lds
    v_mfma_f32_16x16x32_bf16 v[124:127], a[208:211], a[168:171], v[124:127]
    s_add_u32 s73, s73, 7168
    ds_read_b64_tr_b16 a[200:201], v245 offset:49152
    v_cvt_pk_bf16_f32 v103, v110, v111
    s_xor_b32 s77, s76, 16777216
    v_mfma_f32_16x16x32_bf16 v[124:127], a[212:215], a[180:183], v[124:127]
    ds_read_b64_tr_b16 a[202:203], v245 offset:51200
    v_mfma_f32_16x16x32_bf16 v[156:159], a[208:211], a[172:175], v[156:159]
    ds_read_b64_tr_b16 a[204:205], v245 offset:53248
    v_mfma_f32_16x16x32_bf16 v[156:159], a[212:215], a[184:187], v[156:159]
    ds_read_b64_tr_b16 a[206:207], v245 offset:55296
    v_mfma_f32_16x16x32_bf16 v[188:191], a[208:211], a[176:179], v[188:191]
    s_xor_b32 s55, s50, 28672
    v_mfma_f32_16x16x32_bf16 v[188:191], a[212:215], a[188:191], v[188:191]
    s_waitcnt lgkmcnt(4)
    buffer_load_dwordx4 v252, s[20:23], s73 offen offset:1024 lds
    v_mfma_f32_16x16x32_bf16 v[192:195], a[192:195], v[0:3], 0
    s_add_u32 s73, s73, 7168
    ds_read_b64_tr_b16 a[208:209], v246 offset:49152
    v_mfma_f32_16x16x32_bf16 v[192:195], a[196:199], v[8:11], v[192:195]
    ds_read_b64_tr_b16 a[210:211], v246 offset:51200
    v_mfma_f32_16x16x32_bf16 v[196:199], a[192:195], v[32:35], 0
    buffer_load_dwordx4 a[8:11], v253, s[24:27], s55 offen sc1
    v_mfma_f32_16x16x32_bf16 v[196:199], a[196:199], v[40:43], v[196:199]
    ds_read_b64_tr_b16 a[212:213], v246 offset:53248
    v_mfma_f32_16x16x32_bf16 v[200:203], a[192:195], v[64:67], 0
    ds_read_b64_tr_b16 a[214:215], v246 offset:55296
    buffer_store_dwordx4 v[100:103], v253, s[24:27], s77 offen sc1
    v_mfma_f32_16x16x32_bf16 v[200:203], a[196:199], v[72:75], v[200:203]
    s_waitcnt lgkmcnt(4)
    buffer_load_dwordx4 v252, s[20:23], s73 offen offset:2048 lds
    v_mfma_f32_16x16x32_bf16 v[204:207], a[200:203], v[0:3], 0
    s_add_u32 s73, s73, 7168
    ds_read_b64_tr_b16 a[192:193], v247 offset:49152
    v_cvt_pk_bf16_f32 v132, v132, v133
    v_mfma_f32_16x16x32_bf16 v[204:207], a[204:207], v[8:11], v[204:207]
    ds_read_b64_tr_b16 a[194:195], v247 offset:51200
    v_cvt_pk_bf16_f32 v133, v134, v135
    v_mfma_f32_16x16x32_bf16 v[208:211], a[200:203], v[32:35], 0
L_hopa_13:
    s_cbranch_execz L_backa
    ds_read_b64_tr_b16 a[196:197], v247 offset:53248
    v_cvt_pk_bf16_f32 v134, v140, v141
    v_mfma_f32_16x16x32_bf16 v[208:211], a[204:207], v[40:43], v[208:211]
    ds_read_b64_tr_b16 a[198:199], v247 offset:55296
    v_cvt_pk_bf16_f32 v135, v142, v143
    s_xor_b32 s77, s76, 17825792
    v_mfma_f32_16x16x32_bf16 v[212:215], a[200:203], v[64:67], 0
    s_xor_b32 s55, s50, 1060864
    v_mfma_f32_16x16x32_bf16 v[212:215], a[204:207], v[72:75], v[212:215]
    s_waitcnt lgkmcnt(4)
    buffer_load_dwordx4 v252, s[20:23], s73 offen offset:3072 lds
    v_mfma_f32_16x16x32_bf16 v[192:195], a[208:211], a[96:99], v[192:195]
    v_mfma_f32_16x16x32_bf16 v[192:195], a[212:215], a[108:111], v[192:195]
    s_waitcnt vmcnt(15) lgkmcnt(0)
    v_mfma_f32_16x16x32_bf16 v[196:199], a[208:211], a[100:103], v[196:199]
    s_barrier
    buffer_load_dwordx4 a[28:31], v253, s[24:27], s55 offen sc1
    v_mfma_f32_16x16x32_bf16 v[196:199], a[212:215], a[112:115], v[196:199]
    s_add_u32 m0, s70, 49152
    ds_read_b64_tr_b16 a[200:201], v244 offset:8192
    ds_read_b64_tr_b16 a[202:203], v244 offset:10240
    v_mfma_f32_16x16x32_bf16 v[200:203], a[208:211], a[104:107], v[200:203]
    s_xor_b32 s73, s49, 65536
    ds_read_b64_tr_b16 a[204:205], v244 offset:12288
    ds_read_b64_tr_b16 a[206:207], v244 offset:14336
    buffer_store_dwordx4 v[132:135], v253, s[24:27], s77 offen sc1
    v_mfma_f32_16x16x32_bf16 v[200:203], a[212:215], a[116:119], v[200:203]
    buffer_load_dwordx4 v252, s[20:23], s73 offen offset:0 lds
    v_mfma_f32_16x16x32_bf16 v[204:207], a[192:195], a[96:99], v[204:207]
    s_add_u32 s73, s73, 7168
    buffer_store_dword v254, off, s[24:27], s35 sc1
    v_mfma_f32_16x16x32_bf16 v[204:207], a[196:199], a[108:111], v[204:207]
    ds_read_b64_tr_b16 a[208:209], v245 offset:8192
    v_cvt_pk_bf16_f32 v164, v164, v165
    v_mfma_f32_16x16x32_bf16 v[208:211], a[192:195], a[100:103], v[208:211]
    ds_read_b64_tr_b16 a[210:211], v245 offset:10240
    v_cvt_pk_bf16_f32 v165, v166, v167
    v_mfma_f32_16x16x32_bf16 v[208:211], a[196:199], a[112:115], v[208:211]
    ds_read_b64_tr_b16 a[212:213], v245 offset:12288
    v_cvt_pk_bf16_f32 v166, v172, v173
    v_mfma_f32_16x16x32_bf16 v[212:215], a[192:195], a[104:107], v[212:215]
    s_xor_b32 s55, s50, 1077248
    ds_read_b64_tr_b16 a[214:215], v245 offset:14336
    v_cvt_pk_bf16_f32 v167, v174, v175
    s_xor_b32 s77, s76, 18874368
    v_mfma_f32_16x16x32_bf16 v[212:215], a[196:199], a[116:119], v[212:215]
    s_waitcnt lgkmcnt(4)
    buffer_load_dwordx4 v252, s[20:23], s73 offen offset:1024 lds
    v_mfma_f32_16x16x32_bf16 v[192:195], a[200:203], v[16:19], v[192:195]
    s_add_u32 s73, s73, 7168
    ds_read_b64_tr_b16 a[192:193], v246 offset:8192
    v_mfma_f32_16x16x32_bf16 v[192:195], a[204:207], v[24:27], v[192:195]
    ds_read_b64_tr_b16 a[194:195], v246 offset:10240
    v_mfma_f32_16x16x32_bf16 v[196:199], a[200:203], v[48:51], v[196:199]
    buffer_load_dwordx4 a[36:39], v253, s[24:27], s55 offen sc1
    v_mfma_f32_16x16x32_bf16 v[196:199], a[204:207], v[56:59], v[196:199]
    ds_read_b64_tr_b16 a[196:197], v246 offset:12288
    v_mfma_f32_16x16x32_bf16 v[200:203], a[200:203], v[80:83], v[200:203]
    ds_read_b64_tr_b16 a[198:199], v246 offset:14336
    buffer_store_dwordx4 v[164:167], v253, s[24:27], s77 offen sc1
    v_mfma_f32_16x16x32_bf16 v[200:203], a[204:207], v[88:91], v[200:203]
    s_waitcnt lgkmcnt(4)
    buffer_load_dwordx4 v252, s[20:23], s73 offen offset:2048 lds
    v_mfma_f32_16x16x32_bf16 v[204:207], a[208:211], v[16:19], v[204:207]
    s_add_u32 s73, s73, 7168
    ds_read_b64_tr_b16 a[200:201], v247 offset:8192
    v_cvt_pk_bf16_f32 v116, v116, v117
    v_mfma_f32_16x16x32_bf16 v[204:207], a[212:215], v[24:27], v[204:207]
    ds_read_b64_tr_b16 a[202:203], v247 offset:10240
    v_cvt_pk_bf16_f32 v117, v118, v119
    v_mfma_f32_16x16x32_bf16 v[208:211], a[208:211], v[48:51], v[208:211]
    ds_read_b64_tr_b16 a[204:205], v247 offset:12288
    v_cvt_pk_bf16_f32 v118, v124, v125
    v_mfma_f32_16x16x32_bf16 v[208:211], a[212:215], v[56:59], v[208:211]
    ds_read_b64_tr_b16 a[206:207], v247 offset:14336
    v_cvt_pk_bf16_f32 v119, v126, v127
    s_xor_b32 s77, s76, 20971520
    v_mfma_f32_16x16x32_bf16 v[212:215], a[208:211], v[80:83], v[212:215]
    s_xor_b32 s55, s50, 2109440
    v_mfma_f32_16x16x32_bf16 v[212:215], a[212:215], v[88:91], v[212:215]
    s_waitcnt lgkmcnt(4)
    buffer_load_dwordx4 v252, s[20:23], s73 offen offset:3072 lds
    v_mfma_f32_16x16x32_bf16 v[192:195], a[192:195], a[120:123], v[192:195]
    v_mfma_f32_16x16x32_bf16 v[192:195], a[196:199], a[132:135], v[192:195]
    s_waitcnt vmcnt(20) lgkmcnt(0)
    v_mfma_f32_16x16x32_bf16 v[196:199], a[192:195], a[124:127], v[196:199]
    s_barrier
    buffer_load_dwordx4 a[56:59], v253, s[24:27], s55 offen sc1
    v_mfma_f32_16x16x32_bf16 v[196:199], a[196:199], a[136:139], v[196:199]
    s_add_u32 m0, s70, 8192
    ds_read_b64_tr_b16 a[208:209], v244 offset:16384
    ds_read_b64_tr_b16 a[210:211], v244 offset:18432
    v_mfma_f32_16x16x32_bf16 v[200:203], a[192:195], a[128:131], v[200:203]
    s_xor_b32 s73, s49, 131072
    ds_read_b64_tr_b16 a[212:213], v244 offset:20480
    ds_read_b64_tr_b16 a[214:215], v244 offset:22528
    buffer_store_dwordx4 v[116:119], v253, s[24:27], s77 offen sc1
    v_mfma_f32_16x16x32_bf16 v[200:203], a[196:199], a[140:143], v[200:203]
    buffer_load_dwordx4 v252, s[20:23], s73 offen offset:0 lds
    v_mfma_f32_16x16x32_bf16 v[204:207], a[200:203], a[120:123], v[204:207]
    s_add_u32 s73, s73, 7168
    ds_read_b64_tr_b16 a[192:193], v245 offset:16384
    v_cvt_pk_bf16_f32 v148, v148, v149
    v_mfma_f32_16x16x32_bf16 v[204:207], a[204:207], a[132:135], v[204:207]
    ds_read_b64_tr_b16 a[194:195], v245 offset:18432
    v_cvt_pk_bf16_f32 v149, v150, v151
    v_mfma_f32_16x16x32_bf16 v[208:211], a[200:203], a[124:127], v[208:211]
    ds_read_b64_tr_b16 a[196:197], v245 offset:20480
    v_cvt_pk_bf16_f32 v150, v156, v157
    v_mfma_f32_16x16x32_bf16 v[208:211], a[204:207], a[136:139], v[208:211]
    ds_read_b64_tr_b16 a[198:199], v245 offset:22528
    v_cvt_pk_bf16_f32 v151, v158, v159
    s_xor_b32 s77, s76, 22020096
    v_mfma_f32_16x16x32_bf16 v[212:215], a[200:203], a[128:131], v[212:215]
    s_xor_b32 s55, s50, 2125824
    v_mfma_f32_16x16x32_bf16 v[212:215], a[204:207], a[140:143], v[212:215]
    s_waitcnt lgkmcnt(4)
    buffer_load_dwordx4 v252, s[20:23], s73 offen offset:1024 lds
    v_mfma_f32_16x16x32_bf16 v[192:195], a[208:211], v[96:99], v[192:195]
    s_add_u32 s73, s73, 7168
    ds_read_b64_tr_b16 a[200:201], v246 offset:16384
    v_mfma_f32_16x16x32_bf16 v[192:195], a[212:215], v[104:107], v[192:195]
    ds_read_b64_tr_b16 a[202:203], v246 offset:18432
    v_mfma_f32_16x16x32_bf16 v[196:199], a[208:211], v[128:131], v[196:199]
    buffer_load_dwordx4 a[64:67], v253, s[24:27], s55 offen sc1
    v_mfma_f32_16x16x32_bf16 v[196:199], a[212:215], v[136:139], v[196:199]
    ds_read_b64_tr_b16 a[204:205], v246 offset:20480
    v_mfma_f32_16x16x32_bf16 v[200:203], a[208:211], v[160:163], v[200:203]
    ds_read_b64_tr_b16 a[206:207], v246 offset:22528
    buffer_store_dwordx4 v[148:151], v253, s[24:27], s77 offen sc1
    v_mfma_f32_16x16x32_bf16 v[200:203], a[212:215], v[168:171], v[200:203]
    s_waitcnt lgkmcnt(4)
    buffer_load_dwordx4 v252, s[20:23], s73 offen offset:2048 lds
    v_mfma_f32_16x16x32_bf16 v[204:207], a[192:195], v[96:99], v[204:207]
    s_add_u32 s73, s73, 7168
    ds_read_b64_tr_b16 a[208:209], v247 offset:16384
    v_cvt_pk_bf16_f32 v180, v180, v181
    v_mfma_f32_16x16x32_bf16 v[204:207], a[196:199], v[104:107], v[204:207]
    ds_read_b64_tr_b16 a[210:211], v247 offset:18432
    v_cvt_pk_bf16_f32 v181, v182, v183
    v_mfma_f32_16x16x32_bf16 v[208:211], a[192:195], v[128:131], v[208:211]
    ds_read_b64_tr_b16 a[212:213], v247 offset:20480
    v_cvt_pk_bf16_f32 v182, v188, v189
    v_mfma_f32_16x16x32_bf16 v[208:211], a[196:199], v[136:139], v[208:211]
    ds_read_b64_tr_b16 a[214:215], v247 offset:22528
    v_cvt_pk_bf16_f32 v183, v190, v191
    s_xor_b32 s77, s76, 23068672
    v_mfma_f32_16x16x32_bf16 v[212:215], a[192:195], v[160:163], v[212:215]
    v_mfma_f32_16x16x32_bf16 v[212:215], a[196:199], v[168:171], v[212:215]
    s_waitcnt lgkmcnt(4)
    buffer_load_dwordx4 v252, s[20:23], s73 offen offset:3072 lds
    v_mfma_f32_16x16x32_bf16 v[192:195], a[200:203], a[144:147], v[192:195]
    v_mfma_f32_16x16x32_bf16 v[192:195], a[204:207], a[156:159], v[192:195]
    s_waitcnt vmcnt(24) lgkmcnt(0)
    v_mfma_f32_16x16x32_bf16 v[196:199], a[200:203], a[148:151], v[196:199]
    s_barrier
    ds_read_b64_tr_b16 a[192:193], v244 offset:57344
    ds_read_b64_tr_b16 a[194:195], v244 offset:59392
    v_mfma_f32_16x16x32_bf16 v[196:199], a[204:207], a[160:163], v[196:199]
    s_add_u32 m0, s70, 16384
    ds_read_b64_tr_b16 a[196:197], v244 offset:61440
    v_mfma_f32_16x16x32_bf16 v[200:203], a[200:203], a[152:155], v[200:203]
    s_xor_b32 s73, s49, 196608
    ds_read_b64_tr_b16 a[198:199], v244 offset:63488
    buffer_store_dwordx4 v[180:183], v253, s[24:27], s77 offen sc1
    v_mfma_f32_16x16x32_bf16 v[200:203], a[204:207], a[164:167], v[200:203]
    buffer_load_dwordx4 v252, s[20:23], s73 offen offset:0 lds
    v_mfma_f32_16x16x32_bf16 v[204:207], a[208:211], a[144:147], v[204:207]
    s_add_u32 s73, s73, 7168
    buffer_load_dword v254, v248, s[24:27], 0 offen sc1
    v_mfma_f32_16x16x32_bf16 v[204:207], a[212:215], a[156:159], v[204:207]
    ds_read_b64_tr_b16 a[200:201], v245 offset:57344
    v_mfma_f32_16x16x32_bf16 v[208:211], a[208:211], a[148:151], v[208:211]
    ds_read_b64_tr_b16 a[202:203], v245 offset:59392
    v_mfma_f32_16x16x32_bf16 v[208:211], a[212:215], a[160:163], v[208:211]
    ds_read_b64_tr_b16 a[204:205], v245 offset:61440
    v_mfma_f32_16x16x32_bf16 v[212:215], a[208:211], a[152:155], v[212:215]
    ds_read_b64_tr_b16 a[206:207], v245 offset:63488
    v_mfma_f32_16x16x32_bf16 v[212:215], a[212:215], a[164:167], v[212:215]
    s_waitcnt lgkmcnt(4)
    buffer_load_dwordx4 v252, s[20:23], s73 offen offset:1024 lds
    v_mfma_f32_16x16x32_bf16 v[192:195], a[192:195], v[112:115], v[192:195]
    s_add_u32 s73, s73, 7168
    ds_read_b64_tr_b16 a[208:209], v246 offset:57344
    v_mfma_f32_16x16x32_bf16 v[192:195], a[196:199], v[120:123], v[192:195]
    ds_read_b64_tr_b16 a[210:211], v246 offset:59392
    v_mfma_f32_16x16x32_bf16 v[196:199], a[192:195], v[144:147], v[196:199]
    ds_read_b64_tr_b16 a[212:213], v246 offset:61440
    v_mfma_f32_16x16x32_bf16 v[196:199], a[196:199], v[152:155], v[196:199]
    ds_read_b64_tr_b16 a[214:215], v246 offset:63488
    v_mfma_f32_16x16x32_bf16 v[200:203], a[192:195], v[176:179], v[200:203]
    v_mfma_f32_16x16x32_bf16 v[200:203], a[196:199], v[184:187], v[200:203]
    s_waitcnt lgkmcnt(4)
    buffer_load_dwordx4 v252, s[20:23], s73 offen offset:2048 lds
    v_mfma_f32_16x16x32_bf16 v[204:207], a[200:203], v[112:115], v[204:207]
    s_add_u32 s73, s73, 7168
    ds_read_b64_tr_b16 a[192:193], v247 offset:57344
    v_mfma_f32_16x16x32_bf16 v[204:207], a[204:207], v[120:123], v[204:207]
    ds_read_b64_tr_b16 a[194:195], v247 offset:59392
    v_mfma_f32_16x16x32_bf16 v[208:211], a[200:203], v[144:147], v[208:211]
    ds_read_b64_tr_b16 a[196:197], v247 offset:61440
    v_mfma_f32_16x16x32_bf16 v[208:211], a[204:207], v[152:155], v[208:211]
    ds_read_b64_tr_b16 a[198:199], v247 offset:63488
    v_mfma_f32_16x16x32_bf16 v[212:215], a[200:203], v[176:179], v[212:215]
    v_mfma_f32_16x16x32_bf16 v[212:215], a[204:207], v[184:187], v[212:215]
    s_waitcnt lgkmcnt(4)
    buffer_load_dwordx4 v252, s[20:23], s73 offen offset:3072 lds
    v_mfma_f32_16x16x32_bf16 v[192:195], a[208:211], a[168:171], v[192:195]
    v_mfma_f32_16x16x32_bf16 v[192:195], a[212:215], a[180:183], v[192:195]
    s_waitcnt vmcnt(23) lgkmcnt(0)
    v_mfma_f32_16x16x32_bf16 v[196:199], a[208:211], a[172:175], v[196:199]
    s_barrier
    ds_read_b64_tr_b16 a[200:201], v244 offset:24576
    v_mfma_f32_16x16x32_bf16 v[196:199], a[212:215], a[184:187], v[196:199]
    ds_read_b64_tr_b16 a[202:203], v244 offset:26624
    v_mfma_f32_16x16x32_bf16 v[200:203], a[208:211], a[176:179], v[200:203]
    ds_read_b64_tr_b16 a[204:205], v244 offset:28672
    v_mfma_f32_16x16x32_bf16 v[200:203], a[212:215], a[188:191], v[200:203]
    ds_read_b64_tr_b16 a[206:207], v244 offset:30720
    v_mfma_f32_16x16x32_bf16 v[204:207], a[192:195], a[168:171], v[204:207]
    ds_read_b64_tr_b16 a[208:209], v245 offset:24576
    v_mfma_f32_16x16x32_bf16 v[204:207], a[196:199], a[180:183], v[204:207]
    ds_read_b64_tr_b16 a[210:211], v245 offset:26624
    v_mfma_f32_16x16x32_bf16 v[208:211], a[192:195], a[172:175], v[208:211]
    ds_read_b64_tr_b16 a[212:213], v245 offset:28672
    v_mfma_f32_16x16x32_bf16 v[208:211], a[196:199], a[184:187], v[208:211]
    ds_read_b64_tr_b16 a[214:215], v245 offset:30720
    v_mfma_f32_16x16x32_bf16 v[212:215], a[192:195], a[176:179], v[212:215]
    v_mfma_f32_16x16x32_bf16 v[212:215], a[196:199], a[188:191], v[212:215]
    s_waitcnt lgkmcnt(4)
    v_mfma_f32_16x16x32_bf16 v[216:219], a[200:203], v[0:3], 0
    ds_read_b64_tr_b16 a[192:193], v246 offset:24576
    v_cvt_pk_bf16_f32 v204, v204, v205
    v_mfma_f32_16x16x32_bf16 v[216:219], a[204:207], v[8:11], v[216:219]
    ds_read_b64_tr_b16 a[194:195], v246 offset:26624
    v_cvt_pk_bf16_f32 v205, v206, v207
    v_mfma_f32_16x16x32_bf16 v[220:223], a[200:203], v[32:35], 0
    ds_read_b64_tr_b16 a[196:197], v246 offset:28672
    v_cvt_pk_bf16_f32 v206, v192, v193
    v_mfma_f32_16x16x32_bf16 v[220:223], a[204:207], v[40:43], v[220:223]
    ds_read_b64_tr_b16 a[198:199], v246 offset:30720
    v_cvt_pk_bf16_f32 v207, v194, v195
    s_xor_b32 s77, s76, 25165824
    buffer_store_dwordx4 v[204:207], v253, s[24:27], s77 offen sc1
    v_mfma_f32_16x16x32_bf16 v[224:227], a[200:203], v[64:67], 0
    v_cvt_pk_bf16_f32 v208, v208, v209
    v_cvt_pk_bf16_f32 v209, v210, v211
    v_mfma_f32_16x16x32_bf16 v[224:227], a[204:207], v[72:75], v[224:227]
    s_waitcnt lgkmcnt(4)
    v_cvt_pk_bf16_f32 v210, v196, v197
    v_cvt_pk_bf16_f32 v211, v198, v199
    s_xor_b32 s77, s76, 26214400
    v_mfma_f32_16x16x32_bf16 v[228:231], a[208:211], v[0:3], 0
    s_waitcnt vmcnt(4)
    ds_read_b64_tr_b16 a[200:201], v247 offset:24576
    v_cmp_ne_u32 vcc, v250, v254
    v_mfma_f32_16x16x32_bf16 v[228:231], a[212:215], v[8:11], v[228:231]
    ds_read_b64_tr_b16 a[202:203], v247 offset:26624
    buffer_store_dwordx4 v[208:211], v253, s[24:27], s77 offen sc1
    v_mfma_f32_16x16x32_bf16 v[232:235], a[208:211], v[32:35], 0
    ds_read_b64_tr_b16 a[204:205], v247 offset:28672
    v_cvt_pk_bf16_f32 v212, v212, v213
    v_mfma_f32_16x16x32_bf16 v[232:235], a[212:215], v[40:43], v[232:235]
    ds_read_b64_tr_b16 a[206:207], v247 offset:30720
    v_cvt_pk_bf16_f32 v213, v214, v215
    v_mfma_f32_16x16x32_bf16 v[236:239], a[208:211], v[64:67], 0
    s_xor_b32 s55, s50, 8396800
    v_cvt_pk_bf16_f32 v214, v200, v201
    v_cvt_pk_bf16_f32 v215, v202, v203
    s_xor_b32 s77, s76, 27262976
    v_mfma_f32_16x16x32_bf16 v[236:239], a[212:215], v[72:75], v[236:239]
    s_waitcnt lgkmcnt(4)
    buffer_store_dwordx4 v[212:215], v253, s[24:27], s77 offen sc1
    v_mfma_f32_16x16x32_bf16 v[216:219], a[192:195], a[96:99], v[216:219]
    s_cbranch_vccnz L_spinA
L_spinA_back:
    v_mfma_f32_16x16x32_bf16 v[216:219], a[196:199], a[108:111], v[216:219]
    s_waitcnt lgkmcnt(0)
    v_mfma_f32_16x16x32_bf16 v[220:223], a[192:195], a[100:103], v[220:223]
    s_barrier
    buffer_load_dwordx4 a[4:7], v253, s[24:27], s55 offen sc1
    v_mfma_f32_16x16x32_bf16 v[220:223], a[196:199], a[112:115], v[220:223]
    s_xor_b32 s55, s50, 8413184
    ds_read_b64_tr_b16 a[208:209], v244 offset:49152
    ds_read_b64_tr_b16 a[210:211], v244 offset:51200
    v_mfma_f32_16x16x32_bf16 v[224:227], a[192:195], a[104:107], v[224:227]
    ds_read_b64_tr_b16 a[212:213], v244 offset:53248
    ds_read_b64_tr_b16 a[214:215], v244 offset:55296
    v_mfma_f32_16x16x32_bf16 v[224:227], a[196:199], a[116:119], v[224:227]
    buffer_load_dwordx4 a[12:15], v253, s[24:27], s55 offen sc1
    v_mfma_f32_16x16x32_bf16 v[228:231], a[200:203], a[96:99], v[228:231]
    s_xor_b32 s55, s50, 9445376
    ds_read_b64_tr_b16 a[192:193], v245 offset:49152
    v_mfma_f32_16x16x32_bf16 v[228:231], a[204:207], a[108:111], v[228:231]
    ds_read_b64_tr_b16 a[194:195], v245 offset:51200
    v_mfma_f32_16x16x32_bf16 v[232:235], a[200:203], a[100:103], v[232:235]
    buffer_load_dwordx4 a[32:35], v253, s[24:27], s55 offen sc1
    v_mfma_f32_16x16x32_bf16 v[232:235], a[204:207], a[112:115], v[232:235]
    s_xor_b32 s55, s50, 9461760
    ds_read_b64_tr_b16 a[196:197], v245 offset:53248
    v_mfma_f32_16x16x32_bf16 v[236:239], a[200:203], a[104:107], v[236:239]
    ds_read_b64_tr_b16 a[198:199], v245 offset:55296
    v_mfma_f32_16x16x32_bf16 v[236:239], a[204:207], a[116:119], v[236:239]
    s_waitcnt lgkmcnt(4)
    buffer_load_dwordx4 a[40:43], v253, s[24:27], s55 offen sc1
    v_mfma_f32_16x16x32_bf16 v[216:219], a[208:211], v[16:19], v[216:219]
    s_xor_b32 s55, s50, 10493952
    ds_read_b64_tr_b16 a[200:201], v246 offset:49152
    v_mfma_f32_16x16x32_bf16 v[216:219], a[212:215], v[24:27], v[216:219]
    ds_read_b64_tr_b16 a[202:203], v246 offset:51200
    v_mfma_f32_16x16x32_bf16 v[220:223], a[208:211], v[48:51], v[220:223]
    buffer_load_dwordx4 a[60:63], v253, s[24:27], s55 offen sc1
    v_mfma_f32_16x16x32_bf16 v[220:223], a[212:215], v[56:59], v[220:223]
    s_xor_b32 s55, s50, 10510336
    ds_read_b64_tr_b16 a[204:205], v246 offset:53248
    v_mfma_f32_16x16x32_bf16 v[224:227], a[208:211], v[80:83], v[224:227]
    ds_read_b64_tr_b16 a[206:207], v246 offset:55296
    v_mfma_f32_16x16x32_bf16 v[224:227], a[212:215], v[88:91], v[224:227]
    s_waitcnt lgkmcnt(4)
    buffer_load_dwordx4 a[68:71], v253, s[24:27], s55 offen sc1
    v_mfma_f32_16x16x32_bf16 v[228:231], a[192:195], v[16:19], v[228:231]
    ds_read_b64_tr_b16 a[208:209], v247 offset:49152
    v_mfma_f32_16x16x32_bf16 v[228:231], a[196:199], v[24:27], v[228:231]
    ds_read_b64_tr_b16 a[210:211], v247 offset:51200
    v_mfma_f32_16x16x32_bf16 v[232:235], a[192:195], v[48:51], v[232:235]
    ds_read_b64_tr_b16 a[212:213], v247 offset:53248
    v_mfma_f32_16x16x32_bf16 v[232:235], a[196:199], v[56:59], v[232:235]
    ds_read_b64_tr_b16 a[214:215], v247 offset:55296
    v_mfma_f32_16x16x32_bf16 v[236:239], a[192:195], v[80:83], v[236:239]
    v_mfma_f32_16x16x32_bf16 v[236:239], a[196:199], v[88:91], v[236:239]
    s_waitcnt lgkmcnt(4)
    v_mfma_f32_16x16x32_bf16 v[216:219], a[200:203], a[120:123], v[216:219]
    v_mfma_f32_16x16x32_bf16 v[216:219], a[204:207], a[132:135], v[216:219]
    s_waitcnt lgkmcnt(0)
    v_mfma_f32_16x16x32_bf16 v[220:223], a[200:203], a[124:127], v[220:223]
    s_barrier
    ds_read_b64_tr_b16 a[192:193], v244 offset:8192
    v_mfma_f32_16x16x32_bf16 v[220:223], a[204:207], a[136:139], v[220:223]
    ds_read_b64_tr_b16 a[194:195], v244 offset:10240
    v_mfma_f32_16x16x32_bf16 v[224:227], a[200:203], a[128:131], v[224:227]
    ds_read_b64_tr_b16 a[196:197], v244 offset:12288
    v_mfma_f32_16x16x32_bf16 v[224:227], a[204:207], a[140:143], v[224:227]
    ds_read_b64_tr_b16 a[198:199], v244 offset:14336
    v_mfma_f32_16x16x32_bf16 v[228:231], a[208:211], a[120:123], v[228:231]
    ds_read_b64_tr_b16 a[200:201], v245 offset:8192
    v_mfma_f32_16x16x32_bf16 v[228:231], a[212:215], a[132:135], v[228:231]
    ds_read_b64_tr_b16 a[202:203], v245 offset:10240
    v_mfma_f32_16x16x32_bf16 v[232:235], a[208:211], a[124:127], v[232:235]
    s_xor_b32 s55, s50, 16781312
    ds_read_b64_tr_b16 a[204:205], v245 offset:12288
    v_mfma_f32_16x16x32_bf16 v[232:235], a[212:215], a[136:139], v[232:235]
    ds_read_b64_tr_b16 a[206:207], v245 offset:14336
    v_mfma_f32_16x16x32_bf16 v[236:239], a[208:211], a[128:131], v[236:239]
    v_mfma_f32_16x16x32_bf16 v[236:239], a[212:215], a[140:143], v[236:239]
    s_waitcnt lgkmcnt(4)
    v_mfma_f32_16x16x32_bf16 v[216:219], a[192:195], v[96:99], v[216:219]
    buffer_load_dwordx4 a[16:19], v253, s[24:27], s55 offen sc1
    v_mfma_f32_16x16x32_bf16 v[216:219], a[196:199], v[104:107], v[216:219]
    s_xor_b32 s55, s50, 16797696
    ds_read_b64_tr_b16 a[208:209], v246 offset:8192
    ds_read_b64_tr_b16 a[210:211], v246 offset:10240
    v_mfma_f32_16x16x32_bf16 v[220:223], a[192:195], v[128:131], v[220:223]
    buffer_load_dwordx4 a[24:27], v253, s[24:27], s55 offen sc1
    v_mfma_f32_16x16x32_bf16 v[220:223], a[196:199], v[136:139], v[220:223]
    s_xor_b32 s55, s50, 17829888
    ds_read_b64_tr_b16 a[212:213], v246 offset:12288
    ds_read_b64_tr_b16 a[214:215], v246 offset:14336
    v_mfma_f32_16x16x32_bf16 v[224:227], a[192:195], v[160:163], v[224:227]
    buffer_load_dwordx4 a[44:47], v253, s[24:27], s55 offen sc1
    v_mfma_f32_16x16x32_bf16 v[224:227], a[196:199], v[168:171], v[224:227]
    s_waitcnt lgkmcnt(4)
    v_mfma_f32_16x16x32_bf16 v[228:231], a[200:203], v[96:99], v[228:231]
    s_xor_b32 s55, s50, 17846272
    buffer_load_dwordx4 a[52:55], v253, s[24:27], s55 offen sc1
    v_mfma_f32_16x16x32_bf16 v[228:231], a[204:207], v[104:107], v[228:231]
    s_xor_b32 s55, s50, 18878464
    ds_read_b64_tr_b16 a[192:193], v247 offset:8192
    ds_read_b64_tr_b16 a[194:195], v247 offset:10240
    v_mfma_f32_16x16x32_bf16 v[232:235], a[200:203], v[128:131], v[232:235]
    buffer_load_dwordx4 a[72:75], v253, s[24:27], s55 offen sc1
    v_mfma_f32_16x16x32_bf16 v[232:235], a[204:207], v[136:139], v[232:235]
    s_xor_b32 s55, s50, 18894848
    ds_read_b64_tr_b16 a[196:197], v247 offset:12288
    ds_read_b64_tr_b16 a[198:199], v247 offset:14336
    v_mfma_f32_16x16x32_bf16 v[236:239], a[200:203], v[160:163], v[236:239]
    buffer_load_dwordx4 a[80:83], v253, s[24:27], s55 offen sc1
    v_mfma_f32_16x16x32_bf16 v[236:239], a[204:207], v[168:171], v[236:239]
    s_waitcnt lgkmcnt(4)
    v_mfma_f32_16x16x32_bf16 v[216:219], a[208:211], a[144:147], v[216:219]
    v_mfma_f32_16x16x32_bf16 v[216:219], a[212:215], a[156:159], v[216:219]
    s_waitcnt vmcnt(15) lgkmcnt(0)
    v_mfma_f32_16x16x32_bf16 v[220:223], a[208:211], a[148:151], v[220:223]
    s_barrier
    ds_read_b64_tr_b16 a[200:201], v244 offset:16384
    v_mfma_f32_16x16x32_bf16 v[220:223], a[212:215], a[160:163], v[220:223]
    ds_read_b64_tr_b16 a[202:203], v244 offset:18432
    v_mfma_f32_16x16x32_bf16 v[224:227], a[208:211], a[152:155], v[224:227]
    ds_read_b64_tr_b16 a[204:205], v244 offset:20480
    v_mfma_f32_16x16x32_bf16 v[224:227], a[212:215], a[164:167], v[224:227]
    ds_read_b64_tr_b16 a[206:207], v244 offset:22528
    v_mfma_f32_16x16x32_bf16 v[228:231], a[192:195], a[144:147], v[228:231]
    ds_read_b64_tr_b16 a[208:209], v245 offset:16384
    v_mfma_f32_16x16x32_bf16 v[228:231], a[196:199], a[156:159], v[228:231]
    ds_read_b64_tr_b16 a[210:211], v245 offset:18432
    v_mfma_f32_16x16x32_bf16 v[232:235], a[192:195], a[148:151], v[232:235]
    ds_read_b64_tr_b16 a[212:213], v245 offset:20480
    v_mfma_f32_16x16x32_bf16 v[232:235], a[196:199], a[160:163], v[232:235]
    ds_read_b64_tr_b16 a[214:215], v245 offset:22528
    v_mfma_f32_16x16x32_bf16 v[236:239], a[192:195], a[152:155], v[236:239]
    v_mfma_f32_16x16x32_bf16 v[236:239], a[196:199], a[164:167], v[236:239]
    s_waitcnt lgkmcnt(4)
    v_mfma_f32_16x16x32_bf16 v[216:219], a[200:203], v[112:115], v[216:219]
    ds_read_b64_tr_b16 a[192:193], v246 offset:16384
    v_mfma_f32_16x16x32_bf16 v[216:219], a[204:207], v[120:123], v[216:219]
    ds_read_b64_tr_b16 a[194:195], v246 offset:18432
    v_mfma_f32_16x16x32_bf16 v[220:223], a[200:203], v[144:147], v[220:223]
    ds_read_b64_tr_b16 a[196:197], v246 offset:20480
    v_mfma_f32_16x16x32_bf16 v[220:223], a[204:207], v[152:155], v[220:223]
    s_xor_b32 s55, s51, 25165824
    ds_read_b64_tr_b16 a[198:199], v246 offset:22528
    v_mfma_f32_16x16x32_bf16 v[224:227], a[200:203], v[176:179], v[224:227]
    v_mfma_f32_16x16x32_bf16 v[224:227], a[204:207], v[184:187], v[224:227]
    s_waitcnt lgkmcnt(4)
    v_mfma_f32_16x16x32_bf16 v[228:231], a[208:211], v[112:115], v[228:231]
    ds_read_b64_tr_b16 a[200:201], v247 offset:16384
    ds_read_b64_tr_b16 a[202:203], v247 offset:18432
    v_mfma_f32_16x16x32_bf16 v[228:231], a[212:215], v[120:123], v[228:231]
    buffer_load_dwordx4 a[20:23], v253, s[24:27], s55 offen sc1
    v_mfma_f32_16x16x32_bf16 v[232:235], a[208:211], v[144:147], v[232:235]
    s_xor_b32 s55, s51, 26214400
    ds_read_b64_tr_b16 a[204:205], v247 offset:20480
    ds_read_b64_tr_b16 a[206:207], v247 offset:22528
    v_mfma_f32_16x16x32_bf16 v[232:235], a[212:215], v[152:155], v[232:235]
    buffer_load_dwordx4 a[48:51], v253, s[24:27], s55 offen sc1
    v_mfma_f32_16x16x32_bf16 v[236:239], a[208:211], v[176:179], v[236:239]
    s_xor_b32 s55, s51, 27262976
    v_mfma_f32_16x16x32_bf16 v[236:239], a[212:215], v[184:187], v[236:239]
    s_waitcnt lgkmcnt(4)
    buffer_load_dwordx4 a[76:79], v253, s[24:27], s55 offen sc1
    v_mfma_f32_16x16x32_bf16 v[216:219], a[192:195], a[168:171], v[216:219]
    v_mfma_f32_16x16x32_bf16 v[216:219], a[196:199], a[180:183], v[216:219]
    v_mfma_f32_16x16x32_bf16 v[220:223], a[192:195], a[172:175], v[220:223]
    v_mfma_f32_16x16x32_bf16 v[220:223], a[196:199], a[184:187], v[220:223]
    v_mfma_f32_16x16x32_bf16 v[224:227], a[192:195], a[176:179], v[224:227]
    v_mfma_f32_16x16x32_bf16 v[224:227], a[196:199], a[188:191], v[224:227]
    s_waitcnt lgkmcnt(2)
    v_mfma_f32_16x16x32_bf16 v[228:231], a[200:203], a[168:171], v[228:231]
    s_waitcnt lgkmcnt(0)
    v_mfma_f32_16x16x32_bf16 v[228:231], a[204:207], a[180:183], v[228:231]
    v_mfma_f32_16x16x32_bf16 v[232:235], a[200:203], a[172:175], v[232:235]
    v_mfma_f32_16x16x32_bf16 v[232:235], a[204:207], a[184:187], v[232:235]
    v_mfma_f32_16x16x32_bf16 v[236:239], a[200:203], a[176:179], v[236:239]
    v_mfma_f32_16x16x32_bf16 v[236:239], a[204:207], a[188:191], v[236:239]
    v_mfma_f32_16x16x32_bf16 v[216:219], a[88:91], a[0:3], v[216:219]
    v_mfma_f32_16x16x32_bf16 v[220:223], a[88:91], a[28:31], v[220:223]
    v_mfma_f32_16x16x32_bf16 v[224:227], a[88:91], a[56:59], v[224:227]
    s_waitcnt vmcnt(14)
    v_mfma_f32_16x16x32_bf16 v[228:231], a[86:89], a[2:5], v[228:231]
    s_waitcnt vmcnt(12)
    v_mfma_f32_16x16x32_bf16 v[232:235], a[86:89], a[30:33], v[232:235]
    s_waitcnt vmcnt(10)
    v_mfma_f32_16x16x32_bf16 v[236:239], a[86:89], a[58:61], v[236:239]
    v_mfma_f32_16x16x32_bf16 v[216:219], a[86:89], a[6:9], v[216:219]
    v_mfma_f32_16x16x32_bf16 v[220:223], a[86:89], a[34:37], v[220:223]
    v_mfma_f32_16x16x32_bf16 v[224:227], a[86:89], a[62:65], v[224:227]
    v_mfma_f32_16x16x32_bf16 v[228:231], a[86:89], a[10:13], v[228:231]
    v_mfma_f32_16x16x32_bf16 v[232:235], a[86:89], a[38:41], v[232:235]
    s_waitcnt vmcnt(9)
    v_mfma_f32_16x16x32_bf16 v[236:239], a[86:89], a[66:69], v[236:239]
    s_mov_b32 s54, 524288
L_fin:
    s_waitcnt vmcnt(8)
    v_mfma_f32_16x16x32_bf16 v[192:195], a[86:89], a[14:17], v[216:219]
    s_waitcnt vmcnt(6)
    v_mfma_f32_16x16x32_bf16 v[196:199], a[86:89], a[42:45], v[220:223]
    s_waitcnt vmcnt(4)
    v_mfma_f32_16x16x32_bf16 v[200:203], a[86:89], a[70:73], v[224:227]
    s_waitcnt vmcnt(2)
    v_mfma_f32_16x16x32_bf16 v[204:207], a[86:89], a[18:21], v[228:231]
    s_waitcnt vmcnt(1)
    v_mfma_f32_16x16x32_bf16 v[208:211], a[86:89], a[46:49], v[232:235]
    s_waitcnt vmcnt(0)
    v_mfma_f32_16x16x32_bf16 v[212:215], a[86:89], a[74:77], v[236:239]
    v_mfma_f32_16x16x32_bf16 v[192:195], a[86:89], a[22:25], v[192:195]
    v_mfma_f32_16x16x32_bf16 v[196:199], a[86:89], a[50:53], v[196:199]
    v_mfma_f32_16x16x32_bf16 v[200:203], a[86:89], a[78:81], v[200:203]
    v_mfma_f32_16x16x32_bf16 v[204:207], a[84:87], a[24:27], v[204:207]
    v_mfma_f32_16x16x32_bf16 v[208:211], a[84:87], a[52:55], v[208:211]
    v_mfma_f32_16x16x32_bf16 v[212:215], a[84:87], a[80:83], v[212:215]
    s_mov_b32 s82, 32768
    s_mov_b32 s83, 65536
    s_nop 1
    v_cmp_u_f32_e64 s[80:81], v192, v196
    v_cvt_pk_bf16_f32 v192, v192, v193
    v_cvt_pk_bf16_f32 v193, v194, v195
    v_cvt_pk_bf16_f32 v196, v196, v197
    v_cvt_pk_bf16_f32 v197, v198, v199
    v_cmp_u_f32_e64 s[36:37], v200, v204
    v_cvt_pk_bf16_f32 v200, v200, v201
    v_cvt_pk_bf16_f32 v201, v202, v203
    v_cvt_pk_bf16_f32 v194, v204, v205
    v_cvt_pk_bf16_f32 v195, v206, v207
    s_or_b64 s[80:81], s[80:81], s[36:37]
    v_cmp_u_f32 vcc, v208, v212
    v_cvt_pk_bf16_f32 v198, v208, v209
    v_cvt_pk_bf16_f32 v199, v210, v211
    v_cvt_pk_bf16_f32 v202, v212, v213
    v_cvt_pk_bf16_f32 v203, v214, v215
    s_or_b64 s[80:81], s[80:81], vcc
    s_cbranch_scc1 L_retry
L_fin2:
    v_permlane16_swap_b32 v192, v194
    v_permlane16_swap_b32 v193, v195
    buffer_store_dwordx4 v[192:195], v249, s[28:31], 0 offen
    v_permlane16_swap_b32 v196, v198
    v_permlane16_swap_b32 v197, v199
    buffer_store_dwordx4 v[196:199], v249, s[28:31], s82 offen
    v_permlane16_swap_b32 v200, v202
    v_permlane16_swap_b32 v201, v203
    buffer_store_dwordx4 v[200:203], v249, s[28:31], s83 offen
L_exit:
    s_endpgm
L_retry:
    s_sub_u32 s54, s54, 1
    s_cmp_eq_u32 s54, 0
    s_cbranch_scc1 L_fin2
    s_xor_b32 s55, s50, 16781312
    buffer_load_dwordx4 a[16:19], v253, s[24:27], s55 offen sc1
    s_xor_b32 s55, s51, 25165824
    buffer_load_dwordx4 a[20:23], v253, s[24:27], s55 offen sc1
    s_xor_b32 s55, s50, 16797696
    buffer_load_dwordx4 a[24:27], v253, s[24:27], s55 offen sc1
    s_xor_b32 s55, s50, 17829888
    buffer_load_dwordx4 a[44:47], v253, s[24:27], s55 offen sc1
    s_xor_b32 s55, s51, 26214400
    buffer_load_dwordx4 a[48:51], v253, s[24:27], s55 offen sc1
    s_xor_b32 s55, s50, 17846272
    buffer_load_dwordx4 a[52:55], v253, s[24:27], s55 offen sc1
    s_xor_b32 s55, s50, 18878464
    buffer_load_dwordx4 a[72:75], v253, s[24:27], s55 offen sc1
    s_xor_b32 s55, s51, 27262976
    buffer_load_dwordx4 a[76:79], v253, s[24:27], s55 offen sc1
    s_xor_b32 s55, s50, 18894848
    buffer_load_dwordx4 a[80:83], v253, s[24:27], s55 offen sc1
    s_waitcnt vmcnt(0)
    s_branch L_fin
L_spinA:
    s_mov_b32 s54, 131072
L_spinA_loop:
    buffer_load_dword v254, v248, s[24:27], 0 offen sc1
    s_waitcnt vmcnt(0)
L_hopa_14:
    s_cbranch_execz L_backa
    v_cmp_ne_u32 vcc, v250, v254
    s_nop 4
    s_cbranch_vccz L_spinA_back
    s_sub_u32 s54, s54, 1
    s_cmp_lg_u32 s54, 0
    s_cbranch_scc1 L_spinA_loop
    s_branch L_spinA_back
L_spinB:
    s_mov_b32 s54, 32768
L_spinB_loop:
    buffer_load_dword v255, v248, s[24:27], 0 offen sc1
    s_waitcnt vmcnt(0)
    v_cmp_eq_u32_e64 s[36:37], v250, v255
    s_nop 0
    s_and_b32 s36, s36, 0x88
    s_cbranch_scc0 L_spinB_back
    s_sub_u32 s54, s54, 1
    s_cmp_lg_u32 s54, 0
    s_cbranch_scc1 L_spinB_loop
    s_branch L_spinB_back
L_fallback:
    s_waitcnt vmcnt(0) lgkmcnt(0)
    s_barrier
    s_mov_b32 s78, 1
    s_nop 7
    v_accvgpr_read_b32 v0, a246
    v_lshrrev_b32 v0, 4, v0
    v_lshrrev_b32 v1, 4, v0
    v_and_b32 v2, 15, v0
    v_lshlrev_b32 v3, 1, v1
    v_xor_b32 v3, v2, v3
    v_lshlrev_b32 v3, 4, v3
    v_lshl_or_b32 v3, v1, 8, v3
    s_lshl_b32 s82, s65, 1
    s_add_u32 s82, s82, s62
    s_lshl_b32 s82, s82, 3
    s_add_u32 s82, s82, s64
    s_lshl_b32 s82, s82, 5
    s_add_u32 s82, s82, s63
    s_lshl_b32 s82, s82, 12
    v_add_u32 v252, s82, v3
    v_xor_b32 v253, 0x80, v252
    v_xor_b32 v254, 16, v252
    v_xor_b32 v255, 0x90, v252
    s_mul_i32 s82, s62, 40960
    s_and_b32 s83, s67, 1
    s_lshl_b32 s83, s83, 7
    s_add_u32 s83, s83, s82
    v_bfe_u32 v3, v0, 4, 1
    v_lshrrev_b32 v4, 5, v0
    v_lshl_or_b32 v1, v3, 1, v4
    v_and_b32 v3, 7, v0
    v_bfe_u32 v4, v0, 3, 1
    v_lshl_or_b32 v3, v3, 1, v4
    v_xor_b32 v3, v3, v1
    v_lshlrev_b32 v3, 4, v3
    v_lshl_or_b32 v3, v2, 8, v3
    v_xor_b32 v240, s83, v3
    v_xor_b32 v241, 64, v240
    v_xor_b32 v242, 0x80, v240
    v_xor_b32 v243, 0xc0, v240
    v_and_b32 v2, 3, v0
    v_lshlrev_b32 v3, 1, v2
    v_xor_b32 v3, v3, v1
    v_lshlrev_b32 v3, 4, v3
    v_lshl_or_b32 v3, v2, 8, v3
    v_xor_b32 v212, s83, v3
    v_xor_b32 v213, 64, v212
    v_xor_b32 v214, 0x80, v212
    v_xor_b32 v215, 0xc0, v212
    s_add_u32 s82, s83, 81920
    v_bfe_u32 v1, v0, 2, 3
    v_lshrrev_b32 v2, 5, v0
    v_lshl_or_b32 v1, v1, 1, v2
    v_bfe_u32 v2, v0, 1, 1
    v_xor_b32 v1, v1, v2
    v_and_b32 v2, 1, v0
    v_lshl_or_b32 v1, v1, 1, v2
    v_lshlrev_b32 v1, 3, v1
    v_lshrrev_b32 v2, 2, v0
    v_lshl_or_b32 v1, v2, 8, v1
    v_xor_b32 v244, s82, v1
    v_xor_b32 v245, 0x20, v244
    v_xor_b32 v246, 0x40, v244
    v_xor_b32 v247, 0x60, v244
    v_xor_b32 v248, 0x80, v244
    v_xor_b32 v249, 0xa0, v244
    v_xor_b32 v250, 0xc0, v244
    v_xor_b32 v251, 0xe0, v244
    v_mov_b32 v8, 0xff800000
    v_mov_b32 v9, 0xff800000
    v_mov_b32 v10, 0xff800000
    v_mov_b32 v11, 0xff800000
    v_mov_b32 v12, 0xff800000
    v_mov_b32 v13, 0xff800000
    s_mov_b32 s74, 0
L_fbloop:
    s_mov_b32 m0, s68
    s_nop 0
    buffer_load_dwordx4 v252, s[8:11], s74 offen offset:0 nt lds
    buffer_load_dwordx4 v253, s[8:11], s74 offen offset:1024 nt lds
    buffer_load_dwordx4 v254, s[8:11], s74 offen offset:2048 nt lds
    buffer_load_dwordx4 v255, s[8:11], s74 offen offset:3072 nt lds
    s_waitcnt vmcnt(0)
    s_barrier
    ds_read_b128 a[96:99], v240 offset:0
    ds_read_b128 a[100:103], v241 offset:0
    ds_read_b128 a[104:107], v242 offset:0
    ds_read_b128 a[108:111], v243 offset:0
    ds_read_b128 a[112:115], v240 offset:4096
    ds_read_b128 a[116:119], v241 offset:4096
    ds_read_b128 a[120:123], v242 offset:4096
    ds_read_b128 a[124:127], v243 offset:4096
    s_waitcnt lgkmcnt(0)
    s_barrier
    v_mfma_f32_16x16x32_bf16 v[16:19], a[96:99], a[0:3], 0
    v_mfma_f32_16x16x32_bf16 v[16:19], a[100:103], a[12:15], v[16:19]
    v_mfma_f32_16x16x32_bf16 v[16:19], a[104:107], a[24:27], v[16:19]
    v_mfma_f32_16x16x32_bf16 v[16:19], a[108:111], a[36:39], v[16:19]
    v_mfma_f32_16x16x32_bf16 v[20:23], a[112:115], a[0:3], 0
    v_mfma_f32_16x16x32_bf16 v[20:23], a[116:119], a[12:15], v[20:23]
    v_mfma_f32_16x16x32_bf16 v[20:23], a[120:123], a[24:27], v[20:23]
    v_mfma_f32_16x16x32_bf16 v[20:23], a[124:127], a[36:39], v[20:23]
    v_mfma_f32_16x16x32_bf16 v[24:27], a[96:99], a[4:7], 0
    v_mfma_f32_16x16x32_bf16 v[24:27], a[100:103], a[16:19], v[24:27]
    v_mfma_f32_16x16x32_bf16 v[24:27], a[104:107], a[28:31], v[24:27]
    v_mfma_f32_16x16x32_bf16 v[24:27], a[108:111], a[40:43], v[24:27]
    v_mfma_f32_16x16x32_bf16 v[28:31], a[112:115], a[4:7], 0
    v_mfma_f32_16x16x32_bf16 v[28:31], a[116:119], a[16:19], v[28:31]
    v_mfma_f32_16x16x32_bf16 v[28:31], a[120:123], a[28:31], v[28:31]
    v_mfma_f32_16x16x32_bf16 v[28:31], a[124:127], a[40:43], v[28:31]
    v_mfma_f32_16x16x32_bf16 v[32:35], a[96:99], a[8:11], 0
    v_mfma_f32_16x16x32_bf16 v[32:35], a[100:103], a[20:23], v[32:35]
    v_mfma_f32_16x16x32_bf16 v[32:35], a[104:107], a[32:35], v[32:35]
    v_mfma_f32_16x16x32_bf16 v[32:35], a[108:111], a[44:47], v[32:35]
    v_mfma_f32_16x16x32_bf16 v[36:39], a[112:115], a[8:11], 0
    v_mfma_f32_16x16x32_bf16 v[36:39], a[116:119], a[20:23], v[36:39]
    v_mfma_f32_16x16x32_bf16 v[36:39], a[120:123], a[32:35], v[36:39]
    v_mfma_f32_16x16x32_bf16 v[36:39], a[124:127], a[44:47], v[36:39]
    v_mfma_f32_16x16x32_bf16 v[40:43], a[96:99], a[48:51], 0
    v_mfma_f32_16x16x32_bf16 v[40:43], a[100:103], a[60:63], v[40:43]
    v_mfma_f32_16x16x32_bf16 v[40:43], a[104:107], a[72:75], v[40:43]
    v_mfma_f32_16x16x32_bf16 v[40:43], a[108:111], a[84:87], v[40:43]
    v_mfma_f32_16x16x32_bf16 v[44:47], a[112:115], a[48:51], 0
    v_mfma_f32_16x16x32_bf16 v[44:47], a[116:119], a[60:63], v[44:47]
    v_mfma_f32_16x16x32_bf16 v[44:47], a[120:123], a[72:75], v[44:47]
    v_mfma_f32_16x16x32_bf16 v[44:47], a[124:127], a[84:87], v[44:47]
    v_mfma_f32_16x16x32_bf16 v[48:51], a[96:99], a[52:55], 0
    v_mfma_f32_16x16x32_bf16 v[48:51], a[100:103], a[64:67], v[48:51]
    v_mfma_f32_16x16x32_bf16 v[48:51], a[104:107], a[76:79], v[48:51]
    v_mfma_f32_16x16x32_bf16 v[48:51], a[108:111], a[88:91], v[48:51]
    v_mfma_f32_16x16x32_bf16 v[52:55], a[112:115], a[52:55], 0
    v_mfma_f32_16x16x32_bf16 v[52:55], a[116:119], a[64:67], v[52:55]
    v_mfma_f32_16x16x32_bf16 v[52:55], a[120:123], a[76:79], v[52:55]
    v_mfma_f32_16x16x32_bf16 v[52:55], a[124:127], a[88:91], v[52:55]
    v_mfma_f32_16x16x32_bf16 v[56:59], a[96:99], a[56:59], 0
    v_mfma_f32_16x16x32_bf16 v[56:59], a[100:103], a[68:71], v[56:59]
    v_mfma_f32_16x16x32_bf16 v[56:59], a[104:107], a[80:83], v[56:59]
    v_mfma_f32_16x16x32_bf16 v[56:59], a[108:111], a[92:95], v[56:59]
    v_mfma_f32_16x16x32_bf16 v[60:63], a[112:115], a[56:59], 0
    v_mfma_f32_16x16x32_bf16 v[60:63], a[116:119], a[68:71], v[60:63]
    v_mfma_f32_16x16x32_bf16 v[60:63], a[120:123], a[80:83], v[60:63]
    v_mfma_f32_16x16x32_bf16 v[60:63], a[124:127], a[92:95], v[60:63]
    v_max3_f32 v8, v8, v16, v17
    v_max3_f32 v8, v8, v18, v19
    v_max3_f32 v8, v8, v20, v21
    v_max3_f32 v8, v8, v22, v23
    v_max3_f32 v9, v9, v24, v25
    v_max3_f32 v9, v9, v26, v27
    v_max3_f32 v9, v9, v28, v29
    v_max3_f32 v9, v9, v30, v31
    v_max3_f32 v10, v10, v32, v33
    v_max3_f32 v10, v10, v34, v35
    v_max3_f32 v10, v10, v36, v37
    v_max3_f32 v10, v10, v38, v39
    v_max3_f32 v11, v11, v40, v41
    v_max3_f32 v11, v11, v42, v43
    v_max3_f32 v11, v11, v44, v45
    v_max3_f32 v11, v11, v46, v47
    v_max3_f32 v12, v12, v48, v49
    v_max3_f32 v12, v12, v50, v51
    v_max3_f32 v12, v12, v52, v53
    v_max3_f32 v12, v12, v54, v55
    v_max3_f32 v13, v13, v56, v57
    v_max3_f32 v13, v13, v58, v59
    v_max3_f32 v13, v13, v60, v61
    v_max3_f32 v13, v13, v62, v63
    s_add_u32 s74, s74, 8192
    s_cmp_lt_u32 s74, 131072
    s_cbranch_scc1 L_fbloop
    v_mov_b32 v1, v8
    s_nop 1
    v_permlane32_swap_b32 v1, v8
    v_max_f32 v8, v1, v8
    v_mov_b32 v1, v8
    s_nop 1
    v_permlane16_swap_b32 v1, v8
    v_max_f32 v8, v1, v8
    v_sub_f32 v216, 0, v8
    v_sub_f32 v217, 0, v8
    v_sub_f32 v218, 0, v8
    v_sub_f32 v219, 0, v8
    v_mov_b32 v1, v9
    s_nop 1
    v_permlane32_swap_b32 v1, v9
    v_max_f32 v9, v1, v9
    v_mov_b32 v1, v9
    s_nop 1
    v_permlane16_swap_b32 v1, v9
    v_max_f32 v9, v1, v9
    v_sub_f32 v220, 0, v9
    v_sub_f32 v221, 0, v9
    v_sub_f32 v222, 0, v9
    v_sub_f32 v223, 0, v9
    v_mov_b32 v1, v10
    s_nop 1
    v_permlane32_swap_b32 v1, v10
    v_max_f32 v10, v1, v10
    v_mov_b32 v1, v10
    s_nop 1
    v_permlane16_swap_b32 v1, v10
    v_max_f32 v10, v1, v10
    v_sub_f32 v224, 0, v10
    v_sub_f32 v225, 0, v10
    v_sub_f32 v226, 0, v10
    v_sub_f32 v227, 0, v10
    v_mov_b32 v1, v11
    s_nop 1
    v_permlane32_swap_b32 v1, v11
    v_max_f32 v11, v1, v11
    v_mov_b32 v1, v11
    s_nop 1
    v_permlane16_swap_b32 v1, v11
    v_max_f32 v11, v1, v11
    v_sub_f32 v228, 0, v11
    v_sub_f32 v229, 0, v11
    v_sub_f32 v230, 0, v11
    v_sub_f32 v231, 0, v11
    v_mov_b32 v1, v12
    s_nop 1
    v_permlane32_swap_b32 v1, v12
    v_max_f32 v12, v1, v12
    v_mov_b32 v1, v12
    s_nop 1
    v_permlane16_swap_b32 v1, v12
    v_max_f32 v12, v1, v12
    v_sub_f32 v232, 0, v12
    v_sub_f32 v233, 0, v12
    v_sub_f32 v234, 0, v12
    v_sub_f32 v235, 0, v12
    v_mov_b32 v1, v13
    s_nop 1
    v_permlane32_swap_b32 v1, v13
    v_max_f32 v13, v1, v13
    v_mov_b32 v1, v13
    s_nop 1
    v_permlane16_swap_b32 v1, v13
    v_max_f32 v13, v1, v13
    v_sub_f32 v236, 0, v13
    v_sub_f32 v237, 0, v13
    v_sub_f32 v238, 0, v13
    v_sub_f32 v239, 0, v13
    s_add_u32 m0, s68, 0
    s_xor_b32 s74, s38, 0
    buffer_load_dwordx4 v252, s[8:11], s74 offen offset:0 nt lds
    buffer_load_dwordx4 v253, s[8:11], s74 offen offset:1024 nt lds
    buffer_load_dwordx4 v254, s[8:11], s74 offen offset:2048 nt lds
    buffer_load_dwordx4 v255, s[8:11], s74 offen offset:3072 nt lds
    s_add_u32 m0, s68, 81920
    s_xor_b32 s74, s38, 0
    buffer_load_dwordx4 v252, s[12:15], s74 offen offset:0 nt lds
    buffer_load_dwordx4 v253, s[12:15], s74 offen offset:1024 nt lds
    buffer_load_dwordx4 v254, s[12:15], s74 offen offset:2048 nt lds
    buffer_load_dwordx4 v255, s[12:15], s74 offen offset:3072 nt lds
    s_add_u32 m0, s68, 8192
    s_xor_b32 s74, s38, 8192
    buffer_load_dwordx4 v252, s[8:11], s74 offen offset:0 nt lds
    buffer_load_dwordx4 v253, s[8:11], s74 offen offset:1024 nt lds
    buffer_load_dwordx4 v254, s[8:11], s74 offen offset:2048 nt lds
    buffer_load_dwordx4 v255, s[8:11], s74 offen offset:3072 nt lds
    s_add_u32 m0, s68, 90112
    s_xor_b32 s74, s38, 8192
    buffer_load_dwordx4 v252, s[12:15], s74 offen offset:0 nt lds
    buffer_load_dwordx4 v253, s[12:15], s74 offen offset:1024 nt lds
    buffer_load_dwordx4 v254, s[12:15], s74 offen offset:2048 nt lds
    buffer_load_dwordx4 v255, s[12:15], s74 offen offset:3072 nt lds
    s_add_u32 m0, s68, 16384
    s_xor_b32 s74, s38, 16384
    buffer_load_dwordx4 v252, s[8:11], s74 offen offset:0 nt lds
    buffer_load_dwordx4 v253, s[8:11], s74 offen offset:1024 nt lds
    buffer_load_dwordx4 v254, s[8:11], s74 offen offset:2048 nt lds
    buffer_load_dwordx4 v255, s[8:11], s74 offen offset:3072 nt lds
    s_add_u32 m0, s68, 98304
    s_xor_b32 s74, s38, 16384
    buffer_load_dwordx4 v252, s[12:15], s74 offen offset:0 nt lds
    buffer_load_dwordx4 v253, s[12:15], s74 offen offset:1024 nt lds
    buffer_load_dwordx4 v254, s[12:15], s74 offen offset:2048 nt lds
    buffer_load_dwordx4 v255, s[12:15], s74 offen offset:3072 nt lds
    s_add_u32 m0, s68, 24576
    s_xor_b32 s74, s38, 24576
    buffer_load_dwordx4 v252, s[8:11], s74 offen offset:0 nt lds
    buffer_load_dwordx4 v253, s[8:11], s74 offen offset:1024 nt lds
    buffer_load_dwordx4 v254, s[8:11], s74 offen offset:2048 nt lds
    buffer_load_dwordx4 v255, s[8:11], s74 offen offset:3072 nt lds
    s_add_u32 m0, s68, 106496
    s_xor_b32 s74, s38, 24576
    buffer_load_dwordx4 v252, s[12:15], s74 offen offset:0 nt lds
    buffer_load_dwordx4 v253, s[12:15], s74 offen offset:1024 nt lds
    buffer_load_dwordx4 v254, s[12:15], s74 offen offset:2048 nt lds
    buffer_load_dwordx4 v255, s[12:15], s74 offen offset:3072 nt lds
    s_add_u32 m0, s68, 32768
    s_xor_b32 s74, s38, 32768
    buffer_load_dwordx4 v252, s[8:11], s74 offen offset:0 nt lds
    buffer_load_dwordx4 v253, s[8:11], s74 offen offset:1024 nt lds
    buffer_load_dwordx4 v254, s[8:11], s74 offen offset:2048 nt lds
    buffer_load_dwordx4 v255, s[8:11], s74 offen offset:3072 nt lds
    s_add_u32 m0, s68, 114688
    s_xor_b32 s74, s38, 32768
    buffer_load_dwordx4 v252, s[12:15], s74 offen offset:0 nt lds
    buffer_load_dwordx4 v253, s[12:15], s74 offen offset:1024 nt lds
    buffer_load_dwordx4 v254, s[12:15], s74 offen offset:2048 nt lds
    buffer_load_dwordx4 v255, s[12:15], s74 offen offset:3072 nt lds
    s_xor_b32 s74, s38, 40960
    buffer_load_dwordx4 a[216:219], v252, s[8:11], s74 offen offset:0 nt
    buffer_load_dwordx4 a[220:223], v253, s[8:11], s74 offen offset:1024 nt
    buffer_load_dwordx4 a[224:227], v254, s[8:11], s74 offen offset:2048 nt
    buffer_load_dwordx4 a[228:231], v255, s[8:11], s74 offen offset:3072 nt
    s_xor_b32 s74, s38, 40960
    buffer_load_dwordx4 a[232:235], v252, s[12:15], s74 offen offset:0 nt
    buffer_load_dwordx4 a[236:239], v253, s[12:15], s74 offen offset:1024 nt
    buffer_load_dwordx4 a[252:255], v254, s[12:15], s74 offen offset:2048 nt
    buffer_load_dwordx4 v[92:95], v255, s[12:15], s74 offen offset:3072 nt
    s_waitcnt vmcnt(0)
    s_barrier
    ds_read_b128 a[96:99], v240 offset:0
    ds_read_b128 a[100:103], v241 offset:0
    ds_read_b128 a[104:107], v242 offset:0
    ds_read_b128 a[108:111], v243 offset:0
    ds_read_b128 a[112:115], v240 offset:4096
    ds_read_b128 a[116:119], v241 offset:4096
    ds_read_b128 a[120:123], v242 offset:4096
    ds_read_b128 a[124:127], v243 offset:4096
    ds_read_b64_tr_b16 a[144:145], v244 offset:0
    ds_read_b64_tr_b16 a[146:147], v244 offset:4096
    ds_read_b64_tr_b16 a[148:149], v245 offset:0
    ds_read_b64_tr_b16 a[150:151], v245 offset:4096
    ds_read_b64_tr_b16 a[152:153], v246 offset:0
    ds_read_b64_tr_b16 a[154:155], v246 offset:4096
    ds_read_b64_tr_b16 a[156:157], v247 offset:0
    ds_read_b64_tr_b16 a[158:159], v247 offset:4096
    ds_read_b64_tr_b16 a[160:161], v248 offset:0
    ds_read_b64_tr_b16 a[162:163], v248 offset:4096
    ds_read_b64_tr_b16 a[164:165], v249 offset:0
    ds_read_b64_tr_b16 a[166:167], v249 offset:4096
    ds_read_b64_tr_b16 a[168:169], v250 offset:0
    ds_read_b64_tr_b16 a[170:171], v250 offset:4096
    ds_read_b64_tr_b16 a[172:173], v251 offset:0
    ds_read_b64_tr_b16 a[174:175], v251 offset:4096
    s_waitcnt lgkmcnt(0)
    s_add_u32 m0, s68, 32768
    s_xor_b32 s74, s38, 32768
    s_nop 7
    s_branch L_attn
.section .rodata,"a"
.p2align 6
.amdhsa_kernel concat_heads__gqa_block_cached__gqa_block_cached__near_ridge_kernel
  .amdhsa_next_free_vgpr 512
  .amdhsa_next_free_sgpr 102
  .amdhsa_accum_offset 256
  .amdhsa_group_segment_fixed_size 0
  .amdhsa_kernarg_size 104
  .amdhsa_user_sgpr_count 2
  .amdhsa_user_sgpr_kernarg_segment_ptr 1
  .amdhsa_system_sgpr_workgroup_id_x 1
  .amdhsa_float_denorm_mode_32 3
.end_amdhsa_kernel
```
